```python
import torch

def _softmax(x, axis=-1):
    return torch.softmax(x, dim=axis)
def _gelu(x):
    return torch.nn.functional.gelu(x, approximate="tanh")
def _silu(x):
    return torch.nn.functional.silu(x)
def _sigmoid(x):
    return torch.sigmoid(x)
def _layernorm(x, axis=-1, eps=1e-5):
    m = x.mean(dim=axis, keepdim=True)
    v = x.var(dim=axis, keepdim=True, unbiased=False)
    return (x - m) / torch.sqrt(v + eps)
def _scatter_add(tgt, idx, src, axis=0):
    return tgt.clone().index_add_(axis, idx, src)
def _segment_sum(src, seg, n):
    out = torch.zeros((n,) + src.shape[1:], dtype=src.dtype)
    return out.index_add_(0, seg, src)
def _pad(x, pw):
    flat = tuple(v for pair in reversed(pw) for v in pair)
    return torch.nn.functional.pad(x, flat)

kernel_name = 'gated_mix__linear_attn_block__dense_activation_relu__prompt'

def setup_inputs():

    _w = (lambda a: (lambda t: t.to(torch.bfloat16) if t.is_floating_point() else t)(torch.as_tensor(a)))
    def _A_setup():
        B, S, D = 1, 2048, 512
        return {
            "x": _w((lambda *s: torch.randn(*s, dtype=torch.bfloat16) * 0.05)(B, S, D)),
            "wqkv": _w((lambda *s: torch.randn(*s, dtype=torch.bfloat16) * 0.8)(D, 3 * D)),
            "wo": _w((lambda *s: torch.randn(*s, dtype=torch.bfloat16) * 0.2)(D, D)),
        }
    _A_in = _A_setup()

    def _B_setup():
        B, S, D, Dff = 1, 2048, 512, 1376
        return {
            "x": _w((lambda *s: torch.randn(*s, dtype=torch.bfloat16) * 0.05)(B, S, D)),
            "w1": _w((lambda *s: torch.randn(*s, dtype=torch.bfloat16) * 0.05)(D, Dff)),
            "w2": _w((lambda *s: torch.randn(*s, dtype=torch.bfloat16) * 0.05)(Dff, D)),
        }
    _B_in = _B_setup()

    return {
        "A_x": _A_in["x"],
        "A_wqkv": _A_in["wqkv"],
        "A_wo": _A_in["wo"],
        "B_x": _B_in["x"],
        "B_w1": _B_in["w1"],
        "B_w2": _B_in["w2"],
        "gate_w": _w((lambda *s: torch.randn(*s, dtype=torch.bfloat16) * 0.05)(512) * 16.0),
    }

def reference(A_x, A_wqkv, A_wo, B_x, B_w1, B_w2, gate_w):
    def _A_ref(x, wqkv, wo):
        B, S, D = x.shape
        H = 32; Dh = D // H
        qkv = (lambda x, *d: x.permute(*d))((x @ wqkv).reshape(B, S, 3, H, Dh), 2, 0, 3, 1, 4)
        q, k, v = qkv[0], qkv[1], qkv[2]
        phi = lambda t: torch.where(t > 0, t + 1, torch.exp(t)) + 1e-6
        pq, pk = phi(q), phi(k)
        kv = torch.einsum("bhsd,bhse->bhde", pk, v)
        z = torch.einsum("bhsd->bhd", pk)
        num = torch.einsum("bhqd,bhde->bhqe", pq, kv)
        den = torch.einsum("bhqd,bhd->bhq", pq, z)[..., None] + 1e-6
        o = num / den
        return (lambda x, *d: x.permute(*d))(o, 0, 2, 1, 3).reshape(B, S, D) @ wo

    def _B_ref(x, w1, w2):
        h = torch.einsum("bsd,df->bsf", x, w1)
        zero = torch.zeros_like(h)
        h = torch.maximum(h, zero)
        return torch.einsum("bsf,fd->bsd", h, w2)

    x = A_x
    g = _sigmoid((x * gate_w).sum(-1, keepdims=True))
    a = _A_ref(x, A_wqkv, A_wo)
    b = _B_ref(x, B_w1, B_w2)
    return g * a + (1 - g) * b
```

```asm
; @launch grid=(256,1,1) block=(512,1,1) lds=154624
.amdgcn_target "amdgcn-amd-amdhsa--gfx950"
.text
.p2align 12
.fill 832, 4, 0xbf800000
.globl gated_mix__linear_attn_block__dense_activation_relu__prompt_kernel
.p2align 8
.type gated_mix__linear_attn_block__dense_activation_relu__prompt_kernel,@function
gated_mix__linear_attn_block__dense_activation_relu__prompt_kernel:
    s_cmp_ge_u32 s2, 256
    s_cbranch_scc1 L_end
    s_load_dwordx16 s[36:51], s[0:1], 0
    s_load_dwordx4 s[52:55], s[0:1], 64
    v_lshrrev_b32 v1, 6, v0
    s_and_b32 s67, s2, 7
    v_readfirstlane_b32 s56, v1
    v_and_b32 v1, 63, v0
    s_lshr_b32 s68, s2, 3
    s_and_b32 s58, s68, 1
    s_lshr_b32 s57, s67, 1
    s_lshr_b32 s69, s68, 3
    s_lshl2_add_u32 s57, s57, s69
    s_and_b32 s67, s67, 1
    s_bfe_u32 s59, s68, 0x20001
    s_lshl2_add_u32 s59, s67, s59
    s_lshl1_add_u32 s60, s57, s67
    s_and_b32 s61, s68, 7
    s_cmp_lt_u32 s56, 4
    s_cbranch_scc1 L_consumer
    s_add_u32 s65, s57, s59
    s_and_b32 s65, s65, 3
    s_mov_b32 s62, 0x75463120
    s_cmp_eq_u32 s65, 1
    s_cselect_b32 s62, 0x76532410, s62
    s_cmp_eq_u32 s65, 2
    s_cselect_b32 s62, 0x65742031, s62
    s_cmp_eq_u32 s65, 3
    s_cselect_b32 s62, 0x76435201, s62
    s_sub_u32 s69, s56, 4
    s_lshl_b32 s66, s69, 12
    v_lshrrev_b32 v21, 3, v1
    v_lshrrev_b32 v22, 4, v1
    v_and_b32 v23, 7, v1
    v_xor_b32 v23, v23, v22
    v_lshlrev_b32 v23, 4, v23
    v_lshl_add_u32 v23, v21, 10, v23
    s_lshl2_add_u32 s67, s57, s69
    s_lshl_b32 s67, s67, 15
    v_add_u32 v4, s67, v23
    v_xor_b32 v5, 64, v4
    v_add_u32 v6, 14336, v4
    v_add_u32 v7, 21504, v5
    v_add_u32 v5, 7168, v5
    s_lshl_b32 s30, s59, 7
    s_add_u32 s30, s30, 1024
    s_movk_i32 s28, 3072
    s_movk_i32 s29, 1024
    s_cmp_eq_u32 s58, 0
    s_cbranch_scc1 L_par0
    s_lshl_b32 s30, s59, 8
    s_movk_i32 s28, 2752
    s_movk_i32 s29, 128
L_par0:
    s_lshl_b32 s74, s28, 6
    s_lshl_b32 s68, s28, 2
    s_sub_u32 s68, s68, 1024
    v_bfe_u32 v23, v1, 1, 2
    v_xor_b32 v23, v23, v22
    v_and_b32 v24, 1, v1
    v_lshlrev_b32 v24, 4, v24
    v_lshl_add_u32 v24, v23, 5, v24
    v_bfe_u32 v23, v1, 3, 1
    v_xor_b32 v26, 1, v23
    s_lshl_b32 s67, s69, 4
    v_add_u32 v22, s67, v22
    v_mad_u32_u24 v25, v22, s28, v24
    v_add_u32 v25, s30, v25
    v_mad_u32_u24 v8, v23, s29, v25
    v_mad_u32_u24 v10, v26, s29, v25
    v_add_u32 v9, s68, v8
    v_lshl_add_u32 v10, s68, 1, v10
    v_add_u32 v11, s68, v10
    s_mov_b32 s10, 2097152
    s_mov_b32 s11, 0x20000
    s_lshl_b32 s14, s28, 9
    s_mov_b32 s15, 0x20000
    s_cmp_eq_u32 s58, 0
    s_waitcnt lgkmcnt(0)
    s_mov_b32 s8, s36
    s_mov_b32 s9, s37
    s_cselect_b32 s12, s38, s44
    s_cselect_b32 s13, s39, s45
    s_add_u32 m0, s66, 0
    s_bfe_u32 s68, s62, 262144
    s_mul_i32 s68, s68, s74
    buffer_load_dwordx4 v8, s[12:15], s68 offen offset:0  lds
    buffer_load_dwordx4 v9, s[12:15], s68 offen offset:1024  lds
    buffer_load_dwordx4 v10, s[12:15], s68 offen offset:2048  lds
    buffer_load_dwordx4 v11, s[12:15], s68 offen offset:3072  lds
    s_add_u32 m0, s66, 16384
    s_bfe_u32 s68, s62, 262144
    s_lshl_b32 s68, s68, 7
    buffer_load_dwordx4 v4, s[8:11], s68 offen offset:0  lds
    buffer_load_dwordx4 v5, s[8:11], s68 offen offset:1024  lds
    buffer_load_dwordx4 v6, s[8:11], s68 offen offset:2048  lds
    buffer_load_dwordx4 v7, s[8:11], s68 offen offset:3072  lds
    s_add_u32 m0, s66, 32768
    s_bfe_u32 s68, s62, 262148
    s_mul_i32 s68, s68, s74
    buffer_load_dwordx4 v8, s[12:15], s68 offen offset:0  lds
    buffer_load_dwordx4 v9, s[12:15], s68 offen offset:1024  lds
    buffer_load_dwordx4 v10, s[12:15], s68 offen offset:2048  lds
    buffer_load_dwordx4 v11, s[12:15], s68 offen offset:3072  lds
    s_load_dword s64, s[54:55], 983040
    s_mov_b32 s63, 0x75643120
    s_cmp_eq_u32 s65, 1
    s_cselect_b32 s63, 0x67542310, s63
    s_cmp_eq_u32 s65, 2
    s_cselect_b32 s63, 0x76534201, s63
    s_cmp_eq_u32 s65, 3
    s_cselect_b32 s63, 0x76453201, s63
    s_mov_b32 s78, 0xedcb9a8
    s_cmp_eq_u32 s65, 1
    s_cselect_b32 s78, 0xecdba98, s78
    s_cmp_eq_u32 s65, 2
    s_cselect_b32 s78, 0xdebca89, s78
    s_cmp_eq_u32 s65, 3
    s_cselect_b32 s78, 0xedbca89, s78
    s_and_b32 s67, s57, 1
    s_mul_i32 s67, s67, 0x11111111
    s_xor_b32 s63, s63, s67
    s_mov_b32 s65, 0x400000
    s_and_b32 s71, s69, 1
    s_sub_u32 s28, 5824, s28
    s_lshl_b32 s30, s59, 7
    s_cmp_eq_u32 s58, 0
    s_cselect_b32 s67, 2048, 0
    s_cselect_b32 s4, s44, s38
    s_cselect_b32 s5, s45, s39
    s_add_u32 s30, s30, s67
    s_lshl_b32 s6, s28, 9
    s_mov_b32 s7, 0x20000
    s_lshl_b32 s75, s28, 6
    s_lshl_b32 s31, s28, 2
    s_sub_u32 s31, s31, 1024
    v_add_u32 v25, s30, v24
    v_cmp_le_u32 vcc, s28, v25
    v_mad_u32_u24 v12, v22, s28, v25
    v_mov_b32 v25, 0x80000000
    v_cndmask_b32 v12, v12, v25, vcc
    v_lshl_add_u32 v13, s31, 1, v12
    v_lshlrev_b32 v32, 2, v23
    v_lshlrev_b32 v33, 2, v26
    v_lshl_add_u32 v25, v22, 10, v24
    s_lshl_b32 s67, s61, 7
    v_add_u32 v25, s67, v25
    v_lshl_add_u32 v16, v23, 16, v25
    v_lshl_add_u32 v17, v26, 16, v25
    v_add_u32 v18, 6144, v16
    v_add_u32 v19, 9216, v17
    v_add_u32 v17, 3072, v17
    s_lshr_b32 s67, s69, 1
    s_lshl1_add_u32 s67, s60, s67
    s_and_b32 s68, s61, 1
    s_mul_i32 s76, s67, 2
    s_add_u32 s68, s68, s76
    s_mul_i32 s68, s68, 384
    s_add_u32 s68, s68, 131072
    s_mov_b32 s76, 0
    s_add_u32 s72, s54, s68
    s_addc_u32 s73, s55, 0
    s_mul_i32 s67, s67, 122880
    s_lshl_b32 s68, s71, 12
    s_add_u32 s67, s67, s68
    s_add_u32 s67, s67, 1048576
    v_lshlrev_b32 v20, 4, v1
    v_add_u32 v20, s67, v20
    s_mov_b32 s16, s46
    s_mov_b32 s17, s47
    s_mov_b32 s18, 1409024
    s_mov_b32 s19, 0x20000
    s_mov_b32 s20, s40
    s_mov_b32 s21, s41
    s_mov_b32 s22, 524288
    s_mov_b32 s23, 0x20000
    s_mov_b32 s24, s54
    s_mov_b32 s25, s55
    s_mov_b32 s26, 8912896
    s_mov_b32 s27, 0x20000
    s_lshl2_add_u32 s67, s59, s69
    s_mul_i32 s79, s67, 1152
    s_add_u32 s79, s79, 16384
    s_mul_i32 s70, s67, 2
    s_and_b32 s68, s57, 1
    s_add_u32 s70, s70, s68
    s_mul_i32 s70, s70, 384
    s_add_u32 s70, s70, 393216
    v_lshl_add_u32 v52, v1, 4, s66
    v_lshlrev_b32 v40, 2, v1
    v_and_b32 v41, 60, v40
    v_lshlrev_b32 v42, 4, v1
    s_lshl_b32 s67, s69, 6
    s_add_u32 s67, s67, 147456
    v_lshrrev_b32 v43, 4, v1
    v_lshl_add_u32 v43, v43, 8, v41
    v_add_u32 v43, s67, v43
    v_mul_u32_u24 v55, 384, v1
    s_lshl4_add_u32 s3, s59, s57
    s_lshl2_add_u32 s3, s3, s69
    s_mul_i32 s3, s3, 384
    s_add_u32 s3, s3, 655360
    s_mov_b32 s32, s48
    s_mov_b32 s33, s49
    s_mov_b32 s34, 1024
    s_mov_b32 s35, 0x20000
    v_lshlrev_b32 v25, 2, v21
    v_bfe_u32 v25, s62, v25, 4
    v_and_b32 v34, 7, v1
    v_lshl_add_u32 v25, v25, 3, v34
    v_lshlrev_b32 v25, 4, v25
    s_add_u32 m0, s66, 49152
    s_bfe_u32 s68, s62, 262148
    s_lshl_b32 s68, s68, 7
    buffer_load_dwordx4 v4, s[8:11], s68 offen offset:0  lds
    buffer_load_dwordx4 v5, s[8:11], s68 offen offset:1024  lds
    buffer_load_dwordx4 v6, s[8:11], s68 offen offset:2048  lds
    buffer_load_dwordx4 v7, s[8:11], s68 offen offset:3072  lds
    s_waitcnt lgkmcnt(0)
    s_mul_i32 s64, s64, 1664525
    s_add_u32 s64, s64, 1013904223
    v_mov_b32 v54, s64
    s_cmp_eq_u32 s58, 1
    s_cselect_b32 s67, s3, 0x40000000
    v_and_b32 v53, 124, v40
    buffer_store_dword v54, v53, s[24:27], s67 offen sc1
    s_load_dwordx2 s[52:53], s[72:73], 60 glc
    s_add_u32 s67, s70, 60
    s_load_dwordx2 s[52:53], s[54:55], s67 glc
    s_waitcnt vmcnt(9)
    s_barrier
    s_add_u32 m0, s66, 65536
    s_bfe_u32 s68, s62, 262152
    s_lshl_b32 s68, s68, 7
    buffer_load_dwordx4 v4, s[8:11], s68 offen offset:0  lds
    buffer_load_dwordx4 v5, s[8:11], s68 offen offset:1024  lds
    buffer_load_dwordx4 v6, s[8:11], s68 offen offset:2048  lds
    buffer_load_dwordx4 v7, s[8:11], s68 offen offset:3072  lds
    s_add_u32 m0, s66, 81920
    s_bfe_u32 s68, s62, 262152
    s_mul_i32 s68, s68, s74
    buffer_load_dwordx4 v8, s[12:15], s68 offen offset:0  lds
    buffer_load_dwordx4 v9, s[12:15], s68 offen offset:1024  lds
    buffer_load_dwordx4 v10, s[12:15], s68 offen offset:2048  lds
    buffer_load_dwordx4 v11, s[12:15], s68 offen offset:3072  lds
    s_and_b32 s67, s69, 1
    s_lshl1_add_u32 s67, s2, s67
    s_mul_i32 s68, s67, 2752
    s_add_u32 s68, s68, 1728
    s_mul_i32 s67, s67, 3072
    s_cmp_lt_u32 s69, 2
    s_cselect_b32 s67, s67, s68
    s_cselect_b32 s0, s38, s44
    s_cselect_b32 s1, s39, s45
    s_add_u32 s0, s0, s67
    s_addc_u32 s1, s1, 0
    s_load_dwordx2 s[52:53], s[0:1], 956
    s_load_dwordx2 s[52:53], s[0:1], 828
    s_load_dwordx2 s[52:53], s[0:1], 700
    s_load_dwordx2 s[52:53], s[0:1], 572
    s_load_dwordx2 s[52:53], s[0:1], 444
    s_load_dwordx2 s[52:53], s[0:1], 316
    s_waitcnt vmcnt(9)
    s_barrier
    s_add_u32 m0, s66, 98304
    s_bfe_u32 s68, s62, 262156
    s_lshl_b32 s68, s68, 7
    buffer_load_dwordx4 v4, s[8:11], s68 offen offset:0  lds
    buffer_load_dwordx4 v5, s[8:11], s68 offen offset:1024  lds
    buffer_load_dwordx4 v6, s[8:11], s68 offen offset:2048  lds
    buffer_load_dwordx4 v7, s[8:11], s68 offen offset:3072  lds
    s_add_u32 m0, s66, 114688
    s_bfe_u32 s68, s62, 262156
    s_mul_i32 s68, s68, s74
    buffer_load_dwordx4 v8, s[12:15], s68 offen offset:0  lds
    buffer_load_dwordx4 v9, s[12:15], s68 offen offset:1024  lds
    buffer_load_dwordx4 v10, s[12:15], s68 offen offset:2048  lds
    buffer_load_dwordx4 v11, s[12:15], s68 offen offset:3072  lds
    s_load_dwordx2 s[52:53], s[0:1], 188
    s_load_dwordx2 s[52:53], s[0:1], 60
    s_mul_i32 s67, s69, 11
    s_min_u32 s67, s67, 31
    s_mul_i32 s68, s2, 43
    s_add_u32 s67, s67, s68
    s_lshl_b32 s67, s67, 7
    s_add_u32 s0, s46, s67
    s_addc_u32 s1, s47, 0
    s_load_dwordx2 s[52:53], s[0:1], 60
    s_load_dwordx2 s[52:53], s[0:1], 188
    s_load_dwordx2 s[52:53], s[0:1], 316
    s_load_dwordx2 s[52:53], s[0:1], 444
    s_waitcnt vmcnt(8)
    s_barrier
    s_add_u32 m0, s66, 131072
    s_bfe_u32 s68, s62, 262160
    s_lshl_b32 s68, s68, 7
    buffer_load_dwordx4 v4, s[8:11], s68 offen offset:0  lds
    buffer_load_dwordx4 v5, s[8:11], s68 offen offset:1024  lds
    buffer_load_dwordx4 v6, s[8:11], s68 offen offset:2048  lds
    buffer_load_dwordx4 v7, s[8:11], s68 offen offset:3072  lds
    s_add_u32 m0, s66, 16384
    s_bfe_u32 s68, s62, 262160
    s_mul_i32 s68, s68, s74
    buffer_load_dwordx4 v8, s[12:15], s68 offen offset:0  lds
    buffer_load_dwordx4 v9, s[12:15], s68 offen offset:1024  lds
    buffer_load_dwordx4 v10, s[12:15], s68 offen offset:2048  lds
    buffer_load_dwordx4 v11, s[12:15], s68 offen offset:3072  lds
    s_load_dwordx2 s[52:53], s[0:1], 572
    s_load_dwordx2 s[52:53], s[0:1], 700
    s_load_dwordx2 s[52:53], s[0:1], 828
    s_load_dwordx2 s[52:53], s[0:1], 956
    s_load_dwordx2 s[52:53], s[0:1], 1084
    s_load_dwordx2 s[52:53], s[0:1], 1212
    s_waitcnt vmcnt(8)
    s_barrier
    s_add_u32 m0, s66, 0
    s_bfe_u32 s68, s62, 262164
    s_lshl_b32 s68, s68, 7
    buffer_load_dwordx4 v4, s[8:11], s68 offen offset:0  lds
    buffer_load_dwordx4 v5, s[8:11], s68 offen offset:1024  lds
    buffer_load_dwordx4 v6, s[8:11], s68 offen offset:2048  lds
    buffer_load_dwordx4 v7, s[8:11], s68 offen offset:3072  lds
    s_add_u32 m0, s66, 49152
    s_bfe_u32 s68, s62, 262164
    s_mul_i32 s68, s68, s74
    buffer_load_dwordx4 v8, s[12:15], s68 offen offset:0  lds
    buffer_load_dwordx4 v9, s[12:15], s68 offen offset:1024  lds
    buffer_load_dwordx4 v10, s[12:15], s68 offen offset:2048  lds
    buffer_load_dwordx4 v11, s[12:15], s68 offen offset:3072  lds
    s_load_dwordx2 s[52:53], s[0:1], 1340
    s_load_dwordx2 s[52:53], s[0:1], 1468
    s_lshl2_add_u32 s67, s2, s69
    s_lshl_b32 s67, s67, 9
    s_add_u32 s0, s40, s67
    s_addc_u32 s1, s41, 0
    s_load_dwordx2 s[52:53], s[0:1], 60
    s_load_dwordx2 s[52:53], s[0:1], 188
    s_load_dwordx2 s[52:53], s[0:1], 316
    s_load_dwordx2 s[52:53], s[0:1], 444
    s_mov_b32 m0, 148480
    s_nop 0
    buffer_load_dwordx4 v25, s[32:35], 0 offen lds
    s_waitcnt vmcnt(9)
    s_barrier
    s_add_u32 m0, s66, 32768
    s_bfe_u32 s68, s62, 262168
    s_lshl_b32 s68, s68, 7
    buffer_load_dwordx4 v4, s[8:11], s68 offen offset:0  lds
    buffer_load_dwordx4 v5, s[8:11], s68 offen offset:1024  lds
    buffer_load_dwordx4 v6, s[8:11], s68 offen offset:2048  lds
    buffer_load_dwordx4 v7, s[8:11], s68 offen offset:3072  lds
    s_add_u32 m0, s66, 65536
    s_bfe_u32 s68, s62, 262168
    s_mul_i32 s68, s68, s74
    buffer_load_dwordx4 v8, s[12:15], s68 offen offset:0  lds
    buffer_load_dwordx4 v9, s[12:15], s68 offen offset:1024  lds
    buffer_load_dwordx4 v10, s[12:15], s68 offen offset:2048  lds
    buffer_load_dwordx4 v11, s[12:15], s68 offen offset:3072  lds
    s_waitcnt vmcnt(9)
    s_barrier
    s_add_u32 m0, s66, 81920
    s_bfe_u32 s68, s62, 262172
    s_lshl_b32 s68, s68, 7
    buffer_load_dwordx4 v4, s[8:11], s68 offen offset:0  lds
    buffer_load_dwordx4 v5, s[8:11], s68 offen offset:1024  lds
    buffer_load_dwordx4 v6, s[8:11], s68 offen offset:2048  lds
    buffer_load_dwordx4 v7, s[8:11], s68 offen offset:3072  lds
    s_add_u32 m0, s66, 98304
    s_bfe_u32 s68, s62, 262172
    s_mul_i32 s68, s68, s74
    buffer_load_dwordx4 v8, s[12:15], s68 offen offset:0  lds
    buffer_load_dwordx4 v9, s[12:15], s68 offen offset:1024  lds
    buffer_load_dwordx4 v10, s[12:15], s68 offen offset:2048  lds
    buffer_load_dwordx4 v11, s[12:15], s68 offen offset:3072  lds
    s_cmp_eq_u32 s58, 0
    s_cbranch_scc0 L_load1
    s_branch L_load0
L_consumer:
    s_cmp_lg_u32 s56, 0
    s_cbranch_scc1 CT_gated__1
    s_getpc_b64 s[4:5]
L_pc:
    s_sub_u32 s4, s4, L_pc-gated_mix__linear_attn_block__dense_activation_relu__prompt_kernel
    s_subb_u32 s5, s5, 0
    v_and_b32 v2, 15, v1
    s_lshl_b32 s67, s68, 4
    v_add_u32 v2, s67, v2
    v_lshlrev_b32 v2, 7, v2
    v_min_u32 v2, L_end-gated_mix__linear_attn_block__dense_activation_relu__prompt_kernel, v2
    global_load_dword v20, v2, s[4:5]
CT_gated__1:
    s_waitcnt lgkmcnt(0)
    s_load_dword s64, s[54:55], 983040
    s_mov_b32 s24, s54
    s_mov_b32 s25, s55
    s_mov_b32 s26, 8912896
    s_mov_b32 s27, 0x20000
    s_lshl4_add_u32 s67, s58, s57
    s_cmp_lg_u32 s67, s59
    s_cbranch_scc1 ZI_gated__2
    s_lshl2_add_u32 s69, s59, s56
    s_mul_i32 s67, s69, 1152
    s_add_u32 s67, s67, 16384
    v_mov_b32 v44, 0
    v_mov_b32 v45, 0
    v_mov_b32 v46, 0
    v_mov_b32 v47, 0
    v_lshlrev_b32 v16, 4, v1
    buffer_store_dwordx4 v[44:47], v16, s[24:27], s67 offen sc1
    buffer_store_dwordx4 v[44:47], v16, s[24:27], s67 offen offset:128 sc1
ZI_gated__2:
    s_lshl2_add_u32 s67, s58, s56
    s_cmp_eq_u32 s67, 1
    s_cbranch_scc1 L_iw1
    s_cmp_eq_u32 s67, 2
    s_cbranch_scc1 L_iw2
    s_cmp_eq_u32 s67, 3
    s_cbranch_scc1 L_iw3
    s_cmp_eq_u32 s67, 4
    s_cbranch_scc1 L_iw4
    s_cmp_eq_u32 s67, 5
    s_cbranch_scc1 L_iw5
    s_cmp_eq_u32 s67, 6
    s_cbranch_scc1 L_iw6
    s_cmp_eq_u32 s67, 7
    s_cbranch_scc1 L_iw7
L_iw0:
    s_call_b64 s[6:7], L_pg3
    s_call_b64 s[6:7], L_st_load0
    s_call_b64 s[6:7], L_pg1
    s_branch L_iwx
L_iw1:
    s_call_b64 s[6:7], L_pg4
    s_call_b64 s[6:7], L_st_skip
    s_branch L_iwx
L_iw2:
    s_call_b64 s[6:7], L_pg5
    s_call_b64 s[6:7], L_st_join
    s_branch L_iwx
L_iw3:
    s_call_b64 s[6:7], L_pg6
    s_call_b64 s[6:7], L_st_poll
    s_branch L_iwx
L_iw4:
    s_call_b64 s[6:7], L_pg7
    s_call_b64 s[6:7], L_st_poll
    s_branch L_iwx
L_iw5:
    s_call_b64 s[6:7], L_pg8
    s_call_b64 s[6:7], L_pg2
    s_branch L_iwx
L_iw6:
    s_call_b64 s[6:7], L_pg9
    s_branch L_iwx
L_iw7:
    s_call_b64 s[6:7], L_st_load1
    s_branch L_iwx
    s_nop 0
    s_nop 0
    s_nop 0
    s_nop 0
    s_nop 0
    s_nop 0
L_iwx:
    s_setprio 2
    v_and_b32 v16, 15, v1
    v_lshrrev_b32 v17, 4, v1
    v_bfe_u32 v2, v1, 1, 3
    v_xor_b32 v2, v2, v17
    v_lshlrev_b32 v2, 4, v2
    v_lshl_add_u32 v2, v16, 7, v2
    s_lshl_b32 s67, s56, 12
    v_add_u32 v2, s67, v2
    v_xor_b32 v3, 64, v2
    v_bfe_u32 v18, v1, 2, 3
    v_and_b32 v14, 3, v1
    v_lshlrev_b32 v14, 3, v14
    v_lshl_add_u32 v14, v18, 5, v14
    v_bfe_u32 v18, v1, 2, 2
    v_lshl_add_u32 v14, v18, 8, v14
    v_lshl_add_u32 v4, v17, 11, v14
    v_xor_b32 v5, 32, v4
    v_xor_b32 v6, 64, v4
    v_xor_b32 v7, 96, v4
    v_xor_b32 v8, 128, v4
    v_xor_b32 v9, 160, v4
    v_xor_b32 v10, 192, v4
    v_xor_b32 v11, 224, v4
    v_lshl_add_u32 v14, v17, 10, v14
    s_and_b32 s67, s56, 1
    s_lshl_b32 s67, s67, 6
    v_xor_b32 v14, s67, v14
    v_mul_u32_u24 v15, 384, v1
    s_lshl2_add_u32 s67, s57, s56
    s_mul_i32 s70, s67, 768
    s_lshl2_add_u32 s70, s59, s70
    s_add_u32 s70, s70, 131072
    s_add_u32 s4, s54, s70
    s_addc_u32 s5, s55, 0
    s_lshl_b32 s77, s67, 7
    s_mul_i32 s67, s67, 122880
    s_add_u32 s67, s67, 1048576
    v_lshl_add_u32 v12, v1, 4, s67
    s_lshl2_add_u32 s69, s59, s56
    s_mul_i32 s79, s69, 1152
    s_add_u32 s79, s79, 16384
    s_mul_i32 s72, s69, 768
    s_add_u32 s72, s72, 393216
    s_lshl2_add_u32 s73, s57, s72
    s_mov_b32 s28, s50
    s_mov_b32 s29, s51
    s_mov_b32 s30, 2097152
    s_mov_b32 s31, 0x20000
    s_mov_b32 s52, 0x3fb8aa3b
    s_mov_b32 s53, 0x3fb8aa3b
    s_mov_b32 s42, 0x358637bd
    s_mov_b32 s68, 1664525
    s_waitcnt lgkmcnt(0)
    s_mul_i32 s64, s64, 1664525
    s_add_u32 s64, s64, 1013904223
    s_waitcnt vmcnt(0)
    s_cmp_eq_u32 s58, 0
    s_cbranch_scc0 L_cons1
    s_cmp_lg_u32 s57, s59
    s_cbranch_scc1 L_cons0
    v_mov_b32 v13, s64
    s_mov_b64 exec, 3
    buffer_store_dword v13, v15, s[24:27], s72 offen offset:64 sc1
    s_mov_b64 exec, -1
    s_branch L_cons0
L_st_poll:
    s_setpc_b64 s[6:7]
L_poll0:
    s_waitcnt lgkmcnt(0)
    s_mov_b32 s67, 0
    s_cmp_eq_u32 s87, s64
    s_addc_u32 s67, s67, s67
    s_cmp_eq_u32 s86, s64
    s_addc_u32 s67, s67, s67
    s_cmp_eq_u32 s85, s64
    s_addc_u32 s67, s67, s67
    s_cmp_eq_u32 s84, s64
    s_addc_u32 s67, s67, s67
    s_cmp_eq_u32 s83, s64
    s_addc_u32 s67, s67, s67
    s_cmp_eq_u32 s82, s64
    s_addc_u32 s67, s67, s67
    s_cmp_eq_u32 s81, s64
    s_addc_u32 s67, s67, s67
    s_cmp_eq_u32 s80, s64
    s_addc_u32 s67, s67, s67
    s_cmp_eq_u32 s67, 0xff
    s_cbranch_scc1 FE_gated__5
    s_load_dwordx8 s[80:87], s[72:73], 0 glc
FE_gated__5:
    s_lshl_b32 s67, s67, 0
    s_or_b32 s76, s76, s67
    s_bitcmp1_b32 s76, s77
    s_cbranch_scc1 FD_gated__4
    s_sub_u32 s65, s65, 1
    s_cbranch_scc0 L_poll0
    s_mov_b32 s65, 0
FD_gated__4:
    s_setpc_b64 s[32:33]
L_poll1:
    s_waitcnt lgkmcnt(0)
    s_mov_b32 s67, 0
    s_cmp_eq_u32 s95, s64
    s_addc_u32 s67, s67, s67
    s_cmp_eq_u32 s94, s64
    s_addc_u32 s67, s67, s67
    s_cmp_eq_u32 s93, s64
    s_addc_u32 s67, s67, s67
    s_cmp_eq_u32 s92, s64
    s_addc_u32 s67, s67, s67
    s_cmp_eq_u32 s91, s64
    s_addc_u32 s67, s67, s67
    s_cmp_eq_u32 s90, s64
    s_addc_u32 s67, s67, s67
    s_cmp_eq_u32 s89, s64
    s_addc_u32 s67, s67, s67
    s_cmp_eq_u32 s88, s64
    s_addc_u32 s67, s67, s67
    s_cmp_eq_u32 s67, 0xff
    s_cbranch_scc1 FE_gated__7
    s_load_dwordx8 s[88:95], s[72:73], 32 glc
FE_gated__7:
    s_lshl_b32 s67, s67, 8
    s_or_b32 s76, s76, s67
    s_bitcmp1_b32 s76, s77
    s_cbranch_scc1 FD_gated__6
    s_sub_u32 s65, s65, 1
    s_cbranch_scc0 L_poll1
    s_mov_b32 s65, 0
FD_gated__6:
    s_setpc_b64 s[32:33]
L_poll2:
    s_waitcnt lgkmcnt(0)
    s_mov_b32 s67, 0
    s_cmp_eq_u32 s51, s64
    s_addc_u32 s67, s67, s67
    s_cmp_eq_u32 s50, s64
    s_addc_u32 s67, s67, s67
    s_cmp_eq_u32 s49, s64
    s_addc_u32 s67, s67, s67
    s_cmp_eq_u32 s48, s64
    s_addc_u32 s67, s67, s67
    s_cmp_eq_u32 s47, s64
    s_addc_u32 s67, s67, s67
    s_cmp_eq_u32 s46, s64
    s_addc_u32 s67, s67, s67
    s_cmp_eq_u32 s45, s64
    s_addc_u32 s67, s67, s67
    s_cmp_eq_u32 s44, s64
    s_addc_u32 s67, s67, s67
    s_cmp_eq_u32 s67, 0xff
    s_cbranch_scc1 FE_gated__9
    s_load_dwordx8 s[44:51], s[72:73], 64 glc
FE_gated__9:
    s_lshl_b32 s67, s67, 16
    s_or_b32 s76, s76, s67
    s_bitcmp1_b32 s76, s77
    s_cbranch_scc1 FD_gated__8
    s_sub_u32 s65, s65, 1
    s_cbranch_scc0 L_poll2
    s_mov_b32 s65, 0
FD_gated__8:
    s_setpc_b64 s[32:33]
L_st_load0:
    s_setpc_b64 s[6:7]
L_load0:
    s_waitcnt vmcnt(8)
    s_barrier
    s_lshl2_add_u32 s67, s57, s69
    s_mul_i32 s67, s67, 768
    s_lshl2_add_u32 s67, s59, s67
    s_add_u32 s67, s67, 131072
    s_add_u32 s8, s54, s67
    s_addc_u32 s9, s55, 0
    s_load_dword s10, s[8:9], 32
    s_load_dword s11, s[8:9], 416
    s_add_u32 m0, s66, 114688
    s_lshr_b32 s68, s62, 0
    v_bfe_u32 v34, s68, v32, 4
    v_bfe_u32 v35, s68, v33, 4
    v_mad_u32_u24 v36, v34, s75, v12
    v_mad_u32_u24 v38, v35, s75, v13
    v_add_u32 v37, s31, v36
    v_add_u32 v39, s31, v38
    buffer_load_dwordx4 v36, s[4:7], 0 offen offset:0  lds
    buffer_load_dwordx4 v37, s[4:7], 0 offen offset:1024  lds
    buffer_load_dwordx4 v38, s[4:7], 0 offen offset:2048  lds
    buffer_load_dwordx4 v39, s[4:7], 0 offen offset:3072  lds
    s_add_u32 m0, s66, 131072
    s_lshr_b32 s68, s62, 8
    v_bfe_u32 v34, s68, v32, 4
    v_bfe_u32 v35, s68, v33, 4
    v_mad_u32_u24 v36, v34, s75, v12
    v_mad_u32_u24 v38, v35, s75, v13
    v_add_u32 v37, s31, v36
    v_add_u32 v39, s31, v38
    buffer_load_dwordx4 v36, s[4:7], 0 offen offset:0  lds
    buffer_load_dwordx4 v37, s[4:7], 0 offen offset:1024  lds
    buffer_load_dwordx4 v38, s[4:7], 0 offen offset:2048  lds
    buffer_load_dwordx4 v39, s[4:7], 0 offen offset:3072  lds
    s_waitcnt vmcnt(8)
    s_barrier
    s_add_u32 m0, s66, 16384
    s_lshr_b32 s68, s62, 16
    v_bfe_u32 v34, s68, v32, 4
    v_bfe_u32 v35, s68, v33, 4
    v_mad_u32_u24 v36, v34, s75, v12
    v_mad_u32_u24 v38, v35, s75, v13
    v_add_u32 v37, s31, v36
    v_add_u32 v39, s31, v38
    buffer_load_dwordx4 v36, s[4:7], 0 offen offset:0  lds
    buffer_load_dwordx4 v37, s[4:7], 0 offen offset:1024  lds
    buffer_load_dwordx4 v38, s[4:7], 0 offen offset:2048  lds
    buffer_load_dwordx4 v39, s[4:7], 0 offen offset:3072  lds
    s_lshr_b32 s67, s2, 3
    s_lshl2_add_u32 s67, s67, s69
    s_add_u32 s68, s67, 0
    s_lshl_b32 s68, s68, 10
    s_add_u32 s68, s68, 444
    s_load_dwordx2 s[52:53], s[16:17], s68
    s_add_u32 s68, s67, 128
    s_lshl_b32 s68, s68, 10
    s_add_u32 s68, s68, 444
    s_load_dwordx2 s[52:53], s[16:17], s68
    s_add_u32 s68, s67, 256
    s_lshl_b32 s68, s68, 10
    s_add_u32 s68, s68, 444
    s_load_dwordx2 s[52:53], s[16:17], s68
    s_add_u32 s70, s70, 64
    s_load_dword s77, s[54:55], s70 glc
    s_load_dword s80, s[54:55], s3 glc
    s_barrier
ZW_gated__10:
    s_waitcnt lgkmcnt(0)
    s_xor_b32 s77, s77, s64
    s_xor_b32 s80, s80, s64
    s_or_b32 s80, s80, s77
    s_cbranch_scc0 ZD_gated__11
    s_load_dword s77, s[54:55], s70 glc
    s_load_dword s80, s[54:55], s3 glc
    s_sub_u32 s65, s65, 1
    s_cbranch_scc0 ZW_gated__10
    s_mov_b32 s65, 0
    s_waitcnt lgkmcnt(0)
ZD_gated__11:
    s_sub_u32 s10, s64, s10
    s_sub_u32 s11, s64, s11
    s_add_u32 m0, s66, 49152
    s_lshr_b32 s68, s62, 24
    v_bfe_u32 v34, s68, v32, 4
    v_bfe_u32 v35, s68, v33, 4
    v_mad_u32_u24 v36, v34, s75, v12
    v_mad_u32_u24 v38, v35, s75, v13
    v_add_u32 v37, s31, v36
    v_add_u32 v39, s31, v38
    buffer_load_dwordx4 v36, s[4:7], 0 offen offset:0  lds
    buffer_load_dwordx4 v37, s[4:7], 0 offen offset:1024  lds
    buffer_load_dwordx4 v38, s[4:7], 0 offen offset:2048  lds
    buffer_load_dwordx4 v39, s[4:7], 0 offen offset:3072  lds
    s_add_u32 m0, s66, 32768
    s_bfe_u32 s68, s63, 262144
    s_lshl_b32 s68, s68, 17
    buffer_load_dwordx4 v16, s[16:19], s68 offen offset:0  lds
    buffer_load_dwordx4 v17, s[16:19], s68 offen offset:1024  lds
    buffer_load_dwordx4 v18, s[16:19], s68 offen offset:2048  lds
    buffer_load_dwordx4 v19, s[16:19], s68 offen offset:3072  lds
    s_lshr_b32 s67, s2, 3
    s_lshl2_add_u32 s67, s67, s69
    s_add_u32 s68, s67, 384
    s_lshl_b32 s68, s68, 10
    s_add_u32 s68, s68, 444
    s_load_dwordx2 s[52:53], s[16:17], s68
    s_add_u32 s68, s67, 512
    s_lshl_b32 s68, s68, 10
    s_add_u32 s68, s68, 444
    s_branch L_pg1x
L_pg1:
    s_setpc_b64 s[6:7]
L_pg1x:
    s_load_dwordx2 s[52:53], s[16:17], s68
    s_add_u32 s68, s67, 640
    s_lshl_b32 s68, s68, 10
    s_add_u32 s68, s68, 444
    s_load_dwordx2 s[52:53], s[16:17], s68
    s_add_u32 s68, s67, 768
    s_lshl_b32 s68, s68, 10
    s_add_u32 s68, s68, 444
    s_load_dwordx2 s[52:53], s[16:17], s68
    s_add_u32 s68, s67, 896
    s_lshl_b32 s68, s68, 10
    s_add_u32 s68, s68, 444
    s_load_dwordx2 s[52:53], s[16:17], s68
    s_waitcnt vmcnt(8)
    s_barrier
    s_setprio 3
    v_add_u32 v53, 0, v52
    ds_read_b128 v[64:67], v53 offset:0
    ds_read_b128 v[68:71], v53 offset:1024
    ds_read_b128 v[72:75], v53 offset:2048
    ds_read_b128 v[76:79], v53 offset:3072
    ds_read_b32 v80, v43
    s_waitcnt lgkmcnt(0)
    v_add_f32 v64, v64, v68
    v_add_f32 v72, v72, v76
    v_add_f32 v65, v65, v69
    v_add_f32 v73, v73, v77
    v_add_f32 v66, v66, v70
    v_add_f32 v74, v74, v78
    v_add_f32 v67, v67, v71
    v_add_f32 v75, v75, v79
    v_mov_b32 v81, v80
    v_add_f32 v64, v64, v72
    v_add_f32 v65, v65, v73
    v_add_f32 v66, v66, v74
    v_add_f32 v67, v67, v75
    v_permlane16_swap_b32 v80, v81
    v_add_f32 v80, v80, v81
    v_mov_b32 v81, v80
    s_nop 1
    v_permlane32_swap_b32 v80, v81
    v_add_f32 v80, v80, v81
    s_setprio 0
    buffer_atomic_add_f32 v64, v40, s[24:27], s79 offen offset:0
    buffer_atomic_add_f32 v65, v40, s[24:27], s79 offen offset:256
    buffer_atomic_add_f32 v66, v40, s[24:27], s79 offen offset:512
    buffer_atomic_add_f32 v67, v40, s[24:27], s79 offen offset:768
    s_mov_b64 exec, 0xffff
    buffer_atomic_add_f32 v80, v40, s[24:27], s79 offen offset:1024
    s_mov_b64 exec, -1
    s_add_u32 m0, s66, 65536
    s_bfe_u32 s68, s63, 262148
    s_lshl_b32 s68, s68, 17
    buffer_load_dwordx4 v16, s[16:19], s68 offen offset:0  lds
    buffer_load_dwordx4 v17, s[16:19], s68 offen offset:1024  lds
    buffer_load_dwordx4 v18, s[16:19], s68 offen offset:2048  lds
    buffer_load_dwordx4 v19, s[16:19], s68 offen offset:3072  lds
    s_add_u32 m0, s66, 81920
    s_bfe_u32 s68, s63, 262152
    s_lshl_b32 s68, s68, 17
    buffer_load_dwordx4 v16, s[16:19], s68 offen offset:0  lds
    buffer_load_dwordx4 v17, s[16:19], s68 offen offset:1024  lds
    buffer_load_dwordx4 v18, s[16:19], s68 offen offset:2048  lds
    buffer_load_dwordx4 v19, s[16:19], s68 offen offset:3072  lds
    s_lshl2_add_u32 s67, s59, s69
    s_mul_i32 s67, s67, 768
    s_lshl2_add_u32 s67, s57, s67
    s_add_u32 s67, s67, 393216
    v_mov_b32 v54, s64
    s_waitcnt vmcnt(8)
    s_mov_b64 exec, 3
    buffer_store_dword v54, v55, s[24:27], s67 offen sc1
    s_mov_b64 exec, -1
    s_add_u32 m0, s66, 98304
    s_bfe_u32 s68, s63, 262156
    s_lshl_b32 s68, s68, 17
    buffer_load_dwordx4 v16, s[16:19], s68 offen offset:0  lds
    buffer_load_dwordx4 v17, s[16:19], s68 offen offset:1024  lds
    buffer_load_dwordx4 v18, s[16:19], s68 offen offset:2048  lds
    buffer_load_dwordx4 v19, s[16:19], s68 offen offset:3072  lds
    s_add_u32 m0, s66, 0
    s_bfe_u32 s68, s63, 262160
    s_lshl_b32 s68, s68, 17
    buffer_load_dwordx4 v16, s[16:19], s68 offen offset:0  lds
    buffer_load_dwordx4 v17, s[16:19], s68 offen offset:1024  lds
    buffer_load_dwordx4 v18, s[16:19], s68 offen offset:2048  lds
    buffer_load_dwordx4 v19, s[16:19], s68 offen offset:3072  lds
    s_load_dwordx8 s[80:87], s[72:73], 0 glc
    s_waitcnt vmcnt(26)
    s_barrier
    s_add_u32 m0, s66, 114688
    s_bfe_u32 s68, s63, 262164
    s_lshl_b32 s68, s68, 17
    buffer_load_dwordx4 v16, s[16:19], s68 offen offset:0  lds
    buffer_load_dwordx4 v17, s[16:19], s68 offen offset:1024  lds
    buffer_load_dwordx4 v18, s[16:19], s68 offen offset:2048  lds
    buffer_load_dwordx4 v19, s[16:19], s68 offen offset:3072  lds
    s_bfe_u32 s77, s63, 262144
    s_bitcmp1_b32 s76, s77
    s_cbranch_scc1 FD_gated__12
    s_call_b64 s[32:33], L_poll0
FD_gated__12:
    s_add_u32 m0, s66, 131072
    s_bfe_u32 s68, s63, 262144
    s_lshl_b32 s68, s68, 13
    buffer_load_dwordx4 v20, s[24:27], s68 offen offset:0 sc1 lds
    buffer_load_dwordx4 v20, s[24:27], s68 offen offset:1024 sc1 lds
    buffer_load_dwordx4 v20, s[24:27], s68 offen offset:2048 sc1 lds
    buffer_load_dwordx4 v20, s[24:27], s68 offen offset:3072 sc1 lds
    s_barrier
    s_bfe_u32 s77, s63, 262148
    s_bitcmp1_b32 s76, s77
    s_cbranch_scc1 FD_gated__13
    s_call_b64 s[32:33], L_poll0
FD_gated__13:
    s_add_u32 m0, s66, 16384
    s_bfe_u32 s68, s63, 262148
    s_lshl_b32 s68, s68, 13
    buffer_load_dwordx4 v20, s[24:27], s68 offen offset:0 sc1 lds
    buffer_load_dwordx4 v20, s[24:27], s68 offen offset:1024 sc1 lds
    buffer_load_dwordx4 v20, s[24:27], s68 offen offset:2048 sc1 lds
    buffer_load_dwordx4 v20, s[24:27], s68 offen offset:3072 sc1 lds
    s_bfe_u32 s77, s63, 262152
    s_bitcmp1_b32 s76, s77
    s_cbranch_scc1 FD_gated__14
    s_call_b64 s[32:33], L_poll0
FD_gated__14:
    s_add_u32 m0, s66, 49152
    s_bfe_u32 s68, s63, 262152
    s_lshl_b32 s68, s68, 13
    buffer_load_dwordx4 v20, s[24:27], s68 offen offset:0 sc1 lds
    buffer_load_dwordx4 v20, s[24:27], s68 offen offset:1024 sc1 lds
    buffer_load_dwordx4 v20, s[24:27], s68 offen offset:2048 sc1 lds
    buffer_load_dwordx4 v20, s[24:27], s68 offen offset:3072 sc1 lds
    s_waitcnt vmcnt(8)
    s_barrier
    s_lshr_b32 s67, s2, 3
    s_lshl2_add_u32 s67, s67, s69
    s_add_u32 s68, s67, 1024
    s_lshl_b32 s68, s68, 10
    s_add_u32 s68, s68, 444
    s_load_dwordx2 s[52:53], s[16:17], s68
    s_add_u32 s68, s67, 1152
    s_lshl_b32 s68, s68, 10
    s_add_u32 s68, s68, 444
    s_load_dwordx2 s[52:53], s[16:17], s68
    s_add_u32 s68, s67, 1280
    s_min_u32 s68, s68, 1375
    s_lshl_b32 s68, s68, 10
    s_add_u32 s68, s68, 444
    s_load_dwordx2 s[52:53], s[16:17], s68
    s_add_u32 s68, s67, 0
    s_lshl_b32 s68, s68, 10
    s_add_u32 s68, s68, 444
    s_load_dwordx2 s[52:53], s[20:21], s68
    s_waitcnt vmcnt(4)
    s_barrier
    s_bfe_u32 s77, s63, 262156
    s_bitcmp1_b32 s76, s77
    s_cbranch_scc1 FD_gated__15
    s_call_b64 s[32:33], L_poll0
FD_gated__15:
    s_add_u32 m0, s66, 32768
    s_bfe_u32 s68, s63, 262156
    s_lshl_b32 s68, s68, 13
    buffer_load_dwordx4 v20, s[24:27], s68 offen offset:0 sc1 lds
    buffer_load_dwordx4 v20, s[24:27], s68 offen offset:1024 sc1 lds
    buffer_load_dwordx4 v20, s[24:27], s68 offen offset:2048 sc1 lds
    buffer_load_dwordx4 v20, s[24:27], s68 offen offset:3072 sc1 lds
    s_bfe_u32 s77, s63, 262160
    s_bitcmp1_b32 s76, s77
    s_cbranch_scc1 FD_gated__16
    s_call_b64 s[32:33], L_poll0
FD_gated__16:
    s_add_u32 m0, s66, 131072
    s_bfe_u32 s68, s63, 262160
    s_lshl_b32 s68, s68, 13
    buffer_load_dwordx4 v20, s[24:27], s68 offen offset:0 sc1 lds
    buffer_load_dwordx4 v20, s[24:27], s68 offen offset:1024 sc1 lds
    buffer_load_dwordx4 v20, s[24:27], s68 offen offset:2048 sc1 lds
    buffer_load_dwordx4 v20, s[24:27], s68 offen offset:3072 sc1 lds
    s_waitcnt vmcnt(8)
    s_barrier
    s_atomic_add s10, s[8:9], 32
    s_atomic_add s11, s[8:9], 416
    s_bfe_u32 s77, s63, 262164
    s_bitcmp1_b32 s76, s77
    s_cbranch_scc1 FD_gated__17
    s_call_b64 s[32:33], L_poll0
FD_gated__17:
    s_add_u32 m0, s66, 65536
    s_bfe_u32 s68, s63, 262164
    s_lshl_b32 s68, s68, 13
    buffer_load_dwordx4 v20, s[24:27], s68 offen offset:0 sc1 lds
    buffer_load_dwordx4 v20, s[24:27], s68 offen offset:1024 sc1 lds
    buffer_load_dwordx4 v20, s[24:27], s68 offen offset:2048 sc1 lds
    buffer_load_dwordx4 v20, s[24:27], s68 offen offset:3072 sc1 lds
    s_add_u32 m0, s66, 16384
    s_bfe_u32 s68, s63, 262168
    s_lshl_b32 s68, s68, 17
    buffer_load_dwordx4 v16, s[16:19], s68 offen offset:0  lds
    buffer_load_dwordx4 v17, s[16:19], s68 offen offset:1024  lds
    buffer_load_dwordx4 v18, s[16:19], s68 offen offset:2048  lds
    buffer_load_dwordx4 v19, s[16:19], s68 offen offset:3072  lds
    s_lshr_b32 s67, s2, 3
    s_lshl2_add_u32 s67, s67, s69
    s_add_u32 s68, s67, 128
    s_lshl_b32 s68, s68, 10
    s_add_u32 s68, s68, 444
    s_load_dwordx2 s[52:53], s[20:21], s68
    s_add_u32 s68, s67, 256
    s_lshl_b32 s68, s68, 10
    s_add_u32 s68, s68, 444
    s_load_dwordx2 s[52:53], s[20:21], s68
    s_add_u32 s68, s67, 384
    s_lshl_b32 s68, s68, 10
    s_add_u32 s68, s68, 444
    s_load_dwordx2 s[52:53], s[20:21], s68
    s_waitcnt vmcnt(12)
    s_barrier
    s_bfe_u32 s77, s63, 262168
    s_bitcmp1_b32 s76, s77
    s_cbranch_scc1 FD_gated__18
    s_call_b64 s[32:33], L_poll0
FD_gated__18:
    s_add_u32 m0, s66, 81920
    s_bfe_u32 s68, s63, 262168
    s_lshl_b32 s68, s68, 13
    buffer_load_dwordx4 v20, s[24:27], s68 offen offset:0 sc1 lds
    buffer_load_dwordx4 v20, s[24:27], s68 offen offset:1024 sc1 lds
    buffer_load_dwordx4 v20, s[24:27], s68 offen offset:2048 sc1 lds
    buffer_load_dwordx4 v20, s[24:27], s68 offen offset:3072 sc1 lds
    s_add_u32 m0, s66, 49152
    s_bfe_u32 s68, s63, 262172
    s_lshl_b32 s68, s68, 17
    buffer_load_dwordx4 v16, s[16:19], s68 offen offset:0  lds
    buffer_load_dwordx4 v17, s[16:19], s68 offen offset:1024  lds
    buffer_load_dwordx4 v18, s[16:19], s68 offen offset:2048  lds
    buffer_load_dwordx4 v19, s[16:19], s68 offen offset:3072  lds
    s_waitcnt vmcnt(16)
    s_barrier
    s_load_dwordx8 s[88:95], s[72:73], 32 glc
    s_bfe_u32 s77, s63, 262172
    s_bitcmp1_b32 s76, s77
    s_cbranch_scc1 FD_gated__19
    s_call_b64 s[32:33], L_poll0
FD_gated__19:
    s_add_u32 m0, s66, 98304
    s_bfe_u32 s68, s63, 262172
    s_lshl_b32 s68, s68, 13
    buffer_load_dwordx4 v20, s[24:27], s68 offen offset:0 sc1 lds
    buffer_load_dwordx4 v20, s[24:27], s68 offen offset:1024 sc1 lds
    buffer_load_dwordx4 v20, s[24:27], s68 offen offset:2048 sc1 lds
    buffer_load_dwordx4 v20, s[24:27], s68 offen offset:3072 sc1 lds
    s_add_u32 m0, s66, 32768
    s_bfe_u32 s68, s78, 262144
    s_lshl_b32 s68, s68, 17
    buffer_load_dwordx4 v16, s[16:19], s68 offen offset:0  lds
    buffer_load_dwordx4 v17, s[16:19], s68 offen offset:1024  lds
    buffer_load_dwordx4 v18, s[16:19], s68 offen offset:2048  lds
    buffer_load_dwordx4 v19, s[16:19], s68 offen offset:3072  lds
    s_waitcnt vmcnt(20)
    s_barrier
    s_bfe_u32 s77, s78, 262144
    s_lshl1_add_u32 s77, s77, s71
    s_sub_u32 s77, s77, 8
    s_bitcmp1_b32 s76, s77
    s_cbranch_scc1 FD_gated__20
    s_call_b64 s[32:33], L_poll1
FD_gated__20:
    s_add_u32 m0, s66, 0
    s_bfe_u32 s68, s78, 262144
    s_lshl_b32 s68, s68, 13
    buffer_load_dwordx4 v20, s[24:27], s68 offen offset:0 sc1 lds
    buffer_load_dwordx4 v20, s[24:27], s68 offen offset:1024 sc1 lds
    buffer_load_dwordx4 v20, s[24:27], s68 offen offset:2048 sc1 lds
    buffer_load_dwordx4 v20, s[24:27], s68 offen offset:3072 sc1 lds
    s_add_u32 m0, s66, 131072
    s_bfe_u32 s68, s78, 262148
    s_lshl_b32 s68, s68, 17
    buffer_load_dwordx4 v16, s[16:19], s68 offen offset:0  lds
    buffer_load_dwordx4 v17, s[16:19], s68 offen offset:1024  lds
    buffer_load_dwordx4 v18, s[16:19], s68 offen offset:2048  lds
    buffer_load_dwordx4 v19, s[16:19], s68 offen offset:3072  lds
    s_waitcnt vmcnt(20)
    s_barrier
    s_bfe_u32 s77, s78, 262148
    s_lshl1_add_u32 s77, s77, s71
    s_sub_u32 s77, s77, 8
    s_bitcmp1_b32 s76, s77
    s_cbranch_scc1 FD_gated__21
    s_call_b64 s[32:33], L_poll1
FD_gated__21:
    s_add_u32 m0, s66, 114688
    s_bfe_u32 s68, s78, 262148
    s_lshl_b32 s68, s68, 13
    buffer_load_dwordx4 v20, s[24:27], s68 offen offset:0 sc1 lds
    buffer_load_dwordx4 v20, s[24:27], s68 offen offset:1024 sc1 lds
    buffer_load_dwordx4 v20, s[24:27], s68 offen offset:2048 sc1 lds
    buffer_load_dwordx4 v20, s[24:27], s68 offen offset:3072 sc1 lds
    s_add_u32 m0, s66, 65536
    s_bfe_u32 s68, s78, 262152
    s_lshl_b32 s68, s68, 17
    buffer_load_dwordx4 v16, s[16:19], s68 offen offset:0  lds
    buffer_load_dwordx4 v17, s[16:19], s68 offen offset:1024  lds
    buffer_load_dwordx4 v18, s[16:19], s68 offen offset:2048  lds
    buffer_load_dwordx4 v19, s[16:19], s68 offen offset:3072  lds
    s_waitcnt vmcnt(20)
    s_barrier
    s_bfe_u32 s77, s78, 262152
    s_lshl1_add_u32 s77, s77, s71
    s_sub_u32 s77, s77, 8
    s_bitcmp1_b32 s76, s77
    s_cbranch_scc1 FD_gated__22
    s_call_b64 s[32:33], L_poll1
FD_gated__22:
    s_add_u32 m0, s66, 16384
    s_bfe_u32 s68, s78, 262152
    s_lshl_b32 s68, s68, 13
    buffer_load_dwordx4 v20, s[24:27], s68 offen offset:0 sc1 lds
    buffer_load_dwordx4 v20, s[24:27], s68 offen offset:1024 sc1 lds
    buffer_load_dwordx4 v20, s[24:27], s68 offen offset:2048 sc1 lds
    buffer_load_dwordx4 v20, s[24:27], s68 offen offset:3072 sc1 lds
    s_add_u32 m0, s66, 81920
    s_bfe_u32 s68, s78, 262156
    s_sub_u32 s68, s68, 11
    s_lshl_b32 s68, s68, 17
    buffer_load_dwordx4 v16, s[20:23], s68 offen offset:0  lds
    buffer_load_dwordx4 v17, s[20:23], s68 offen offset:1024  lds
    buffer_load_dwordx4 v18, s[20:23], s68 offen offset:2048  lds
    buffer_load_dwordx4 v19, s[20:23], s68 offen offset:3072  lds
    s_waitcnt vmcnt(20)
    s_barrier
    s_load_dwordx8 s[44:51], s[72:73], 64 glc
    s_add_u32 m0, s66, 49152
    s_bfe_u32 s68, s78, 262160
    s_sub_u32 s68, s68, 11
    s_lshl_b32 s68, s68, 17
    buffer_load_dwordx4 v16, s[20:23], s68 offen offset:0  lds
    buffer_load_dwordx4 v17, s[20:23], s68 offen offset:1024  lds
    buffer_load_dwordx4 v18, s[20:23], s68 offen offset:2048  lds
    buffer_load_dwordx4 v19, s[20:23], s68 offen offset:3072  lds
    s_mov_b32 s77, 14
    s_bitcmp1_b32 s76, s77
    s_cbranch_scc1 FD_gated__23
    s_call_b64 s[32:33], L_poll1
FD_gated__23:
    s_waitcnt vmcnt(16)
    s_barrier
    s_bfe_u32 s77, s78, 262156
    s_lshl1_add_u32 s77, s77, s71
    s_sub_u32 s77, s77, 6
    s_bitcmp1_b32 s76, s77
    s_cbranch_scc1 FD_gated__24
    s_call_b64 s[32:33], L_poll2
FD_gated__24:
    s_add_u32 m0, s66, 98304
    s_bfe_u32 s68, s78, 262156
    s_lshl_b32 s68, s68, 13
    buffer_load_dwordx4 v20, s[24:27], s68 offen offset:0 sc1 lds
    buffer_load_dwordx4 v20, s[24:27], s68 offen offset:1024 sc1 lds
    buffer_load_dwordx4 v20, s[24:27], s68 offen offset:2048 sc1 lds
    buffer_load_dwordx4 v20, s[24:27], s68 offen offset:3072 sc1 lds
    s_add_u32 m0, s66, 32768
    s_bfe_u32 s68, s78, 262164
    s_sub_u32 s68, s68, 11
    s_lshl_b32 s68, s68, 17
    buffer_load_dwordx4 v16, s[20:23], s68 offen offset:0  lds
    buffer_load_dwordx4 v17, s[20:23], s68 offen offset:1024  lds
    buffer_load_dwordx4 v18, s[20:23], s68 offen offset:2048  lds
    buffer_load_dwordx4 v19, s[20:23], s68 offen offset:3072  lds
    s_bfe_u32 s77, s78, 262160
    s_lshl1_add_u32 s77, s77, s71
    s_sub_u32 s77, s77, 6
    s_bitcmp1_b32 s76, s77
    s_cbranch_scc1 FD_gated__25
    s_call_b64 s[32:33], L_poll2
FD_gated__25:
    s_add_u32 m0, s66, 0
    s_bfe_u32 s68, s78, 262160
    s_lshl_b32 s68, s68, 13
    buffer_load_dwordx4 v20, s[24:27], s68 offen offset:0 sc1 lds
    buffer_load_dwordx4 v20, s[24:27], s68 offen offset:1024 sc1 lds
    buffer_load_dwordx4 v20, s[24:27], s68 offen offset:2048 sc1 lds
    buffer_load_dwordx4 v20, s[24:27], s68 offen offset:3072 sc1 lds
    s_waitcnt vmcnt(20)
    s_barrier
    s_add_u32 m0, s66, 131072
    s_bfe_u32 s68, s78, 262168
    s_sub_u32 s68, s68, 11
    s_lshl_b32 s68, s68, 17
    buffer_load_dwordx4 v16, s[20:23], s68 offen offset:0  lds
    buffer_load_dwordx4 v17, s[20:23], s68 offen offset:1024  lds
    buffer_load_dwordx4 v18, s[20:23], s68 offen offset:2048  lds
    buffer_load_dwordx4 v19, s[20:23], s68 offen offset:3072  lds
    s_waitcnt vmcnt(12)
    s_barrier
    s_bfe_u32 s77, s78, 262164
    s_lshl1_add_u32 s77, s77, s71
    s_sub_u32 s77, s77, 6
    s_bitcmp1_b32 s76, s77
    s_cbranch_scc1 FD_gated__26
    s_call_b64 s[32:33], L_poll2
FD_gated__26:
    s_add_u32 m0, s66, 114688
    s_bfe_u32 s68, s78, 262164
    s_lshl_b32 s68, s68, 13
    buffer_load_dwordx4 v20, s[24:27], s68 offen offset:0 sc1 lds
    buffer_load_dwordx4 v20, s[24:27], s68 offen offset:1024 sc1 lds
    buffer_load_dwordx4 v20, s[24:27], s68 offen offset:2048 sc1 lds
    buffer_load_dwordx4 v20, s[24:27], s68 offen offset:3072 sc1 lds
    s_waitcnt vmcnt(8)
    s_barrier
    s_bfe_u32 s77, s78, 262168
    s_lshl1_add_u32 s77, s77, s71
    s_sub_u32 s77, s77, 6
    s_bitcmp1_b32 s76, s77
    s_cbranch_scc1 FD_gated__27
    s_call_b64 s[32:33], L_poll2
FD_gated__27:
    s_add_u32 m0, s66, 65536
    s_bfe_u32 s68, s78, 262168
    s_lshl_b32 s68, s68, 13
    buffer_load_dwordx4 v20, s[24:27], s68 offen offset:0 sc1 lds
    buffer_load_dwordx4 v20, s[24:27], s68 offen offset:1024 sc1 lds
    buffer_load_dwordx4 v20, s[24:27], s68 offen offset:2048 sc1 lds
    buffer_load_dwordx4 v20, s[24:27], s68 offen offset:3072 sc1 lds
    s_waitcnt vmcnt(4)
    s_barrier
    s_waitcnt vmcnt(0)
    s_barrier
    s_endpgm
L_st_load1:
    s_setpc_b64 s[6:7]
L_load1:
    s_waitcnt vmcnt(8)
    s_barrier
    s_lshl2_add_u32 s67, s57, s69
    s_mul_i32 s67, s67, 768
    s_lshl2_add_u32 s67, s59, s67
    s_add_u32 s67, s67, 131072
    s_add_u32 s8, s54, s67
    s_addc_u32 s9, s55, 0
    s_load_dword s10, s[8:9], 0
    s_load_dword s11, s[8:9], 384
    s_load_dword s12, s[8:9], 64
    s_load_dword s13, s[8:9], 448
    s_add_u32 m0, s66, 114688
    s_lshr_b32 s68, s62, 0
    v_bfe_u32 v34, s68, v32, 4
    v_bfe_u32 v35, s68, v33, 4
    v_mad_u32_u24 v36, v34, s75, v12
    v_mad_u32_u24 v38, v35, s75, v13
    v_add_u32 v37, s31, v36
    v_add_u32 v39, s31, v38
    buffer_load_dwordx4 v36, s[4:7], 0 offen offset:0  lds
    buffer_load_dwordx4 v37, s[4:7], 0 offen offset:1024  lds
    buffer_load_dwordx4 v38, s[4:7], 0 offen offset:2048  lds
    buffer_load_dwordx4 v39, s[4:7], 0 offen offset:3072  lds
    s_add_u32 m0, s66, 131072
    s_lshr_b32 s68, s62, 8
    v_bfe_u32 v34, s68, v32, 4
    v_bfe_u32 v35, s68, v33, 4
    v_mad_u32_u24 v36, v34, s75, v12
    v_mad_u32_u24 v38, v35, s75, v13
    v_add_u32 v37, s31, v36
    v_add_u32 v39, s31, v38
    buffer_load_dwordx4 v36, s[4:7], 0 offen offset:0  lds
    buffer_load_dwordx4 v37, s[4:7], 0 offen offset:1024  lds
    buffer_load_dwordx4 v38, s[4:7], 0 offen offset:2048  lds
    buffer_load_dwordx4 v39, s[4:7], 0 offen offset:3072  lds
    s_waitcnt vmcnt(8)
    s_barrier
    s_add_u32 m0, s66, 16384
    s_lshr_b32 s68, s62, 16
    v_bfe_u32 v34, s68, v32, 4
    v_bfe_u32 v35, s68, v33, 4
    v_mad_u32_u24 v36, v34, s75, v12
    v_mad_u32_u24 v38, v35, s75, v13
    v_add_u32 v37, s31, v36
    v_add_u32 v39, s31, v38
    buffer_load_dwordx4 v36, s[4:7], 0 offen offset:0  lds
    buffer_load_dwordx4 v37, s[4:7], 0 offen offset:1024  lds
    buffer_load_dwordx4 v38, s[4:7], 0 offen offset:2048  lds
    buffer_load_dwordx4 v39, s[4:7], 0 offen offset:3072  lds
    s_lshr_b32 s67, s2, 3
    s_lshl2_add_u32 s67, s67, s69
    s_add_u32 s68, s67, 0
    s_lshl_b32 s68, s68, 10
    s_add_u32 s68, s68, 444
    s_load_dwordx2 s[52:53], s[16:17], s68
    s_add_u32 s68, s67, 128
    s_lshl_b32 s68, s68, 10
    s_add_u32 s68, s68, 444
    s_load_dwordx2 s[52:53], s[16:17], s68
    s_add_u32 s68, s67, 256
    s_lshl_b32 s68, s68, 10
    s_add_u32 s68, s68, 444
    s_load_dwordx2 s[52:53], s[16:17], s68
    s_waitcnt vmcnt(8)
    s_barrier
    s_waitcnt lgkmcnt(0)
    s_sub_u32 s10, s64, s10
    s_sub_u32 s11, s64, s11
    s_sub_u32 s12, s64, s12
    s_sub_u32 s13, s64, s13
    s_lshr_b32 s67, s2, 3
    s_lshl2_add_u32 s67, s67, s69
    s_add_u32 s68, s67, 384
    s_lshl_b32 s68, s68, 10
    s_add_u32 s68, s68, 444
    s_load_dwordx2 s[52:53], s[16:17], s68
    s_add_u32 s68, s67, 512
    s_lshl_b32 s68, s68, 10
    s_add_u32 s68, s68, 444
    s_load_dwordx2 s[52:53], s[16:17], s68
    s_add_u32 s68, s67, 640
    s_lshl_b32 s68, s68, 10
    s_add_u32 s68, s68, 444
    s_load_dwordx2 s[52:53], s[16:17], s68
    s_add_u32 s68, s67, 768
    s_lshl_b32 s68, s68, 10
    s_add_u32 s68, s68, 444
    s_load_dwordx2 s[52:53], s[16:17], s68
    s_add_u32 s68, s67, 896
    s_lshl_b32 s68, s68, 10
    s_add_u32 s68, s68, 444
    s_load_dwordx2 s[52:53], s[16:17], s68
    s_waitcnt vmcnt(4)
    s_barrier
    s_add_u32 m0, s66, 0
    s_lshr_b32 s68, s62, 24
    v_bfe_u32 v34, s68, v32, 4
    v_bfe_u32 v35, s68, v33, 4
    v_mad_u32_u24 v36, v34, s75, v12
    v_mad_u32_u24 v38, v35, s75, v13
    v_add_u32 v37, s31, v36
    v_add_u32 v39, s31, v38
    buffer_load_dwordx4 v36, s[4:7], 0 offen offset:0  lds
    buffer_load_dwordx4 v37, s[4:7], 0 offen offset:1024  lds
    buffer_load_dwordx4 v38, s[4:7], 0 offen offset:2048  lds
    buffer_load_dwordx4 v39, s[4:7], 0 offen offset:3072  lds
    s_add_u32 m0, s66, 49152
    s_bfe_u32 s68, s63, 262144
    s_lshl_b32 s68, s68, 17
    buffer_load_dwordx4 v16, s[16:19], s68 offen offset:0  lds
    buffer_load_dwordx4 v17, s[16:19], s68 offen offset:1024  lds
    buffer_load_dwordx4 v18, s[16:19], s68 offen offset:2048  lds
    buffer_load_dwordx4 v19, s[16:19], s68 offen offset:3072  lds
    s_waitcnt vmcnt(8)
    s_barrier
    s_atomic_add s10, s[8:9], 0
    s_atomic_add s11, s[8:9], 384
    s_add_u32 m0, s66, 32768
    s_bfe_u32 s68, s63, 262148
    s_lshl_b32 s68, s68, 17
    buffer_load_dwordx4 v16, s[16:19], s68 offen offset:0  lds
    buffer_load_dwordx4 v17, s[16:19], s68 offen offset:1024  lds
    buffer_load_dwordx4 v18, s[16:19], s68 offen offset:2048  lds
    buffer_load_dwordx4 v19, s[16:19], s68 offen offset:3072  lds
    s_add_u32 m0, s66, 65536
    s_bfe_u32 s68, s63, 262152
    s_lshl_b32 s68, s68, 17
    buffer_load_dwordx4 v16, s[16:19], s68 offen offset:0  lds
    buffer_load_dwordx4 v17, s[16:19], s68 offen offset:1024  lds
    buffer_load_dwordx4 v18, s[16:19], s68 offen offset:2048  lds
    buffer_load_dwordx4 v19, s[16:19], s68 offen offset:3072  lds
    s_add_u32 m0, s66, 81920
    s_bfe_u32 s68, s63, 262156
    s_lshl_b32 s68, s68, 17
    buffer_load_dwordx4 v16, s[16:19], s68 offen offset:0  lds
    buffer_load_dwordx4 v17, s[16:19], s68 offen offset:1024  lds
    buffer_load_dwordx4 v18, s[16:19], s68 offen offset:2048  lds
    buffer_load_dwordx4 v19, s[16:19], s68 offen offset:3072  lds
    s_load_dwordx8 s[80:87], s[72:73], 0 glc
    s_waitcnt vmcnt(16)
    s_barrier
    s_add_u32 m0, s66, 98304
    s_bfe_u32 s68, s63, 262160
    s_lshl_b32 s68, s68, 17
    buffer_load_dwordx4 v16, s[16:19], s68 offen offset:0  lds
    buffer_load_dwordx4 v17, s[16:19], s68 offen offset:1024  lds
    buffer_load_dwordx4 v18, s[16:19], s68 offen offset:2048  lds
    buffer_load_dwordx4 v19, s[16:19], s68 offen offset:3072  lds
    s_bfe_u32 s77, s63, 262144
    s_bitcmp1_b32 s76, s77
    s_cbranch_scc1 FD_gated__28
    s_call_b64 s[32:33], L_poll0
FD_gated__28:
    s_add_u32 m0, s66, 114688
    s_bfe_u32 s68, s63, 262144
    s_lshl_b32 s68, s68, 13
    buffer_load_dwordx4 v20, s[24:27], s68 offen offset:0 sc1 lds
    buffer_load_dwordx4 v20, s[24:27], s68 offen offset:1024 sc1 lds
    buffer_load_dwordx4 v20, s[24:27], s68 offen offset:2048 sc1 lds
    buffer_load_dwordx4 v20, s[24:27], s68 offen offset:3072 sc1 lds
    s_barrier
    s_bfe_u32 s77, s63, 262148
    s_bitcmp1_b32 s76, s77
    s_cbranch_scc1 FD_gated__29
    s_call_b64 s[32:33], L_poll0
FD_gated__29:
    s_add_u32 m0, s66, 131072
    s_bfe_u32 s68, s63, 262148
    s_lshl_b32 s68, s68, 13
    buffer_load_dwordx4 v20, s[24:27], s68 offen offset:0 sc1 lds
    buffer_load_dwordx4 v20, s[24:27], s68 offen offset:1024 sc1 lds
    buffer_load_dwordx4 v20, s[24:27], s68 offen offset:2048 sc1 lds
    buffer_load_dwordx4 v20, s[24:27], s68 offen offset:3072 sc1 lds
    s_bfe_u32 s77, s63, 262152
    s_bitcmp1_b32 s76, s77
    s_cbranch_scc1 FD_gated__30
    s_call_b64 s[32:33], L_poll0
FD_gated__30:
    s_add_u32 m0, s66, 16384
    s_bfe_u32 s68, s63, 262152
    s_lshl_b32 s68, s68, 13
    buffer_load_dwordx4 v20, s[24:27], s68 offen offset:0 sc1 lds
    buffer_load_dwordx4 v20, s[24:27], s68 offen offset:1024 sc1 lds
    buffer_load_dwordx4 v20, s[24:27], s68 offen offset:2048 sc1 lds
    buffer_load_dwordx4 v20, s[24:27], s68 offen offset:3072 sc1 lds
    s_bfe_u32 s77, s63, 262156
    s_bitcmp1_b32 s76, s77
    s_cbranch_scc1 FD_gated__31
    s_call_b64 s[32:33], L_poll0
FD_gated__31:
    s_add_u32 m0, s66, 0
    s_bfe_u32 s68, s63, 262156
    s_lshl_b32 s68, s68, 13
    buffer_load_dwordx4 v20, s[24:27], s68 offen offset:0 sc1 lds
    buffer_load_dwordx4 v20, s[24:27], s68 offen offset:1024 sc1 lds
    buffer_load_dwordx4 v20, s[24:27], s68 offen offset:2048 sc1 lds
    buffer_load_dwordx4 v20, s[24:27], s68 offen offset:3072 sc1 lds
    s_waitcnt vmcnt(12)
    s_barrier
    s_load_dwordx16 s[36:51], s[54:55], s70 glc
    s_lshr_b32 s67, s2, 3
    s_lshl2_add_u32 s67, s67, s69
    s_add_u32 s68, s67, 1024
    s_lshl_b32 s68, s68, 10
    s_add_u32 s68, s68, 444
    s_load_dwordx2 s[52:53], s[16:17], s68
    s_add_u32 s68, s67, 1152
    s_lshl_b32 s68, s68, 10
    s_add_u32 s68, s68, 444
    s_load_dwordx2 s[52:53], s[16:17], s68
    s_add_u32 s68, s67, 1280
    s_min_u32 s68, s68, 1375
    s_lshl_b32 s68, s68, 10
    s_add_u32 s68, s68, 444
    s_load_dwordx2 s[52:53], s[16:17], s68
    s_add_u32 s68, s67, 0
    s_lshl_b32 s68, s68, 10
    s_add_u32 s68, s68, 444
    s_load_dwordx2 s[52:53], s[20:21], s68
    s_waitcnt vmcnt(8)
    s_barrier
    s_add_u32 m0, s66, 49152
    s_bfe_u32 s68, s63, 262164
    s_lshl_b32 s68, s68, 17
    buffer_load_dwordx4 v16, s[16:19], s68 offen offset:0  lds
    buffer_load_dwordx4 v17, s[16:19], s68 offen offset:1024  lds
    buffer_load_dwordx4 v18, s[16:19], s68 offen offset:2048  lds
    buffer_load_dwordx4 v19, s[16:19], s68 offen offset:3072  lds
    s_bfe_u32 s77, s63, 262160
    s_branch L_pg2x
L_pg2:
    s_setpc_b64 s[6:7]
L_pg2x:
    s_bitcmp1_b32 s76, s77
    s_cbranch_scc1 FD_gated__32
    s_call_b64 s[32:33], L_poll0
FD_gated__32:
    s_add_u32 m0, s66, 114688
    s_bfe_u32 s68, s63, 262160
    s_lshl_b32 s68, s68, 13
    buffer_load_dwordx4 v20, s[24:27], s68 offen offset:0 sc1 lds
    buffer_load_dwordx4 v20, s[24:27], s68 offen offset:1024 sc1 lds
    buffer_load_dwordx4 v20, s[24:27], s68 offen offset:2048 sc1 lds
    buffer_load_dwordx4 v20, s[24:27], s68 offen offset:3072 sc1 lds
    s_mov_b32 s34, s64
    s_mov_b32 s35, s64
KW_gated__33:
    s_waitcnt lgkmcnt(0)
    s_cmp_eq_u64 s[36:37], s[34:35]
    s_cbranch_scc0 KR_gated__35
    s_cmp_eq_u64 s[38:39], s[34:35]
    s_cbranch_scc0 KR_gated__35
    s_cmp_eq_u64 s[40:41], s[34:35]
    s_cbranch_scc0 KR_gated__35
    s_cmp_eq_u64 s[42:43], s[34:35]
    s_cbranch_scc0 KR_gated__35
    s_cmp_eq_u64 s[44:45], s[34:35]
    s_cbranch_scc0 KR_gated__35
    s_cmp_eq_u64 s[46:47], s[34:35]
    s_cbranch_scc0 KR_gated__35
    s_cmp_eq_u64 s[48:49], s[34:35]
    s_cbranch_scc0 KR_gated__35
    s_cmp_eq_u64 s[50:51], s[34:35]
    s_cbranch_scc1 KD_gated__34
KR_gated__35:
    s_load_dwordx16 s[36:51], s[54:55], s70 glc
    s_sub_u32 s65, s65, 1
    s_cbranch_scc0 KW_gated__33
    s_mov_b32 s65, 0
    s_waitcnt lgkmcnt(0)
KD_gated__34:
    s_mul_i32 s67, s69, 1280
    s_add_u32 m0, s67, 149504
    s_nop 0
    buffer_load_dwordx4 v42, s[24:27], s79 offen sc1 lds
    buffer_load_dword v41, s[24:27], s79 offen offset:1024 sc1 lds
    s_waitcnt vmcnt(14)
    s_barrier
    s_add_u32 m0, s66, 32768
    s_bfe_u32 s68, s63, 262168
    s_lshl_b32 s68, s68, 17
    buffer_load_dwordx4 v16, s[16:19], s68 offen offset:0  lds
    buffer_load_dwordx4 v17, s[16:19], s68 offen offset:1024  lds
    buffer_load_dwordx4 v18, s[16:19], s68 offen offset:2048  lds
    buffer_load_dwordx4 v19, s[16:19], s68 offen offset:3072  lds
    s_bfe_u32 s77, s63, 262164
    s_bitcmp1_b32 s76, s77
    s_cbranch_scc1 FD_gated__36
    s_call_b64 s[32:33], L_poll0
FD_gated__36:
    s_add_u32 m0, s66, 131072
    s_bfe_u32 s68, s63, 262164
    s_lshl_b32 s68, s68, 13
    buffer_load_dwordx4 v20, s[24:27], s68 offen offset:0 sc1 lds
    buffer_load_dwordx4 v20, s[24:27], s68 offen offset:1024 sc1 lds
    buffer_load_dwordx4 v20, s[24:27], s68 offen offset:2048 sc1 lds
    buffer_load_dwordx4 v20, s[24:27], s68 offen offset:3072 sc1 lds
    s_lshr_b32 s67, s2, 3
    s_lshl2_add_u32 s67, s67, s69
    s_add_u32 s68, s67, 128
    s_lshl_b32 s68, s68, 10
    s_add_u32 s68, s68, 444
    s_load_dwordx2 s[52:53], s[20:21], s68
    s_add_u32 s68, s67, 256
    s_lshl_b32 s68, s68, 10
    s_add_u32 s68, s68, 444
    s_load_dwordx2 s[52:53], s[20:21], s68
    s_add_u32 s68, s67, 384
    s_lshl_b32 s68, s68, 10
    s_add_u32 s68, s68, 444
    s_load_dwordx2 s[52:53], s[20:21], s68
    s_waitcnt vmcnt(8)
    s_barrier
    s_add_u32 m0, s66, 65536
    s_bfe_u32 s68, s63, 262172
    s_lshl_b32 s68, s68, 17
    buffer_load_dwordx4 v16, s[16:19], s68 offen offset:0  lds
    buffer_load_dwordx4 v17, s[16:19], s68 offen offset:1024  lds
    buffer_load_dwordx4 v18, s[16:19], s68 offen offset:2048  lds
    buffer_load_dwordx4 v19, s[16:19], s68 offen offset:3072  lds
    s_bfe_u32 s77, s63, 262168
    s_bitcmp1_b32 s76, s77
    s_cbranch_scc1 FD_gated__37
    s_call_b64 s[32:33], L_poll0
FD_gated__37:
    s_add_u32 m0, s66, 16384
    s_bfe_u32 s68, s63, 262168
    s_lshl_b32 s68, s68, 13
    buffer_load_dwordx4 v20, s[24:27], s68 offen offset:0 sc1 lds
    buffer_load_dwordx4 v20, s[24:27], s68 offen offset:1024 sc1 lds
    buffer_load_dwordx4 v20, s[24:27], s68 offen offset:2048 sc1 lds
    buffer_load_dwordx4 v20, s[24:27], s68 offen offset:3072 sc1 lds
    s_waitcnt vmcnt(18)
    s_barrier
    s_load_dwordx8 s[88:95], s[72:73], 32 glc
    s_add_u32 m0, s66, 81920
    s_bfe_u32 s68, s78, 262144
    s_lshl_b32 s68, s68, 17
    buffer_load_dwordx4 v16, s[16:19], s68 offen offset:0  lds
    buffer_load_dwordx4 v17, s[16:19], s68 offen offset:1024  lds
    buffer_load_dwordx4 v18, s[16:19], s68 offen offset:2048  lds
    buffer_load_dwordx4 v19, s[16:19], s68 offen offset:3072  lds
    s_bfe_u32 s77, s63, 262172
    s_bitcmp1_b32 s76, s77
    s_cbranch_scc1 FD_gated__38
    s_call_b64 s[32:33], L_poll0
FD_gated__38:
    s_add_u32 m0, s66, 0
    s_bfe_u32 s68, s63, 262172
    s_lshl_b32 s68, s68, 13
    buffer_load_dwordx4 v20, s[24:27], s68 offen offset:0 sc1 lds
    buffer_load_dwordx4 v20, s[24:27], s68 offen offset:1024 sc1 lds
    buffer_load_dwordx4 v20, s[24:27], s68 offen offset:2048 sc1 lds
    buffer_load_dwordx4 v20, s[24:27], s68 offen offset:3072 sc1 lds
    s_waitcnt vmcnt(16)
    s_barrier
    s_add_u32 m0, s66, 98304
    s_bfe_u32 s68, s78, 262148
    s_lshl_b32 s68, s68, 17
    buffer_load_dwordx4 v16, s[16:19], s68 offen offset:0  lds
    buffer_load_dwordx4 v17, s[16:19], s68 offen offset:1024  lds
    buffer_load_dwordx4 v18, s[16:19], s68 offen offset:2048  lds
    buffer_load_dwordx4 v19, s[16:19], s68 offen offset:3072  lds
    s_bfe_u32 s77, s78, 262144
    s_lshl1_add_u32 s77, s77, s71
    s_sub_u32 s77, s77, 8
    s_bitcmp1_b32 s76, s77
    s_cbranch_scc1 FD_gated__39
    s_call_b64 s[32:33], L_poll1
FD_gated__39:
    s_add_u32 m0, s66, 114688
    s_bfe_u32 s68, s78, 262144
    s_lshl_b32 s68, s68, 13
    buffer_load_dwordx4 v20, s[24:27], s68 offen offset:0 sc1 lds
    buffer_load_dwordx4 v20, s[24:27], s68 offen offset:1024 sc1 lds
    buffer_load_dwordx4 v20, s[24:27], s68 offen offset:2048 sc1 lds
    buffer_load_dwordx4 v20, s[24:27], s68 offen offset:3072 sc1 lds
    s_waitcnt vmcnt(16)
    s_barrier
    s_atomic_add s12, s[8:9], 64
    s_atomic_add s13, s[8:9], 448
    s_add_u32 m0, s66, 49152
    s_bfe_u32 s68, s78, 262152
    s_lshl_b32 s68, s68, 17
    buffer_load_dwordx4 v16, s[16:19], s68 offen offset:0  lds
    buffer_load_dwordx4 v17, s[16:19], s68 offen offset:1024  lds
    buffer_load_dwordx4 v18, s[16:19], s68 offen offset:2048  lds
    buffer_load_dwordx4 v19, s[16:19], s68 offen offset:3072  lds
    s_bfe_u32 s77, s78, 262148
    s_lshl1_add_u32 s77, s77, s71
    s_sub_u32 s77, s77, 8
    s_bitcmp1_b32 s76, s77
    s_cbranch_scc1 FD_gated__40
    s_call_b64 s[32:33], L_poll1
FD_gated__40:
    s_add_u32 m0, s66, 131072
    s_bfe_u32 s68, s78, 262148
    s_lshl_b32 s68, s68, 13
    buffer_load_dwordx4 v20, s[24:27], s68 offen offset:0 sc1 lds
    buffer_load_dwordx4 v20, s[24:27], s68 offen offset:1024 sc1 lds
    buffer_load_dwordx4 v20, s[24:27], s68 offen offset:2048 sc1 lds
    buffer_load_dwordx4 v20, s[24:27], s68 offen offset:3072 sc1 lds
    s_waitcnt vmcnt(16)
    s_barrier
    s_add_u32 m0, s66, 32768
    s_bfe_u32 s68, s78, 262156
    s_sub_u32 s68, s68, 11
    s_lshl_b32 s68, s68, 17
    buffer_load_dwordx4 v16, s[20:23], s68 offen offset:0  lds
    buffer_load_dwordx4 v17, s[20:23], s68 offen offset:1024  lds
    buffer_load_dwordx4 v18, s[20:23], s68 offen offset:2048  lds
    buffer_load_dwordx4 v19, s[20:23], s68 offen offset:3072  lds
    s_bfe_u32 s77, s78, 262152
    s_lshl1_add_u32 s77, s77, s71
    s_sub_u32 s77, s77, 8
    s_bitcmp1_b32 s76, s77
    s_cbranch_scc1 FD_gated__41
    s_call_b64 s[32:33], L_poll1
FD_gated__41:
    s_add_u32 m0, s66, 16384
    s_bfe_u32 s68, s78, 262152
    s_lshl_b32 s68, s68, 13
    buffer_load_dwordx4 v20, s[24:27], s68 offen offset:0 sc1 lds
    buffer_load_dwordx4 v20, s[24:27], s68 offen offset:1024 sc1 lds
    buffer_load_dwordx4 v20, s[24:27], s68 offen offset:2048 sc1 lds
    buffer_load_dwordx4 v20, s[24:27], s68 offen offset:3072 sc1 lds
    s_waitcnt vmcnt(16)
    s_barrier
    s_load_dwordx8 s[44:51], s[72:73], 64 glc
    s_add_u32 m0, s66, 65536
    s_bfe_u32 s68, s78, 262160
    s_sub_u32 s68, s68, 11
    s_lshl_b32 s68, s68, 17
    buffer_load_dwordx4 v16, s[20:23], s68 offen offset:0  lds
    buffer_load_dwordx4 v17, s[20:23], s68 offen offset:1024  lds
    buffer_load_dwordx4 v18, s[20:23], s68 offen offset:2048  lds
    buffer_load_dwordx4 v19, s[20:23], s68 offen offset:3072  lds
    s_mov_b32 s77, 14
    s_bitcmp1_b32 s76, s77
    s_cbranch_scc1 FD_gated__42
    s_call_b64 s[32:33], L_poll1
FD_gated__42:
    s_waitcnt vmcnt(12)
    s_barrier
    s_bfe_u32 s77, s78, 262156
    s_lshl1_add_u32 s77, s77, s71
    s_sub_u32 s77, s77, 6
    s_bitcmp1_b32 s76, s77
    s_cbranch_scc1 FD_gated__43
    s_call_b64 s[32:33], L_poll2
FD_gated__43:
    s_add_u32 m0, s66, 0
    s_bfe_u32 s68, s78, 262156
    s_lshl_b32 s68, s68, 13
    buffer_load_dwordx4 v20, s[24:27], s68 offen offset:0 sc1 lds
    buffer_load_dwordx4 v20, s[24:27], s68 offen offset:1024 sc1 lds
    buffer_load_dwordx4 v20, s[24:27], s68 offen offset:2048 sc1 lds
    buffer_load_dwordx4 v20, s[24:27], s68 offen offset:3072 sc1 lds
    s_add_u32 m0, s66, 81920
    s_bfe_u32 s68, s78, 262164
    s_sub_u32 s68, s68, 11
    s_lshl_b32 s68, s68, 17
    buffer_load_dwordx4 v16, s[20:23], s68 offen offset:0  lds
    buffer_load_dwordx4 v17, s[20:23], s68 offen offset:1024  lds
    buffer_load_dwordx4 v18, s[20:23], s68 offen offset:2048  lds
    buffer_load_dwordx4 v19, s[20:23], s68 offen offset:3072  lds
    s_waitcnt vmcnt(12)
    s_barrier
    s_bfe_u32 s77, s78, 262160
    s_lshl1_add_u32 s77, s77, s71
    s_sub_u32 s77, s77, 6
    s_bitcmp1_b32 s76, s77
    s_cbranch_scc1 FD_gated__44
    s_call_b64 s[32:33], L_poll2
FD_gated__44:
    s_add_u32 m0, s66, 114688
    s_bfe_u32 s68, s78, 262160
    s_lshl_b32 s68, s68, 13
    buffer_load_dwordx4 v20, s[24:27], s68 offen offset:0 sc1 lds
    buffer_load_dwordx4 v20, s[24:27], s68 offen offset:1024 sc1 lds
    buffer_load_dwordx4 v20, s[24:27], s68 offen offset:2048 sc1 lds
    buffer_load_dwordx4 v20, s[24:27], s68 offen offset:3072 sc1 lds
    s_add_u32 m0, s66, 98304
    s_bfe_u32 s68, s78, 262168
    s_sub_u32 s68, s68, 11
    s_lshl_b32 s68, s68, 17
    buffer_load_dwordx4 v16, s[20:23], s68 offen offset:0  lds
    buffer_load_dwordx4 v17, s[20:23], s68 offen offset:1024  lds
    buffer_load_dwordx4 v18, s[20:23], s68 offen offset:2048  lds
    buffer_load_dwordx4 v19, s[20:23], s68 offen offset:3072  lds
    s_waitcnt vmcnt(12)
    s_barrier
    s_bfe_u32 s77, s78, 262164
    s_lshl1_add_u32 s77, s77, s71
    s_sub_u32 s77, s77, 6
    s_bitcmp1_b32 s76, s77
    s_cbranch_scc1 FD_gated__45
    s_call_b64 s[32:33], L_poll2
FD_gated__45:
    s_add_u32 m0, s66, 131072
    s_bfe_u32 s68, s78, 262164
    s_lshl_b32 s68, s68, 13
    buffer_load_dwordx4 v20, s[24:27], s68 offen offset:0 sc1 lds
    buffer_load_dwordx4 v20, s[24:27], s68 offen offset:1024 sc1 lds
    buffer_load_dwordx4 v20, s[24:27], s68 offen offset:2048 sc1 lds
    buffer_load_dwordx4 v20, s[24:27], s68 offen offset:3072 sc1 lds
    s_waitcnt vmcnt(8)
    s_barrier
    s_bfe_u32 s77, s78, 262168
    s_lshl1_add_u32 s77, s77, s71
    s_sub_u32 s77, s77, 6
    s_bitcmp1_b32 s76, s77
    s_cbranch_scc1 FD_gated__46
    s_call_b64 s[32:33], L_poll2
FD_gated__46:
    s_add_u32 m0, s66, 49152
    s_bfe_u32 s68, s78, 262168
    s_lshl_b32 s68, s68, 13
    buffer_load_dwordx4 v20, s[24:27], s68 offen offset:0 sc1 lds
    buffer_load_dwordx4 v20, s[24:27], s68 offen offset:1024 sc1 lds
    buffer_load_dwordx4 v20, s[24:27], s68 offen offset:2048 sc1 lds
    buffer_load_dwordx4 v20, s[24:27], s68 offen offset:3072 sc1 lds
    s_waitcnt vmcnt(4)
    s_barrier
    s_waitcnt vmcnt(0)
    s_barrier
    s_lshl2_add_u32 s67, s59, s69
    s_or_b32 s67, s67, s57
    s_cbranch_scc1 EP_gated__47
    s_mov_b32 s67, 983040
    v_mov_b32 v21, s64
    s_mov_b64 exec, 1
    buffer_store_dword v21, off, s[24:27], s67 sc1
    s_mov_b64 exec, -1
EP_gated__47:
    s_endpgm
L_cons0:
    s_barrier
    ds_read_b64_tr_b16 v[20:21], v4 offset:0
    ds_read_b128 v[128:131], v2 offset:16384
    ds_read_b64_tr_b16 v[22:23], v4 offset:1024
    ds_read_b64_tr_b16 v[24:25], v5 offset:0
    ds_read_b128 v[132:135], v2 offset:18432
    ds_read_b64_tr_b16 v[26:27], v5 offset:1024
    ds_read_b64_tr_b16 v[28:29], v6 offset:0
    ds_read_b128 v[136:139], v3 offset:16384
    ds_read_b64_tr_b16 v[30:31], v6 offset:1024
    ds_read_b64_tr_b16 v[32:33], v7 offset:0
    ds_read_b128 v[140:143], v3 offset:18432
    ds_read_b64_tr_b16 v[34:35], v7 offset:1024
    s_waitcnt lgkmcnt(7)
    v_mfma_f32_16x16x32_bf16 v[64:67], v[128:131], v[20:23], 0
    ds_read_b64_tr_b16 v[36:37], v8 offset:0
    v_mfma_f32_16x16x32_bf16 v[68:71], v[132:135], v[20:23], 0
    ds_read_b64_tr_b16 v[38:39], v8 offset:1024
    s_waitcnt lgkmcnt(8)
    v_mfma_f32_16x16x32_bf16 v[72:75], v[128:131], v[24:27], 0
    ds_read_b64_tr_b16 v[40:41], v9 offset:0
    v_mfma_f32_16x16x32_bf16 v[76:79], v[132:135], v[24:27], 0
    ds_read_b64_tr_b16 v[42:43], v9 offset:1024
    s_waitcnt lgkmcnt(7)
    v_mfma_f32_16x16x32_bf16 v[80:83], v[128:131], v[28:31], 0
    ds_read_b64_tr_b16 v[20:21], v10 offset:0
    v_mfma_f32_16x16x32_bf16 v[84:87], v[132:135], v[28:31], 0
    ds_read_b64_tr_b16 v[22:23], v10 offset:1024
    s_waitcnt lgkmcnt(6)
    v_mfma_f32_16x16x32_bf16 v[88:91], v[128:131], v[32:35], 0
    ds_read_b64_tr_b16 v[24:25], v11 offset:0
    v_mfma_f32_16x16x32_bf16 v[92:95], v[132:135], v[32:35], 0
    ds_read_b64_tr_b16 v[26:27], v11 offset:1024
    s_waitcnt lgkmcnt(6)
    v_mfma_f32_16x16x32_bf16 v[96:99], v[128:131], v[36:39], 0
    ds_read_b64_tr_b16 v[28:29], v4 offset:8192
    v_mfma_f32_16x16x32_bf16 v[100:103], v[132:135], v[36:39], 0
    ds_read_b64_tr_b16 v[30:31], v4 offset:9216
    s_waitcnt lgkmcnt(6)
    v_mfma_f32_16x16x32_bf16 v[104:107], v[128:131], v[40:43], 0
    ds_read_b64_tr_b16 v[32:33], v5 offset:8192
    v_mfma_f32_16x16x32_bf16 v[108:111], v[132:135], v[40:43], 0
    ds_read_b64_tr_b16 v[34:35], v5 offset:9216
    s_waitcnt lgkmcnt(6)
    v_mfma_f32_16x16x32_bf16 v[112:115], v[128:131], v[20:23], 0
    ds_read_b64_tr_b16 v[36:37], v6 offset:8192
    v_mfma_f32_16x16x32_bf16 v[116:119], v[132:135], v[20:23], 0
    ds_read_b64_tr_b16 v[38:39], v6 offset:9216
    s_waitcnt lgkmcnt(6)
    v_mfma_f32_16x16x32_bf16 v[120:123], v[128:131], v[24:27], 0
    ds_read_b64_tr_b16 v[40:41], v7 offset:8192
    v_mfma_f32_16x16x32_bf16 v[124:127], v[132:135], v[24:27], 0
    ds_read_b64_tr_b16 v[42:43], v7 offset:9216
    s_waitcnt lgkmcnt(6)
    v_mfma_f32_16x16x32_bf16 v[64:67], v[136:139], v[28:31], v[64:67]
    ds_read_b64_tr_b16 v[20:21], v8 offset:8192
    v_mfma_f32_16x16x32_bf16 v[68:71], v[140:143], v[28:31], v[68:71]
    ds_read_b64_tr_b16 v[22:23], v8 offset:9216
    s_waitcnt lgkmcnt(6)
    v_mfma_f32_16x16x32_bf16 v[72:75], v[136:139], v[32:35], v[72:75]
    ds_read_b64_tr_b16 v[24:25], v9 offset:8192
    v_mfma_f32_16x16x32_bf16 v[76:79], v[140:143], v[32:35], v[76:79]
    ds_read_b64_tr_b16 v[26:27], v9 offset:9216
    s_waitcnt lgkmcnt(6)
    v_mfma_f32_16x16x32_bf16 v[80:83], v[136:139], v[36:39], v[80:83]
    ds_read_b64_tr_b16 v[28:29], v10 offset:8192
    v_mfma_f32_16x16x32_bf16 v[84:87], v[140:143], v[36:39], v[84:87]
    ds_read_b64_tr_b16 v[30:31], v10 offset:9216
    s_waitcnt lgkmcnt(6)
    v_mfma_f32_16x16x32_bf16 v[88:91], v[136:139], v[40:43], v[88:91]
    ds_read_b64_tr_b16 v[32:33], v11 offset:8192
    v_mfma_f32_16x16x32_bf16 v[92:95], v[140:143], v[40:43], v[92:95]
    ds_read_b64_tr_b16 v[34:35], v11 offset:9216
    s_waitcnt lgkmcnt(6)
    v_mfma_f32_16x16x32_bf16 v[96:99], v[136:139], v[20:23], v[96:99]
    s_barrier
    ds_read_b64_tr_b16 v[36:37], v4 offset:32768
    ds_read_b128 v[144:147], v2 offset:49152
    v_mfma_f32_16x16x32_bf16 v[100:103], v[140:143], v[20:23], v[100:103]
    ds_read_b64_tr_b16 v[38:39], v4 offset:33792
    s_waitcnt lgkmcnt(7)
    v_mfma_f32_16x16x32_bf16 v[104:107], v[136:139], v[24:27], v[104:107]
    ds_read_b64_tr_b16 v[40:41], v5 offset:32768
    ds_read_b128 v[148:151], v2 offset:51200
    v_mfma_f32_16x16x32_bf16 v[108:111], v[140:143], v[24:27], v[108:111]
    ds_read_b64_tr_b16 v[42:43], v5 offset:33792
    s_waitcnt lgkmcnt(8)
    v_mfma_f32_16x16x32_bf16 v[112:115], v[136:139], v[28:31], v[112:115]
    ds_read_b64_tr_b16 v[20:21], v6 offset:32768
    ds_read_b128 v[152:155], v3 offset:49152
    v_mfma_f32_16x16x32_bf16 v[116:119], v[140:143], v[28:31], v[116:119]
    ds_read_b64_tr_b16 v[22:23], v6 offset:33792
    s_waitcnt lgkmcnt(9)
    v_mfma_f32_16x16x32_bf16 v[120:123], v[136:139], v[32:35], v[120:123]
    ds_read_b64_tr_b16 v[24:25], v7 offset:32768
    ds_read_b128 v[156:159], v3 offset:51200
    v_mfma_f32_16x16x32_bf16 v[124:127], v[140:143], v[32:35], v[124:127]
    ds_read_b64_tr_b16 v[26:27], v7 offset:33792
    s_waitcnt lgkmcnt(7)
    v_mfma_f32_16x16x32_bf16 v[64:67], v[144:147], v[36:39], v[64:67]
    ds_read_b64_tr_b16 v[28:29], v8 offset:32768
    v_mfma_f32_16x16x32_bf16 v[68:71], v[148:151], v[36:39], v[68:71]
    ds_read_b64_tr_b16 v[30:31], v8 offset:33792
    s_waitcnt lgkmcnt(8)
    v_mfma_f32_16x16x32_bf16 v[72:75], v[144:147], v[40:43], v[72:75]
    ds_read_b64_tr_b16 v[32:33], v9 offset:32768
    v_mfma_f32_16x16x32_bf16 v[76:79], v[148:151], v[40:43], v[76:79]
    ds_read_b64_tr_b16 v[34:35], v9 offset:33792
    s_waitcnt lgkmcnt(7)
    v_mfma_f32_16x16x32_bf16 v[80:83], v[144:147], v[20:23], v[80:83]
    ds_read_b64_tr_b16 v[36:37], v10 offset:32768
    v_mfma_f32_16x16x32_bf16 v[84:87], v[148:151], v[20:23], v[84:87]
    ds_read_b64_tr_b16 v[38:39], v10 offset:33792
    s_waitcnt lgkmcnt(6)
    v_mfma_f32_16x16x32_bf16 v[88:91], v[144:147], v[24:27], v[88:91]
    ds_read_b64_tr_b16 v[40:41], v11 offset:32768
    v_mfma_f32_16x16x32_bf16 v[92:95], v[148:151], v[24:27], v[92:95]
    ds_read_b64_tr_b16 v[42:43], v11 offset:33792
    s_waitcnt lgkmcnt(6)
    v_mfma_f32_16x16x32_bf16 v[96:99], v[144:147], v[28:31], v[96:99]
    ds_read_b64_tr_b16 v[20:21], v4 offset:40960
    v_mfma_f32_16x16x32_bf16 v[100:103], v[148:151], v[28:31], v[100:103]
    ds_read_b64_tr_b16 v[22:23], v4 offset:41984
    s_waitcnt lgkmcnt(6)
    v_mfma_f32_16x16x32_bf16 v[104:107], v[144:147], v[32:35], v[104:107]
    ds_read_b64_tr_b16 v[24:25], v5 offset:40960
    v_mfma_f32_16x16x32_bf16 v[108:111], v[148:151], v[32:35], v[108:111]
    ds_read_b64_tr_b16 v[26:27], v5 offset:41984
    s_waitcnt lgkmcnt(6)
    v_mfma_f32_16x16x32_bf16 v[112:115], v[144:147], v[36:39], v[112:115]
    ds_read_b64_tr_b16 v[28:29], v6 offset:40960
    v_mfma_f32_16x16x32_bf16 v[116:119], v[148:151], v[36:39], v[116:119]
    ds_read_b64_tr_b16 v[30:31], v6 offset:41984
    s_waitcnt lgkmcnt(6)
    v_mfma_f32_16x16x32_bf16 v[120:123], v[144:147], v[40:43], v[120:123]
    ds_read_b64_tr_b16 v[32:33], v7 offset:40960
    v_mfma_f32_16x16x32_bf16 v[124:127], v[148:151], v[40:43], v[124:127]
    ds_read_b64_tr_b16 v[34:35], v7 offset:41984
    s_waitcnt lgkmcnt(6)
    v_mfma_f32_16x16x32_bf16 v[64:67], v[152:155], v[20:23], v[64:67]
    ds_read_b64_tr_b16 v[36:37], v8 offset:40960
    v_mfma_f32_16x16x32_bf16 v[68:71], v[156:159], v[20:23], v[68:71]
    ds_read_b64_tr_b16 v[38:39], v8 offset:41984
    s_waitcnt lgkmcnt(6)
    v_mfma_f32_16x16x32_bf16 v[72:75], v[152:155], v[24:27], v[72:75]
    ds_read_b64_tr_b16 v[40:41], v9 offset:40960
    v_mfma_f32_16x16x32_bf16 v[76:79], v[156:159], v[24:27], v[76:79]
    ds_read_b64_tr_b16 v[42:43], v9 offset:41984
    s_waitcnt lgkmcnt(6)
    v_mfma_f32_16x16x32_bf16 v[80:83], v[152:155], v[28:31], v[80:83]
    ds_read_b64_tr_b16 v[20:21], v10 offset:40960
    v_mfma_f32_16x16x32_bf16 v[84:87], v[156:159], v[28:31], v[84:87]
    ds_read_b64_tr_b16 v[22:23], v10 offset:41984
    s_waitcnt lgkmcnt(6)
    v_mfma_f32_16x16x32_bf16 v[88:91], v[152:155], v[32:35], v[88:91]
    ds_read_b64_tr_b16 v[24:25], v11 offset:40960
    v_mfma_f32_16x16x32_bf16 v[92:95], v[156:159], v[32:35], v[92:95]
    ds_read_b64_tr_b16 v[26:27], v11 offset:41984
    s_waitcnt lgkmcnt(6)
    v_mfma_f32_16x16x32_bf16 v[96:99], v[152:155], v[36:39], v[96:99]
    s_barrier
    v_add_u32 v4, 65536, v4
    ds_read_b64_tr_b16 v[28:29], v4 offset:16384
    v_add_u32 v2, 65536, v2
    ds_read_b128 v[160:163], v2 offset:0
    v_mfma_f32_16x16x32_bf16 v[100:103], v[156:159], v[36:39], v[100:103]
    ds_read_b64_tr_b16 v[30:31], v4 offset:17408
    s_waitcnt lgkmcnt(7)
    v_mfma_f32_16x16x32_bf16 v[104:107], v[152:155], v[40:43], v[104:107]
    v_add_u32 v5, 65536, v5
    ds_read_b64_tr_b16 v[32:33], v5 offset:16384
    ds_read_b128 v[164:167], v2 offset:2048
    v_mfma_f32_16x16x32_bf16 v[108:111], v[156:159], v[40:43], v[108:111]
    ds_read_b64_tr_b16 v[34:35], v5 offset:17408
    s_waitcnt lgkmcnt(8)
    v_mfma_f32_16x16x32_bf16 v[112:115], v[152:155], v[20:23], v[112:115]
    v_add_u32 v6, 65536, v6
    ds_read_b64_tr_b16 v[36:37], v6 offset:16384
    v_add_u32 v3, 65536, v3
    ds_read_b128 v[168:171], v3 offset:0
    v_mfma_f32_16x16x32_bf16 v[116:119], v[156:159], v[20:23], v[116:119]
    ds_read_b64_tr_b16 v[38:39], v6 offset:17408
    s_waitcnt lgkmcnt(9)
    v_mfma_f32_16x16x32_bf16 v[120:123], v[152:155], v[24:27], v[120:123]
    v_add_u32 v7, 65536, v7
    ds_read_b64_tr_b16 v[40:41], v7 offset:16384
    ds_read_b128 v[172:175], v3 offset:2048
    v_mfma_f32_16x16x32_bf16 v[124:127], v[156:159], v[24:27], v[124:127]
    ds_read_b64_tr_b16 v[42:43], v7 offset:17408
    s_waitcnt lgkmcnt(7)
    v_mfma_f32_16x16x32_bf16 v[64:67], v[160:163], v[28:31], v[64:67]
    v_add_u32 v8, 65536, v8
    ds_read_b64_tr_b16 v[20:21], v8 offset:16384
    v_mfma_f32_16x16x32_bf16 v[68:71], v[164:167], v[28:31], v[68:71]
    ds_read_b64_tr_b16 v[22:23], v8 offset:17408
    s_waitcnt lgkmcnt(8)
    v_mfma_f32_16x16x32_bf16 v[72:75], v[160:163], v[32:35], v[72:75]
    v_add_u32 v9, 65536, v9
    ds_read_b64_tr_b16 v[24:25], v9 offset:16384
    v_mfma_f32_16x16x32_bf16 v[76:79], v[164:167], v[32:35], v[76:79]
    ds_read_b64_tr_b16 v[26:27], v9 offset:17408
    s_waitcnt lgkmcnt(7)
    v_mfma_f32_16x16x32_bf16 v[80:83], v[160:163], v[36:39], v[80:83]
    v_add_u32 v10, 65536, v10
    ds_read_b64_tr_b16 v[28:29], v10 offset:16384
    v_mfma_f32_16x16x32_bf16 v[84:87], v[164:167], v[36:39], v[84:87]
    ds_read_b64_tr_b16 v[30:31], v10 offset:17408
    s_waitcnt lgkmcnt(6)
    v_mfma_f32_16x16x32_bf16 v[88:91], v[160:163], v[40:43], v[88:91]
    v_add_u32 v11, 65536, v11
    ds_read_b64_tr_b16 v[32:33], v11 offset:16384
    v_mfma_f32_16x16x32_bf16 v[92:95], v[164:167], v[40:43], v[92:95]
    ds_read_b64_tr_b16 v[34:35], v11 offset:17408
    s_waitcnt lgkmcnt(6)
    v_mfma_f32_16x16x32_bf16 v[96:99], v[160:163], v[20:23], v[96:99]
    ds_read_b64_tr_b16 v[36:37], v4 offset:24576
    v_mfma_f32_16x16x32_bf16 v[100:103], v[164:167], v[20:23], v[100:103]
    ds_read_b64_tr_b16 v[38:39], v4 offset:25600
    s_waitcnt lgkmcnt(6)
    v_mfma_f32_16x16x32_bf16 v[104:107], v[160:163], v[24:27], v[104:107]
    ds_read_b64_tr_b16 v[40:41], v5 offset:24576
    v_mfma_f32_16x16x32_bf16 v[108:111], v[164:167], v[24:27], v[108:111]
    ds_read_b64_tr_b16 v[42:43], v5 offset:25600
    s_waitcnt lgkmcnt(6)
    v_mfma_f32_16x16x32_bf16 v[112:115], v[160:163], v[28:31], v[112:115]
    ds_read_b64_tr_b16 v[20:21], v6 offset:24576
    v_mfma_f32_16x16x32_bf16 v[116:119], v[164:167], v[28:31], v[116:119]
    ds_read_b64_tr_b16 v[22:23], v6 offset:25600
    s_waitcnt lgkmcnt(6)
    v_mfma_f32_16x16x32_bf16 v[120:123], v[160:163], v[32:35], v[120:123]
    ds_read_b64_tr_b16 v[24:25], v7 offset:24576
    v_mfma_f32_16x16x32_bf16 v[124:127], v[164:167], v[32:35], v[124:127]
    ds_read_b64_tr_b16 v[26:27], v7 offset:25600
    s_waitcnt lgkmcnt(6)
    v_mfma_f32_16x16x32_bf16 v[64:67], v[168:171], v[36:39], v[64:67]
    ds_read_b64_tr_b16 v[28:29], v8 offset:24576
    v_mfma_f32_16x16x32_bf16 v[68:71], v[172:175], v[36:39], v[68:71]
    ds_read_b64_tr_b16 v[30:31], v8 offset:25600
    s_waitcnt lgkmcnt(6)
    v_mfma_f32_16x16x32_bf16 v[72:75], v[168:171], v[40:43], v[72:75]
    ds_read_b64_tr_b16 v[32:33], v9 offset:24576
    v_mfma_f32_16x16x32_bf16 v[76:79], v[172:175], v[40:43], v[76:79]
    ds_read_b64_tr_b16 v[34:35], v9 offset:25600
    s_waitcnt lgkmcnt(6)
    v_mfma_f32_16x16x32_bf16 v[80:83], v[168:171], v[20:23], v[80:83]
    ds_read_b64_tr_b16 v[36:37], v10 offset:24576
    v_mfma_f32_16x16x32_bf16 v[84:87], v[172:175], v[20:23], v[84:87]
    ds_read_b64_tr_b16 v[38:39], v10 offset:25600
    s_waitcnt lgkmcnt(6)
    v_mfma_f32_16x16x32_bf16 v[88:91], v[168:171], v[24:27], v[88:91]
    ds_read_b64_tr_b16 v[40:41], v11 offset:24576
    v_mfma_f32_16x16x32_bf16 v[92:95], v[172:175], v[24:27], v[92:95]
    ds_read_b64_tr_b16 v[42:43], v11 offset:25600
    s_waitcnt lgkmcnt(6)
    v_mfma_f32_16x16x32_bf16 v[96:99], v[168:171], v[28:31], v[96:99]
    s_barrier
    ds_read_b64_tr_b16 v[20:21], v4 offset:49152
    ds_read_b128 v[176:179], v2 offset:32768
    v_mfma_f32_16x16x32_bf16 v[100:103], v[172:175], v[28:31], v[100:103]
    ds_read_b64_tr_b16 v[22:23], v4 offset:50176
    s_waitcnt lgkmcnt(7)
    v_mfma_f32_16x16x32_bf16 v[104:107], v[168:171], v[32:35], v[104:107]
    ds_read_b64_tr_b16 v[24:25], v5 offset:49152
    ds_read_b128 v[180:183], v2 offset:34816
    v_mfma_f32_16x16x32_bf16 v[108:111], v[172:175], v[32:35], v[108:111]
    ds_read_b64_tr_b16 v[26:27], v5 offset:50176
    s_waitcnt lgkmcnt(8)
    v_mfma_f32_16x16x32_bf16 v[112:115], v[168:171], v[36:39], v[112:115]
    ds_read_b64_tr_b16 v[28:29], v6 offset:49152
    ds_read_b128 v[184:187], v3 offset:32768
    v_mfma_f32_16x16x32_bf16 v[116:119], v[172:175], v[36:39], v[116:119]
    ds_read_b64_tr_b16 v[30:31], v6 offset:50176
    s_waitcnt lgkmcnt(9)
    v_mfma_f32_16x16x32_bf16 v[120:123], v[168:171], v[40:43], v[120:123]
    ds_read_b64_tr_b16 v[32:33], v7 offset:49152
    ds_read_b128 v[188:191], v3 offset:34816
    v_mfma_f32_16x16x32_bf16 v[124:127], v[172:175], v[40:43], v[124:127]
    ds_read_b64_tr_b16 v[34:35], v7 offset:50176
    s_waitcnt lgkmcnt(7)
    v_mfma_f32_16x16x32_bf16 v[64:67], v[176:179], v[20:23], v[64:67]
    ds_read_b64_tr_b16 v[36:37], v8 offset:49152
    v_mfma_f32_16x16x32_bf16 v[68:71], v[180:183], v[20:23], v[68:71]
    ds_read_b64_tr_b16 v[38:39], v8 offset:50176
    s_waitcnt lgkmcnt(8)
    v_mfma_f32_16x16x32_bf16 v[72:75], v[176:179], v[24:27], v[72:75]
    ds_read_b64_tr_b16 v[40:41], v9 offset:49152
    v_mfma_f32_16x16x32_bf16 v[76:79], v[180:183], v[24:27], v[76:79]
    ds_read_b64_tr_b16 v[42:43], v9 offset:50176
    s_waitcnt lgkmcnt(7)
    v_mfma_f32_16x16x32_bf16 v[80:83], v[176:179], v[28:31], v[80:83]
    ds_read_b64_tr_b16 v[20:21], v10 offset:49152
    v_mfma_f32_16x16x32_bf16 v[84:87], v[180:183], v[28:31], v[84:87]
    ds_read_b64_tr_b16 v[22:23], v10 offset:50176
    s_waitcnt lgkmcnt(6)
    v_mfma_f32_16x16x32_bf16 v[88:91], v[176:179], v[32:35], v[88:91]
    ds_read_b64_tr_b16 v[24:25], v11 offset:49152
    v_mfma_f32_16x16x32_bf16 v[92:95], v[180:183], v[32:35], v[92:95]
    ds_read_b64_tr_b16 v[26:27], v11 offset:50176
    s_waitcnt lgkmcnt(6)
    v_mfma_f32_16x16x32_bf16 v[96:99], v[176:179], v[36:39], v[96:99]
    ds_read_b64_tr_b16 v[28:29], v4 offset:57344
    v_mfma_f32_16x16x32_bf16 v[100:103], v[180:183], v[36:39], v[100:103]
    ds_read_b64_tr_b16 v[30:31], v4 offset:58368
    s_waitcnt lgkmcnt(6)
    v_mfma_f32_16x16x32_bf16 v[104:107], v[176:179], v[40:43], v[104:107]
    ds_read_b64_tr_b16 v[32:33], v5 offset:57344
    v_mfma_f32_16x16x32_bf16 v[108:111], v[180:183], v[40:43], v[108:111]
    ds_read_b64_tr_b16 v[34:35], v5 offset:58368
    s_waitcnt lgkmcnt(6)
    v_mfma_f32_16x16x32_bf16 v[112:115], v[176:179], v[20:23], v[112:115]
    ds_read_b64_tr_b16 v[36:37], v6 offset:57344
    v_mfma_f32_16x16x32_bf16 v[116:119], v[180:183], v[20:23], v[116:119]
    ds_read_b64_tr_b16 v[38:39], v6 offset:58368
    s_waitcnt lgkmcnt(6)
    v_mfma_f32_16x16x32_bf16 v[120:123], v[176:179], v[24:27], v[120:123]
    ds_read_b64_tr_b16 v[40:41], v7 offset:57344
    v_mfma_f32_16x16x32_bf16 v[124:127], v[180:183], v[24:27], v[124:127]
    ds_read_b64_tr_b16 v[42:43], v7 offset:58368
    s_waitcnt lgkmcnt(6)
    v_mfma_f32_16x16x32_bf16 v[64:67], v[184:187], v[28:31], v[64:67]
    ds_read_b64_tr_b16 v[20:21], v8 offset:57344
    v_mfma_f32_16x16x32_bf16 v[68:71], v[188:191], v[28:31], v[68:71]
    ds_read_b64_tr_b16 v[22:23], v8 offset:58368
    s_waitcnt lgkmcnt(6)
    s_branch L_pg3x
L_pg3:
    s_setpc_b64 s[6:7]
L_pg3x:
    v_mfma_f32_16x16x32_bf16 v[72:75], v[184:187], v[32:35], v[72:75]
    ds_read_b64_tr_b16 v[24:25], v9 offset:57344
    v_mfma_f32_16x16x32_bf16 v[76:79], v[188:191], v[32:35], v[76:79]
    ds_read_b64_tr_b16 v[26:27], v9 offset:58368
    s_waitcnt lgkmcnt(6)
    v_mfma_f32_16x16x32_bf16 v[80:83], v[184:187], v[36:39], v[80:83]
    ds_read_b64_tr_b16 v[28:29], v10 offset:57344
    v_mfma_f32_16x16x32_bf16 v[84:87], v[188:191], v[36:39], v[84:87]
    ds_read_b64_tr_b16 v[30:31], v10 offset:58368
    s_waitcnt lgkmcnt(6)
    v_mfma_f32_16x16x32_bf16 v[88:91], v[184:187], v[40:43], v[88:91]
    ds_read_b64_tr_b16 v[32:33], v11 offset:57344
    v_mfma_f32_16x16x32_bf16 v[92:95], v[188:191], v[40:43], v[92:95]
    ds_read_b64_tr_b16 v[34:35], v11 offset:58368
    s_waitcnt lgkmcnt(6)
    v_mfma_f32_16x16x32_bf16 v[96:99], v[184:187], v[20:23], v[96:99]
    s_barrier
    v_add_u32 v4, 4294901760, v4
    ds_read_b64_tr_b16 v[36:37], v4 offset:16384
    v_add_u32 v2, 32768, v2
    ds_read_b128 v[192:195], v2 offset:32768
    v_mfma_f32_16x16x32_bf16 v[100:103], v[188:191], v[20:23], v[100:103]
    ds_read_b64_tr_b16 v[38:39], v4 offset:17408
    s_waitcnt lgkmcnt(7)
    v_mfma_f32_16x16x32_bf16 v[104:107], v[184:187], v[24:27], v[104:107]
    v_add_u32 v5, 4294901760, v5
    ds_read_b64_tr_b16 v[40:41], v5 offset:16384
    ds_read_b128 v[196:199], v2 offset:34816
    v_mfma_f32_16x16x32_bf16 v[108:111], v[188:191], v[24:27], v[108:111]
    ds_read_b64_tr_b16 v[42:43], v5 offset:17408
    s_waitcnt lgkmcnt(8)
    v_mfma_f32_16x16x32_bf16 v[112:115], v[184:187], v[28:31], v[112:115]
    v_add_u32 v6, 4294901760, v6
    ds_read_b64_tr_b16 v[20:21], v6 offset:16384
    v_add_u32 v3, 32768, v3
    ds_read_b128 v[200:203], v3 offset:32768
    v_mfma_f32_16x16x32_bf16 v[116:119], v[188:191], v[28:31], v[116:119]
    ds_read_b64_tr_b16 v[22:23], v6 offset:17408
    s_waitcnt lgkmcnt(9)
    v_mfma_f32_16x16x32_bf16 v[120:123], v[184:187], v[32:35], v[120:123]
    v_add_u32 v7, 4294901760, v7
    ds_read_b64_tr_b16 v[24:25], v7 offset:16384
    ds_read_b128 v[204:207], v3 offset:34816
    v_mfma_f32_16x16x32_bf16 v[124:127], v[188:191], v[32:35], v[124:127]
    ds_read_b64_tr_b16 v[26:27], v7 offset:17408
    s_waitcnt lgkmcnt(7)
    v_mfma_f32_16x16x32_bf16 v[64:67], v[192:195], v[36:39], v[64:67]
    v_add_u32 v8, 4294901760, v8
    ds_read_b64_tr_b16 v[28:29], v8 offset:16384
    v_mfma_f32_16x16x32_bf16 v[68:71], v[196:199], v[36:39], v[68:71]
    ds_read_b64_tr_b16 v[30:31], v8 offset:17408
    s_waitcnt lgkmcnt(8)
    v_mfma_f32_16x16x32_bf16 v[72:75], v[192:195], v[40:43], v[72:75]
    v_add_u32 v9, 4294901760, v9
    ds_read_b64_tr_b16 v[32:33], v9 offset:16384
    v_mfma_f32_16x16x32_bf16 v[76:79], v[196:199], v[40:43], v[76:79]
    ds_read_b64_tr_b16 v[34:35], v9 offset:17408
    s_waitcnt lgkmcnt(7)
    v_mfma_f32_16x16x32_bf16 v[80:83], v[192:195], v[20:23], v[80:83]
    v_add_u32 v10, 4294901760, v10
    ds_read_b64_tr_b16 v[36:37], v10 offset:16384
    v_mfma_f32_16x16x32_bf16 v[84:87], v[196:199], v[20:23], v[84:87]
    ds_read_b64_tr_b16 v[38:39], v10 offset:17408
    s_waitcnt lgkmcnt(6)
    v_mfma_f32_16x16x32_bf16 v[88:91], v[192:195], v[24:27], v[88:91]
    v_add_u32 v11, 4294901760, v11
    ds_read_b64_tr_b16 v[40:41], v11 offset:16384
    v_mfma_f32_16x16x32_bf16 v[92:95], v[196:199], v[24:27], v[92:95]
    ds_read_b64_tr_b16 v[42:43], v11 offset:17408
    s_waitcnt lgkmcnt(6)
    v_mfma_f32_16x16x32_bf16 v[96:99], v[192:195], v[28:31], v[96:99]
    ds_read_b64_tr_b16 v[20:21], v4 offset:24576
    v_mfma_f32_16x16x32_bf16 v[100:103], v[196:199], v[28:31], v[100:103]
    ds_read_b64_tr_b16 v[22:23], v4 offset:25600
    s_waitcnt lgkmcnt(6)
    v_mfma_f32_16x16x32_bf16 v[104:107], v[192:195], v[32:35], v[104:107]
    ds_read_b64_tr_b16 v[24:25], v5 offset:24576
    v_mfma_f32_16x16x32_bf16 v[108:111], v[196:199], v[32:35], v[108:111]
    ds_read_b64_tr_b16 v[26:27], v5 offset:25600
    s_waitcnt lgkmcnt(6)
    v_mfma_f32_16x16x32_bf16 v[112:115], v[192:195], v[36:39], v[112:115]
    ds_read_b64_tr_b16 v[28:29], v6 offset:24576
    v_mfma_f32_16x16x32_bf16 v[116:119], v[196:199], v[36:39], v[116:119]
    ds_read_b64_tr_b16 v[30:31], v6 offset:25600
    s_waitcnt lgkmcnt(6)
    v_mfma_f32_16x16x32_bf16 v[120:123], v[192:195], v[40:43], v[120:123]
    ds_read_b64_tr_b16 v[32:33], v7 offset:24576
    v_mfma_f32_16x16x32_bf16 v[124:127], v[196:199], v[40:43], v[124:127]
    ds_read_b64_tr_b16 v[34:35], v7 offset:25600
    s_waitcnt lgkmcnt(6)
    v_mfma_f32_16x16x32_bf16 v[64:67], v[200:203], v[20:23], v[64:67]
    ds_read_b64_tr_b16 v[36:37], v8 offset:24576
    v_mfma_f32_16x16x32_bf16 v[68:71], v[204:207], v[20:23], v[68:71]
    ds_read_b64_tr_b16 v[38:39], v8 offset:25600
    s_waitcnt lgkmcnt(6)
    v_mfma_f32_16x16x32_bf16 v[72:75], v[200:203], v[24:27], v[72:75]
    ds_read_b64_tr_b16 v[40:41], v9 offset:24576
    v_mfma_f32_16x16x32_bf16 v[76:79], v[204:207], v[24:27], v[76:79]
    ds_read_b64_tr_b16 v[42:43], v9 offset:25600
    s_waitcnt lgkmcnt(6)
    v_mfma_f32_16x16x32_bf16 v[80:83], v[200:203], v[28:31], v[80:83]
    ds_read_b64_tr_b16 v[20:21], v10 offset:24576
    v_mfma_f32_16x16x32_bf16 v[84:87], v[204:207], v[28:31], v[84:87]
    ds_read_b64_tr_b16 v[22:23], v10 offset:25600
    s_waitcnt lgkmcnt(6)
    v_mfma_f32_16x16x32_bf16 v[88:91], v[200:203], v[32:35], v[88:91]
    ds_read_b64_tr_b16 v[24:25], v11 offset:24576
    v_mfma_f32_16x16x32_bf16 v[92:95], v[204:207], v[32:35], v[92:95]
    ds_read_b64_tr_b16 v[26:27], v11 offset:25600
    s_waitcnt lgkmcnt(6)
    v_mfma_f32_16x16x32_bf16 v[96:99], v[200:203], v[36:39], v[96:99]
    s_barrier
    ds_read_b64_tr_b16 v[28:29], v4 offset:49152
    v_add_u32 v2, 4294868992, v2
    ds_read_b128 v[208:211], v2 offset:0
    v_mfma_f32_16x16x32_bf16 v[100:103], v[204:207], v[36:39], v[100:103]
    ds_read_b64_tr_b16 v[30:31], v4 offset:50176
    s_waitcnt lgkmcnt(7)
    v_mfma_f32_16x16x32_bf16 v[104:107], v[200:203], v[40:43], v[104:107]
    ds_read_b64_tr_b16 v[32:33], v5 offset:49152
    ds_read_b128 v[212:215], v2 offset:2048
    v_mfma_f32_16x16x32_bf16 v[108:111], v[204:207], v[40:43], v[108:111]
    ds_read_b64_tr_b16 v[34:35], v5 offset:50176
    s_waitcnt lgkmcnt(8)
    v_mfma_f32_16x16x32_bf16 v[112:115], v[200:203], v[20:23], v[112:115]
    ds_read_b64_tr_b16 v[36:37], v6 offset:49152
    v_add_u32 v3, 4294868992, v3
    ds_read_b128 v[216:219], v3 offset:0
    v_mfma_f32_16x16x32_bf16 v[116:119], v[204:207], v[20:23], v[116:119]
    ds_read_b64_tr_b16 v[38:39], v6 offset:50176
    s_waitcnt lgkmcnt(9)
    v_mfma_f32_16x16x32_bf16 v[120:123], v[200:203], v[24:27], v[120:123]
    ds_read_b64_tr_b16 v[40:41], v7 offset:49152
    ds_read_b128 v[220:223], v3 offset:2048
    v_mfma_f32_16x16x32_bf16 v[124:127], v[204:207], v[24:27], v[124:127]
    ds_read_b64_tr_b16 v[42:43], v7 offset:50176
    s_waitcnt lgkmcnt(7)
    v_mfma_f32_16x16x32_bf16 v[64:67], v[208:211], v[28:31], v[64:67]
    ds_read_b64_tr_b16 v[20:21], v8 offset:49152
    v_mfma_f32_16x16x32_bf16 v[68:71], v[212:215], v[28:31], v[68:71]
    ds_read_b64_tr_b16 v[22:23], v8 offset:50176
    s_waitcnt lgkmcnt(8)
    v_mfma_f32_16x16x32_bf16 v[72:75], v[208:211], v[32:35], v[72:75]
    ds_read_b64_tr_b16 v[24:25], v9 offset:49152
    v_mfma_f32_16x16x32_bf16 v[76:79], v[212:215], v[32:35], v[76:79]
    ds_read_b64_tr_b16 v[26:27], v9 offset:50176
    s_waitcnt lgkmcnt(7)
    v_mfma_f32_16x16x32_bf16 v[80:83], v[208:211], v[36:39], v[80:83]
    ds_read_b64_tr_b16 v[28:29], v10 offset:49152
    v_mfma_f32_16x16x32_bf16 v[84:87], v[212:215], v[36:39], v[84:87]
    ds_read_b64_tr_b16 v[30:31], v10 offset:50176
    s_waitcnt lgkmcnt(6)
    v_mfma_f32_16x16x32_bf16 v[88:91], v[208:211], v[40:43], v[88:91]
    ds_read_b64_tr_b16 v[32:33], v11 offset:49152
    v_mfma_f32_16x16x32_bf16 v[92:95], v[212:215], v[40:43], v[92:95]
    ds_read_b64_tr_b16 v[34:35], v11 offset:50176
    s_waitcnt lgkmcnt(6)
    v_mfma_f32_16x16x32_bf16 v[96:99], v[208:211], v[20:23], v[96:99]
    ds_read_b64_tr_b16 v[36:37], v4 offset:57344
    v_mfma_f32_16x16x32_bf16 v[100:103], v[212:215], v[20:23], v[100:103]
    ds_read_b64_tr_b16 v[38:39], v4 offset:58368
    s_waitcnt lgkmcnt(6)
    v_mfma_f32_16x16x32_bf16 v[104:107], v[208:211], v[24:27], v[104:107]
    ds_read_b64_tr_b16 v[40:41], v5 offset:57344
    v_mfma_f32_16x16x32_bf16 v[108:111], v[212:215], v[24:27], v[108:111]
    ds_read_b64_tr_b16 v[42:43], v5 offset:58368
    s_waitcnt lgkmcnt(6)
    v_mfma_f32_16x16x32_bf16 v[112:115], v[208:211], v[28:31], v[112:115]
    ds_read_b64_tr_b16 v[20:21], v6 offset:57344
    v_mfma_f32_16x16x32_bf16 v[116:119], v[212:215], v[28:31], v[116:119]
    ds_read_b64_tr_b16 v[22:23], v6 offset:58368
    s_waitcnt lgkmcnt(6)
    v_mfma_f32_16x16x32_bf16 v[120:123], v[208:211], v[32:35], v[120:123]
    ds_read_b64_tr_b16 v[24:25], v7 offset:57344
    v_mfma_f32_16x16x32_bf16 v[124:127], v[212:215], v[32:35], v[124:127]
    ds_read_b64_tr_b16 v[26:27], v7 offset:58368
    s_waitcnt lgkmcnt(6)
    v_mfma_f32_16x16x32_bf16 v[64:67], v[216:219], v[36:39], v[64:67]
    ds_read_b64_tr_b16 v[28:29], v8 offset:57344
    v_mfma_f32_16x16x32_bf16 v[68:71], v[220:223], v[36:39], v[68:71]
    ds_read_b64_tr_b16 v[30:31], v8 offset:58368
    s_waitcnt lgkmcnt(6)
    v_mfma_f32_16x16x32_bf16 v[72:75], v[216:219], v[40:43], v[72:75]
    ds_read_b64_tr_b16 v[32:33], v9 offset:57344
    v_mfma_f32_16x16x32_bf16 v[76:79], v[220:223], v[40:43], v[76:79]
    ds_read_b64_tr_b16 v[34:35], v9 offset:58368
    s_waitcnt lgkmcnt(6)
    v_mfma_f32_16x16x32_bf16 v[80:83], v[216:219], v[20:23], v[80:83]
    ds_read_b64_tr_b16 v[36:37], v10 offset:57344
    v_mfma_f32_16x16x32_bf16 v[84:87], v[220:223], v[20:23], v[84:87]
    ds_read_b64_tr_b16 v[38:39], v10 offset:58368
    s_waitcnt lgkmcnt(6)
    v_mfma_f32_16x16x32_bf16 v[88:91], v[216:219], v[24:27], v[88:91]
    ds_read_b64_tr_b16 v[40:41], v11 offset:57344
    v_mfma_f32_16x16x32_bf16 v[92:95], v[220:223], v[24:27], v[92:95]
    ds_read_b64_tr_b16 v[42:43], v11 offset:58368
    s_waitcnt lgkmcnt(6)
    v_mfma_f32_16x16x32_bf16 v[96:99], v[216:219], v[28:31], v[96:99]
    s_barrier
    v_add_u32 v4, 65536, v4
    ds_read_b64_tr_b16 v[20:21], v4 offset:0
    ds_read_b128 v[224:227], v2 offset:32768
    v_mfma_f32_16x16x32_bf16 v[100:103], v[220:223], v[28:31], v[100:103]
    ds_read_b64_tr_b16 v[22:23], v4 offset:1024
    s_waitcnt lgkmcnt(7)
    v_mfma_f32_16x16x32_bf16 v[104:107], v[216:219], v[32:35], v[104:107]
    v_add_u32 v5, 65536, v5
    ds_read_b64_tr_b16 v[24:25], v5 offset:0
    ds_read_b128 v[228:231], v2 offset:34816
    v_mfma_f32_16x16x32_bf16 v[108:111], v[220:223], v[32:35], v[108:111]
    ds_read_b64_tr_b16 v[26:27], v5 offset:1024
    s_waitcnt lgkmcnt(8)
    v_mfma_f32_16x16x32_bf16 v[112:115], v[216:219], v[36:39], v[112:115]
    v_add_u32 v6, 65536, v6
    ds_read_b64_tr_b16 v[28:29], v6 offset:0
    ds_read_b128 v[232:235], v3 offset:32768
    v_mfma_f32_16x16x32_bf16 v[116:119], v[220:223], v[36:39], v[116:119]
    ds_read_b64_tr_b16 v[30:31], v6 offset:1024
    s_waitcnt lgkmcnt(9)
    v_mfma_f32_16x16x32_bf16 v[120:123], v[216:219], v[40:43], v[120:123]
    v_add_u32 v7, 65536, v7
    ds_read_b64_tr_b16 v[32:33], v7 offset:0
    ds_read_b128 v[236:239], v3 offset:34816
    v_mfma_f32_16x16x32_bf16 v[124:127], v[220:223], v[40:43], v[124:127]
    ds_read_b64_tr_b16 v[34:35], v7 offset:1024
    s_waitcnt lgkmcnt(7)
    v_mfma_f32_16x16x32_bf16 v[64:67], v[224:227], v[20:23], v[64:67]
    v_add_u32 v8, 65536, v8
    ds_read_b64_tr_b16 v[36:37], v8 offset:0
    v_mfma_f32_16x16x32_bf16 v[68:71], v[228:231], v[20:23], v[68:71]
    ds_read_b64_tr_b16 v[38:39], v8 offset:1024
    s_waitcnt lgkmcnt(8)
    v_mfma_f32_16x16x32_bf16 v[72:75], v[224:227], v[24:27], v[72:75]
    v_add_u32 v9, 65536, v9
    ds_read_b64_tr_b16 v[40:41], v9 offset:0
    v_mfma_f32_16x16x32_bf16 v[76:79], v[228:231], v[24:27], v[76:79]
    ds_read_b64_tr_b16 v[42:43], v9 offset:1024
    s_waitcnt lgkmcnt(7)
    v_mfma_f32_16x16x32_bf16 v[80:83], v[224:227], v[28:31], v[80:83]
    v_add_u32 v10, 65536, v10
    ds_read_b64_tr_b16 v[20:21], v10 offset:0
    v_mfma_f32_16x16x32_bf16 v[84:87], v[228:231], v[28:31], v[84:87]
    ds_read_b64_tr_b16 v[22:23], v10 offset:1024
    s_waitcnt lgkmcnt(6)
    v_mfma_f32_16x16x32_bf16 v[88:91], v[224:227], v[32:35], v[88:91]
    v_add_u32 v11, 65536, v11
    ds_read_b64_tr_b16 v[24:25], v11 offset:0
    v_mfma_f32_16x16x32_bf16 v[92:95], v[228:231], v[32:35], v[92:95]
    ds_read_b64_tr_b16 v[26:27], v11 offset:1024
    s_waitcnt lgkmcnt(6)
    v_mfma_f32_16x16x32_bf16 v[96:99], v[224:227], v[36:39], v[96:99]
    ds_read_b64_tr_b16 v[28:29], v4 offset:8192
    v_mfma_f32_16x16x32_bf16 v[100:103], v[228:231], v[36:39], v[100:103]
    ds_read_b64_tr_b16 v[30:31], v4 offset:9216
    s_waitcnt lgkmcnt(6)
    v_mfma_f32_16x16x32_bf16 v[104:107], v[224:227], v[40:43], v[104:107]
    ds_read_b64_tr_b16 v[32:33], v5 offset:8192
    v_mfma_f32_16x16x32_bf16 v[108:111], v[228:231], v[40:43], v[108:111]
    ds_read_b64_tr_b16 v[34:35], v5 offset:9216
    s_waitcnt lgkmcnt(6)
    v_mfma_f32_16x16x32_bf16 v[112:115], v[224:227], v[20:23], v[112:115]
    ds_read_b64_tr_b16 v[36:37], v6 offset:8192
    v_mfma_f32_16x16x32_bf16 v[116:119], v[228:231], v[20:23], v[116:119]
    ds_read_b64_tr_b16 v[38:39], v6 offset:9216
    s_waitcnt lgkmcnt(6)
    v_mfma_f32_16x16x32_bf16 v[120:123], v[224:227], v[24:27], v[120:123]
    ds_read_b64_tr_b16 v[40:41], v7 offset:8192
    v_mfma_f32_16x16x32_bf16 v[124:127], v[228:231], v[24:27], v[124:127]
    ds_read_b64_tr_b16 v[42:43], v7 offset:9216
    s_waitcnt lgkmcnt(6)
    v_mfma_f32_16x16x32_bf16 v[64:67], v[232:235], v[28:31], v[64:67]
    ds_read_b64_tr_b16 v[20:21], v8 offset:8192
    v_mfma_f32_16x16x32_bf16 v[68:71], v[236:239], v[28:31], v[68:71]
    ds_read_b64_tr_b16 v[22:23], v8 offset:9216
    s_waitcnt lgkmcnt(6)
    v_mfma_f32_16x16x32_bf16 v[72:75], v[232:235], v[32:35], v[72:75]
    ds_read_b64_tr_b16 v[24:25], v9 offset:8192
    v_mfma_f32_16x16x32_bf16 v[76:79], v[236:239], v[32:35], v[76:79]
    ds_read_b64_tr_b16 v[26:27], v9 offset:9216
    s_waitcnt lgkmcnt(6)
    v_mfma_f32_16x16x32_bf16 v[80:83], v[232:235], v[36:39], v[80:83]
    ds_read_b64_tr_b16 v[28:29], v10 offset:8192
    v_mfma_f32_16x16x32_bf16 v[84:87], v[236:239], v[36:39], v[84:87]
    ds_read_b64_tr_b16 v[30:31], v10 offset:9216
    s_waitcnt lgkmcnt(6)
    v_mfma_f32_16x16x32_bf16 v[88:91], v[232:235], v[40:43], v[88:91]
    ds_read_b64_tr_b16 v[32:33], v11 offset:8192
    v_mfma_f32_16x16x32_bf16 v[92:95], v[236:239], v[40:43], v[92:95]
    ds_read_b64_tr_b16 v[34:35], v11 offset:9216
    s_waitcnt lgkmcnt(6)
    v_mfma_f32_16x16x32_bf16 v[96:99], v[232:235], v[20:23], v[96:99]
    s_barrier
    ds_read_b64_tr_b16 v[36:37], v4 offset:32768
    v_add_u32 v2, 65536, v2
    ds_read_b128 v[240:243], v2 offset:16384
    v_mfma_f32_16x16x32_bf16 v[100:103], v[236:239], v[20:23], v[100:103]
    ds_read_b64_tr_b16 v[38:39], v4 offset:33792
    s_waitcnt lgkmcnt(7)
    v_mfma_f32_16x16x32_bf16 v[104:107], v[232:235], v[24:27], v[104:107]
    ds_read_b64_tr_b16 v[40:41], v5 offset:32768
    ds_read_b128 v[244:247], v2 offset:18432
    v_mfma_f32_16x16x32_bf16 v[108:111], v[236:239], v[24:27], v[108:111]
    ds_read_b64_tr_b16 v[42:43], v5 offset:33792
    s_waitcnt lgkmcnt(8)
    v_mfma_f32_16x16x32_bf16 v[112:115], v[232:235], v[28:31], v[112:115]
    ds_read_b64_tr_b16 v[20:21], v6 offset:32768
    v_add_u32 v3, 65536, v3
    ds_read_b128 v[248:251], v3 offset:16384
    v_mfma_f32_16x16x32_bf16 v[116:119], v[236:239], v[28:31], v[116:119]
    ds_read_b64_tr_b16 v[22:23], v6 offset:33792
    s_waitcnt lgkmcnt(9)
    v_mfma_f32_16x16x32_bf16 v[120:123], v[232:235], v[32:35], v[120:123]
    ds_read_b64_tr_b16 v[24:25], v7 offset:32768
    ds_read_b128 v[252:255], v3 offset:18432
    v_mfma_f32_16x16x32_bf16 v[124:127], v[236:239], v[32:35], v[124:127]
    ds_read_b64_tr_b16 v[26:27], v7 offset:33792
    s_waitcnt lgkmcnt(7)
    v_mfma_f32_16x16x32_bf16 v[64:67], v[240:243], v[36:39], v[64:67]
    ds_read_b64_tr_b16 v[28:29], v8 offset:32768
    v_mfma_f32_16x16x32_bf16 v[68:71], v[244:247], v[36:39], v[68:71]
    ds_read_b64_tr_b16 v[30:31], v8 offset:33792
    s_waitcnt lgkmcnt(8)
    v_mfma_f32_16x16x32_bf16 v[72:75], v[240:243], v[40:43], v[72:75]
    ds_read_b64_tr_b16 v[32:33], v9 offset:32768
    v_mfma_f32_16x16x32_bf16 v[76:79], v[244:247], v[40:43], v[76:79]
    ds_read_b64_tr_b16 v[34:35], v9 offset:33792
    s_waitcnt lgkmcnt(7)
    v_mfma_f32_16x16x32_bf16 v[80:83], v[240:243], v[20:23], v[80:83]
    ds_read_b64_tr_b16 v[36:37], v10 offset:32768
    v_mfma_f32_16x16x32_bf16 v[84:87], v[244:247], v[20:23], v[84:87]
    ds_read_b64_tr_b16 v[38:39], v10 offset:33792
    s_waitcnt lgkmcnt(6)
    v_mfma_f32_16x16x32_bf16 v[88:91], v[240:243], v[24:27], v[88:91]
    ds_read_b64_tr_b16 v[40:41], v11 offset:32768
    v_mfma_f32_16x16x32_bf16 v[92:95], v[244:247], v[24:27], v[92:95]
    ds_read_b64_tr_b16 v[42:43], v11 offset:33792
    s_waitcnt lgkmcnt(6)
    v_mfma_f32_16x16x32_bf16 v[96:99], v[240:243], v[28:31], v[96:99]
    ds_read_b64_tr_b16 v[20:21], v4 offset:40960
    v_mfma_f32_16x16x32_bf16 v[100:103], v[244:247], v[28:31], v[100:103]
    ds_read_b64_tr_b16 v[22:23], v4 offset:41984
    s_waitcnt lgkmcnt(6)
    v_mfma_f32_16x16x32_bf16 v[104:107], v[240:243], v[32:35], v[104:107]
    ds_read_b64_tr_b16 v[24:25], v5 offset:40960
    v_mfma_f32_16x16x32_bf16 v[108:111], v[244:247], v[32:35], v[108:111]
    ds_read_b64_tr_b16 v[26:27], v5 offset:41984
    s_waitcnt lgkmcnt(6)
    v_mfma_f32_16x16x32_bf16 v[112:115], v[240:243], v[36:39], v[112:115]
    ds_read_b64_tr_b16 v[28:29], v6 offset:40960
    v_mfma_f32_16x16x32_bf16 v[116:119], v[244:247], v[36:39], v[116:119]
    ds_read_b64_tr_b16 v[30:31], v6 offset:41984
    s_waitcnt lgkmcnt(6)
    v_mfma_f32_16x16x32_bf16 v[120:123], v[240:243], v[40:43], v[120:123]
    ds_read_b64_tr_b16 v[32:33], v7 offset:40960
    v_mfma_f32_16x16x32_bf16 v[124:127], v[244:247], v[40:43], v[124:127]
    ds_read_b64_tr_b16 v[34:35], v7 offset:41984
    s_waitcnt lgkmcnt(6)
    v_mfma_f32_16x16x32_bf16 v[64:67], v[248:251], v[20:23], v[64:67]
    ds_read_b64_tr_b16 v[36:37], v8 offset:40960
    v_mfma_f32_16x16x32_bf16 v[68:71], v[252:255], v[20:23], v[68:71]
    ds_read_b64_tr_b16 v[38:39], v8 offset:41984
    s_waitcnt lgkmcnt(6)
    v_mfma_f32_16x16x32_bf16 v[72:75], v[248:251], v[24:27], v[72:75]
    ds_read_b64_tr_b16 v[40:41], v9 offset:40960
    v_mfma_f32_16x16x32_bf16 v[76:79], v[252:255], v[24:27], v[76:79]
    ds_read_b64_tr_b16 v[42:43], v9 offset:41984
    s_waitcnt lgkmcnt(6)
    v_mfma_f32_16x16x32_bf16 v[80:83], v[248:251], v[28:31], v[80:83]
    ds_read_b64_tr_b16 v[20:21], v10 offset:40960
    v_mfma_f32_16x16x32_bf16 v[84:87], v[252:255], v[28:31], v[84:87]
    ds_read_b64_tr_b16 v[22:23], v10 offset:41984
    s_waitcnt lgkmcnt(6)
    v_mfma_f32_16x16x32_bf16 v[88:91], v[248:251], v[32:35], v[88:91]
    ds_read_b64_tr_b16 v[24:25], v11 offset:40960
    v_mfma_f32_16x16x32_bf16 v[92:95], v[252:255], v[32:35], v[92:95]
    ds_read_b64_tr_b16 v[26:27], v11 offset:41984
    s_waitcnt lgkmcnt(6)
    v_mfma_f32_16x16x32_bf16 v[96:99], v[248:251], v[36:39], v[96:99]
    v_mfma_f32_16x16x32_bf16 v[100:103], v[252:255], v[36:39], v[100:103]
    s_waitcnt lgkmcnt(4)
    v_mfma_f32_16x16x32_bf16 v[104:107], v[248:251], v[40:43], v[104:107]
    v_mfma_f32_16x16x32_bf16 v[108:111], v[252:255], v[40:43], v[108:111]
    s_waitcnt lgkmcnt(2)
    v_mfma_f32_16x16x32_bf16 v[112:115], v[248:251], v[20:23], v[112:115]
    v_mfma_f32_16x16x32_bf16 v[116:119], v[252:255], v[20:23], v[116:119]
    s_waitcnt lgkmcnt(0)
    v_mfma_f32_16x16x32_bf16 v[120:123], v[248:251], v[24:27], v[120:123]
    v_mfma_f32_16x16x32_bf16 v[124:127], v[252:255], v[24:27], v[124:127]
    s_barrier
    s_lshl_b32 s67, s56, 10
    s_add_u32 s67, s67, 0
    v_lshl_add_u32 v2, v1, 4, s67
    v_mov_b32 v44, 0x3f803f80
    v_mov_b32 v45, 0x3f803f80
    v_mov_b32 v46, 0x3f803f80
    v_mov_b32 v47, 0x3f803f80
    v_pk_mul_f32 v[16:17], v[64:65], s[52:53]
    v_pk_mul_f32 v[18:19], v[66:67], s[52:53]
    v_exp_f32_e64 v16, v16 clamp
    v_max_f32 v64, s42, v64
    v_exp_f32_e64 v17, v17 clamp
    v_max_f32 v65, s42, v65
    v_exp_f32_e64 v18, v18 clamp
    v_max_f32 v66, s42, v66
    v_exp_f32_e64 v19, v19 clamp
    v_max_f32 v67, s42, v67
    v_pk_add_f32 v[16:17], v[16:17], v[64:65]
    v_pk_add_f32 v[18:19], v[18:19], v[66:67]
    v_cvt_pk_bf16_f32 v64, v16, v17
    v_cvt_pk_bf16_f32 v65, v18, v19
    v_pk_mul_f32 v[16:17], v[68:69], s[52:53]
    v_pk_mul_f32 v[18:19], v[70:71], s[52:53]
    v_exp_f32_e64 v16, v16 clamp
    v_max_f32 v68, s42, v68
    v_exp_f32_e64 v17, v17 clamp
    v_max_f32 v69, s42, v69
    v_exp_f32_e64 v18, v18 clamp
    v_max_f32 v70, s42, v70
    v_exp_f32_e64 v19, v19 clamp
    v_max_f32 v71, s42, v71
    v_pk_add_f32 v[16:17], v[16:17], v[68:69]
    v_pk_add_f32 v[18:19], v[18:19], v[70:71]
    v_cvt_pk_bf16_f32 v66, v16, v17
    v_cvt_pk_bf16_f32 v67, v18, v19
    v_cvt_pk_bf16_f32 v96, v96, v97
    v_cvt_pk_bf16_f32 v97, v98, v99
    v_cvt_pk_bf16_f32 v98, v100, v101
    v_cvt_pk_bf16_f32 v99, v102, v103
    s_nop 1
    v_mfma_f32_16x16x32_bf16 v[68:71], v[64:67], v[96:99], 0
    v_mfma_f32_16x16x32_bf16 v[100:103], v[44:47], v[64:67], 0
    v_pk_mul_f32 v[16:17], v[72:73], s[52:53]
    v_pk_mul_f32 v[18:19], v[74:75], s[52:53]
    v_exp_f32_e64 v16, v16 clamp
    v_max_f32 v72, s42, v72
    v_exp_f32_e64 v17, v17 clamp
    v_max_f32 v73, s42, v73
    v_exp_f32_e64 v18, v18 clamp
    v_max_f32 v74, s42, v74
    v_exp_f32_e64 v19, v19 clamp
    v_max_f32 v75, s42, v75
    v_pk_add_f32 v[16:17], v[16:17], v[72:73]
    v_pk_add_f32 v[18:19], v[18:19], v[74:75]
    v_cvt_pk_bf16_f32 v72, v16, v17
    v_cvt_pk_bf16_f32 v73, v18, v19
    v_pk_mul_f32 v[16:17], v[76:77], s[52:53]
    v_pk_mul_f32 v[18:19], v[78:79], s[52:53]
    v_exp_f32_e64 v16, v16 clamp
    v_max_f32 v76, s42, v76
    v_exp_f32_e64 v17, v17 clamp
    v_max_f32 v77, s42, v77
    v_exp_f32_e64 v18, v18 clamp
    v_max_f32 v78, s42, v78
    v_exp_f32_e64 v19, v19 clamp
    v_max_f32 v79, s42, v79
    v_pk_add_f32 v[16:17], v[16:17], v[76:77]
    v_pk_add_f32 v[18:19], v[18:19], v[78:79]
    v_cvt_pk_bf16_f32 v74, v16, v17
    v_cvt_pk_bf16_f32 v75, v18, v19
    v_cvt_pk_bf16_f32 v104, v104, v105
    v_cvt_pk_bf16_f32 v105, v106, v107
    v_cvt_pk_bf16_f32 v106, v108, v109
    v_cvt_pk_bf16_f32 v107, v110, v111
    ds_write_b128 v2, v[68:71] offset:0
    s_nop 0
    v_mfma_f32_16x16x32_bf16 v[76:79], v[72:75], v[104:107], 0
    v_mfma_f32_16x16x32_bf16 v[108:111], v[44:47], v[72:75], 0
    v_pk_mul_f32 v[16:17], v[80:81], s[52:53]
    v_pk_mul_f32 v[18:19], v[82:83], s[52:53]
    v_exp_f32_e64 v16, v16 clamp
    v_max_f32 v80, s42, v80
    v_exp_f32_e64 v17, v17 clamp
    v_max_f32 v81, s42, v81
    v_exp_f32_e64 v18, v18 clamp
    v_max_f32 v82, s42, v82
    v_exp_f32_e64 v19, v19 clamp
    v_max_f32 v83, s42, v83
    v_pk_add_f32 v[16:17], v[16:17], v[80:81]
    v_pk_add_f32 v[18:19], v[18:19], v[82:83]
    v_cvt_pk_bf16_f32 v80, v16, v17
    v_cvt_pk_bf16_f32 v81, v18, v19
    v_pk_mul_f32 v[16:17], v[84:85], s[52:53]
    v_pk_mul_f32 v[18:19], v[86:87], s[52:53]
    v_exp_f32_e64 v16, v16 clamp
    v_max_f32 v84, s42, v84
    v_exp_f32_e64 v17, v17 clamp
    v_max_f32 v85, s42, v85
    v_exp_f32_e64 v18, v18 clamp
    v_max_f32 v86, s42, v86
    v_exp_f32_e64 v19, v19 clamp
    v_max_f32 v87, s42, v87
    v_pk_add_f32 v[16:17], v[16:17], v[84:85]
    v_pk_add_f32 v[18:19], v[18:19], v[86:87]
    v_cvt_pk_bf16_f32 v82, v16, v17
    v_cvt_pk_bf16_f32 v83, v18, v19
    v_cvt_pk_bf16_f32 v112, v112, v113
    v_cvt_pk_bf16_f32 v113, v114, v115
    v_cvt_pk_bf16_f32 v114, v116, v117
    v_cvt_pk_bf16_f32 v115, v118, v119
    ds_write_b128 v2, v[76:79] offset:4096
    s_nop 0
    v_mfma_f32_16x16x32_bf16 v[84:87], v[80:83], v[112:115], 0
    v_mfma_f32_16x16x32_bf16 v[116:119], v[44:47], v[80:83], 0
    v_pk_mul_f32 v[16:17], v[88:89], s[52:53]
    v_pk_mul_f32 v[18:19], v[90:91], s[52:53]
    v_exp_f32_e64 v16, v16 clamp
    v_max_f32 v88, s42, v88
    v_exp_f32_e64 v17, v17 clamp
    v_max_f32 v89, s42, v89
    v_exp_f32_e64 v18, v18 clamp
    v_max_f32 v90, s42, v90
    v_exp_f32_e64 v19, v19 clamp
    v_max_f32 v91, s42, v91
    v_pk_add_f32 v[16:17], v[16:17], v[88:89]
    v_pk_add_f32 v[18:19], v[18:19], v[90:91]
    v_cvt_pk_bf16_f32 v88, v16, v17
    v_cvt_pk_bf16_f32 v89, v18, v19
    v_pk_mul_f32 v[16:17], v[92:93], s[52:53]
    v_pk_mul_f32 v[18:19], v[94:95], s[52:53]
    v_exp_f32_e64 v16, v16 clamp
    v_max_f32 v92, s42, v92
    v_exp_f32_e64 v17, v17 clamp
    v_max_f32 v93, s42, v93
    v_exp_f32_e64 v18, v18 clamp
    v_max_f32 v94, s42, v94
    v_exp_f32_e64 v19, v19 clamp
    v_max_f32 v95, s42, v95
    v_pk_add_f32 v[16:17], v[16:17], v[92:93]
    v_pk_add_f32 v[18:19], v[18:19], v[94:95]
    v_cvt_pk_bf16_f32 v90, v16, v17
    v_cvt_pk_bf16_f32 v91, v18, v19
    v_cvt_pk_bf16_f32 v120, v120, v121
    v_cvt_pk_bf16_f32 v121, v122, v123
    v_cvt_pk_bf16_f32 v122, v124, v125
    v_cvt_pk_bf16_f32 v123, v126, v127
    ds_write_b128 v2, v[84:87] offset:8192
    s_nop 0
    v_mfma_f32_16x16x32_bf16 v[92:95], v[88:91], v[120:123], 0
    v_mfma_f32_16x16x32_bf16 v[124:127], v[44:47], v[88:91], 0
    s_lshl_b32 s67, s56, 8
    s_add_u32 s67, s67, 147456
    v_lshlrev_b32 v18, 2, v1
    v_add_u32 v3, s67, v18
    v_cmp_gt_u32 vcc, 16, v1
    v_cmp_gt_u32 s[68:69], 32, v1
    s_nop 0
    ds_write_b128 v2, v[92:95] offset:12288
    v_cndmask_b32 v16, v108, v100, vcc
    v_cmp_gt_u32 vcc, 48, v1
    s_nop 1
    v_cndmask_b32 v17, v124, v116, vcc
    v_cndmask_b32 v16, v17, v16, s[68:69]
    ds_write_b32 v3, v16
    s_waitcnt lgkmcnt(0)
    s_barrier
    s_cmp_ge_u32 s59, 6
    s_cbranch_scc1 SKB_gated__48
    ds_read_b64_tr_b16 v[28:29], v4 offset:49152
    ds_read_b64_tr_b16 v[30:31], v4 offset:50176
    ds_read_b64_tr_b16 v[32:33], v5 offset:49152
    ds_read_b64_tr_b16 v[34:35], v5 offset:50176
    ds_read_b64_tr_b16 v[36:37], v6 offset:49152
    ds_read_b64_tr_b16 v[38:39], v6 offset:50176
    ds_read_b64_tr_b16 v[40:41], v7 offset:49152
    ds_read_b64_tr_b16 v[42:43], v7 offset:50176
    s_waitcnt lgkmcnt(6)
    v_mfma_f32_16x16x32_bf16 v[64:67], v[28:31], v[128:131], 0
    ds_read_b64_tr_b16 v[20:21], v4 offset:57344
    v_mfma_f32_16x16x32_bf16 v[68:71], v[28:31], v[132:135], 0
    ds_read_b64_tr_b16 v[22:23], v4 offset:58368
    s_waitcnt lgkmcnt(6)
    v_mfma_f32_16x16x32_bf16 v[72:75], v[32:35], v[128:131], 0
    ds_read_b64_tr_b16 v[24:25], v5 offset:57344
    v_mfma_f32_16x16x32_bf16 v[76:79], v[32:35], v[132:135], 0
    ds_read_b64_tr_b16 v[26:27], v5 offset:58368
    s_branch L_pg4x
L_pg4:
    s_setpc_b64 s[6:7]
L_pg4x:
    s_waitcnt lgkmcnt(6)
    v_mfma_f32_16x16x32_bf16 v[80:83], v[36:39], v[128:131], 0
    ds_read_b64_tr_b16 v[28:29], v6 offset:57344
    v_mfma_f32_16x16x32_bf16 v[84:87], v[36:39], v[132:135], 0
    ds_read_b64_tr_b16 v[30:31], v6 offset:58368
    s_waitcnt lgkmcnt(6)
    v_mfma_f32_16x16x32_bf16 v[88:91], v[40:43], v[128:131], 0
    ds_read_b64_tr_b16 v[32:33], v7 offset:57344
    v_mfma_f32_16x16x32_bf16 v[92:95], v[40:43], v[132:135], 0
    ds_read_b64_tr_b16 v[34:35], v7 offset:58368
    s_waitcnt lgkmcnt(6)
    v_mfma_f32_16x16x32_bf16 v[64:67], v[20:23], v[136:139], v[64:67]
    ds_read_b64_tr_b16 v[36:37], v8 offset:49152
    v_mfma_f32_16x16x32_bf16 v[68:71], v[20:23], v[140:143], v[68:71]
    ds_read_b64_tr_b16 v[38:39], v8 offset:50176
    s_waitcnt lgkmcnt(6)
    v_mfma_f32_16x16x32_bf16 v[72:75], v[24:27], v[136:139], v[72:75]
    ds_read_b64_tr_b16 v[40:41], v9 offset:49152
    v_mfma_f32_16x16x32_bf16 v[76:79], v[24:27], v[140:143], v[76:79]
    ds_read_b64_tr_b16 v[42:43], v9 offset:50176
    s_waitcnt lgkmcnt(6)
    v_mfma_f32_16x16x32_bf16 v[80:83], v[28:31], v[136:139], v[80:83]
    ds_read_b64_tr_b16 v[20:21], v10 offset:49152
    v_mfma_f32_16x16x32_bf16 v[84:87], v[28:31], v[140:143], v[84:87]
    ds_read_b64_tr_b16 v[22:23], v10 offset:50176
    s_waitcnt lgkmcnt(6)
    v_mfma_f32_16x16x32_bf16 v[88:91], v[32:35], v[136:139], v[88:91]
    ds_read_b64_tr_b16 v[24:25], v11 offset:49152
    v_mfma_f32_16x16x32_bf16 v[92:95], v[32:35], v[140:143], v[92:95]
    ds_read_b64_tr_b16 v[26:27], v11 offset:50176
    s_waitcnt lgkmcnt(6)
    v_mfma_f32_16x16x32_bf16 v[64:67], v[36:39], v[144:147], v[64:67]
    ds_read_b64_tr_b16 v[28:29], v8 offset:57344
    v_mfma_f32_16x16x32_bf16 v[68:71], v[36:39], v[148:151], v[68:71]
    ds_read_b64_tr_b16 v[30:31], v8 offset:58368
    s_waitcnt lgkmcnt(6)
    v_mfma_f32_16x16x32_bf16 v[72:75], v[40:43], v[144:147], v[72:75]
    ds_read_b64_tr_b16 v[32:33], v9 offset:57344
    v_mfma_f32_16x16x32_bf16 v[76:79], v[40:43], v[148:151], v[76:79]
    ds_read_b64_tr_b16 v[34:35], v9 offset:58368
    s_waitcnt lgkmcnt(6)
    v_mfma_f32_16x16x32_bf16 v[80:83], v[20:23], v[144:147], v[80:83]
    ds_read_b64_tr_b16 v[36:37], v10 offset:57344
    v_mfma_f32_16x16x32_bf16 v[84:87], v[20:23], v[148:151], v[84:87]
    ds_read_b64_tr_b16 v[38:39], v10 offset:58368
    s_waitcnt lgkmcnt(6)
    v_mfma_f32_16x16x32_bf16 v[88:91], v[24:27], v[144:147], v[88:91]
    ds_read_b64_tr_b16 v[40:41], v11 offset:57344
    v_mfma_f32_16x16x32_bf16 v[92:95], v[24:27], v[148:151], v[92:95]
    ds_read_b64_tr_b16 v[42:43], v11 offset:58368
    s_waitcnt lgkmcnt(6)
    v_mfma_f32_16x16x32_bf16 v[64:67], v[28:31], v[152:155], v[64:67]
    v_add_u32 v4, 32768, v4
    ds_read_b64_tr_b16 v[20:21], v4 offset:32768
    v_mfma_f32_16x16x32_bf16 v[68:71], v[28:31], v[156:159], v[68:71]
    ds_read_b64_tr_b16 v[22:23], v4 offset:33792
    s_waitcnt lgkmcnt(6)
    v_mfma_f32_16x16x32_bf16 v[72:75], v[32:35], v[152:155], v[72:75]
    v_add_u32 v5, 32768, v5
    ds_read_b64_tr_b16 v[24:25], v5 offset:32768
    v_mfma_f32_16x16x32_bf16 v[76:79], v[32:35], v[156:159], v[76:79]
    ds_read_b64_tr_b16 v[26:27], v5 offset:33792
    s_waitcnt lgkmcnt(6)
    v_mfma_f32_16x16x32_bf16 v[80:83], v[36:39], v[152:155], v[80:83]
    v_add_u32 v6, 32768, v6
    ds_read_b64_tr_b16 v[28:29], v6 offset:32768
    v_mfma_f32_16x16x32_bf16 v[84:87], v[36:39], v[156:159], v[84:87]
    ds_read_b64_tr_b16 v[30:31], v6 offset:33792
    s_waitcnt lgkmcnt(6)
    v_mfma_f32_16x16x32_bf16 v[88:91], v[40:43], v[152:155], v[88:91]
    v_add_u32 v7, 32768, v7
    ds_read_b64_tr_b16 v[32:33], v7 offset:32768
    v_mfma_f32_16x16x32_bf16 v[92:95], v[40:43], v[156:159], v[92:95]
    ds_read_b64_tr_b16 v[34:35], v7 offset:33792
    s_waitcnt lgkmcnt(6)
    v_mfma_f32_16x16x32_bf16 v[64:67], v[20:23], v[160:163], v[64:67]
    ds_read_b64_tr_b16 v[36:37], v4 offset:40960
    v_mfma_f32_16x16x32_bf16 v[68:71], v[20:23], v[164:167], v[68:71]
    ds_read_b64_tr_b16 v[38:39], v4 offset:41984
    s_waitcnt lgkmcnt(6)
    v_mfma_f32_16x16x32_bf16 v[72:75], v[24:27], v[160:163], v[72:75]
    ds_read_b64_tr_b16 v[40:41], v5 offset:40960
    v_mfma_f32_16x16x32_bf16 v[76:79], v[24:27], v[164:167], v[76:79]
    ds_read_b64_tr_b16 v[42:43], v5 offset:41984
    s_waitcnt lgkmcnt(6)
    v_mfma_f32_16x16x32_bf16 v[80:83], v[28:31], v[160:163], v[80:83]
    ds_read_b64_tr_b16 v[20:21], v6 offset:40960
    v_mfma_f32_16x16x32_bf16 v[84:87], v[28:31], v[164:167], v[84:87]
    ds_read_b64_tr_b16 v[22:23], v6 offset:41984
    s_waitcnt lgkmcnt(6)
    v_mfma_f32_16x16x32_bf16 v[88:91], v[32:35], v[160:163], v[88:91]
    ds_read_b64_tr_b16 v[24:25], v7 offset:40960
    v_mfma_f32_16x16x32_bf16 v[92:95], v[32:35], v[164:167], v[92:95]
    ds_read_b64_tr_b16 v[26:27], v7 offset:41984
    s_waitcnt lgkmcnt(6)
    v_mfma_f32_16x16x32_bf16 v[64:67], v[36:39], v[168:171], v[64:67]
    v_add_u32 v8, 32768, v8
    ds_read_b64_tr_b16 v[28:29], v8 offset:32768
    v_mfma_f32_16x16x32_bf16 v[68:71], v[36:39], v[172:175], v[68:71]
    ds_read_b64_tr_b16 v[30:31], v8 offset:33792
    s_waitcnt lgkmcnt(6)
    v_mfma_f32_16x16x32_bf16 v[72:75], v[40:43], v[168:171], v[72:75]
    v_add_u32 v9, 32768, v9
    ds_read_b64_tr_b16 v[32:33], v9 offset:32768
    v_mfma_f32_16x16x32_bf16 v[76:79], v[40:43], v[172:175], v[76:79]
    ds_read_b64_tr_b16 v[34:35], v9 offset:33792
    s_waitcnt lgkmcnt(6)
    v_mfma_f32_16x16x32_bf16 v[80:83], v[20:23], v[168:171], v[80:83]
    v_add_u32 v10, 32768, v10
    ds_read_b64_tr_b16 v[36:37], v10 offset:32768
    v_mfma_f32_16x16x32_bf16 v[84:87], v[20:23], v[172:175], v[84:87]
    ds_read_b64_tr_b16 v[38:39], v10 offset:33792
    s_waitcnt lgkmcnt(6)
    v_mfma_f32_16x16x32_bf16 v[88:91], v[24:27], v[168:171], v[88:91]
    v_add_u32 v11, 32768, v11
    ds_read_b64_tr_b16 v[40:41], v11 offset:32768
    v_mfma_f32_16x16x32_bf16 v[92:95], v[24:27], v[172:175], v[92:95]
    ds_read_b64_tr_b16 v[42:43], v11 offset:33792
    s_waitcnt lgkmcnt(6)
    v_mfma_f32_16x16x32_bf16 v[64:67], v[28:31], v[176:179], v[64:67]
    ds_read_b64_tr_b16 v[20:21], v8 offset:40960
    v_mfma_f32_16x16x32_bf16 v[68:71], v[28:31], v[180:183], v[68:71]
    ds_read_b64_tr_b16 v[22:23], v8 offset:41984
    s_waitcnt lgkmcnt(6)
    v_mfma_f32_16x16x32_bf16 v[72:75], v[32:35], v[176:179], v[72:75]
    ds_read_b64_tr_b16 v[24:25], v9 offset:40960
    v_mfma_f32_16x16x32_bf16 v[76:79], v[32:35], v[180:183], v[76:79]
    ds_read_b64_tr_b16 v[26:27], v9 offset:41984
    s_waitcnt lgkmcnt(6)
    v_mfma_f32_16x16x32_bf16 v[80:83], v[36:39], v[176:179], v[80:83]
    ds_read_b64_tr_b16 v[28:29], v10 offset:40960
    v_mfma_f32_16x16x32_bf16 v[84:87], v[36:39], v[180:183], v[84:87]
    ds_read_b64_tr_b16 v[30:31], v10 offset:41984
    s_waitcnt lgkmcnt(6)
    v_mfma_f32_16x16x32_bf16 v[88:91], v[40:43], v[176:179], v[88:91]
    ds_read_b64_tr_b16 v[32:33], v11 offset:40960
    v_mfma_f32_16x16x32_bf16 v[92:95], v[40:43], v[180:183], v[92:95]
    ds_read_b64_tr_b16 v[34:35], v11 offset:41984
    s_waitcnt lgkmcnt(6)
    v_mfma_f32_16x16x32_bf16 v[64:67], v[20:23], v[184:187], v[64:67]
    v_add_u32 v4, 4294868992, v4
    ds_read_b64_tr_b16 v[36:37], v4 offset:16384
    v_mfma_f32_16x16x32_bf16 v[68:71], v[20:23], v[188:191], v[68:71]
    ds_read_b64_tr_b16 v[38:39], v4 offset:17408
    s_waitcnt lgkmcnt(6)
    v_mfma_f32_16x16x32_bf16 v[72:75], v[24:27], v[184:187], v[72:75]
    v_add_u32 v5, 4294868992, v5
    ds_read_b64_tr_b16 v[40:41], v5 offset:16384
    v_mfma_f32_16x16x32_bf16 v[76:79], v[24:27], v[188:191], v[76:79]
    ds_read_b64_tr_b16 v[42:43], v5 offset:17408
    s_waitcnt lgkmcnt(6)
    v_mfma_f32_16x16x32_bf16 v[80:83], v[28:31], v[184:187], v[80:83]
    v_add_u32 v6, 4294868992, v6
    ds_read_b64_tr_b16 v[20:21], v6 offset:16384
    v_mfma_f32_16x16x32_bf16 v[84:87], v[28:31], v[188:191], v[84:87]
    ds_read_b64_tr_b16 v[22:23], v6 offset:17408
    s_waitcnt lgkmcnt(6)
    v_mfma_f32_16x16x32_bf16 v[88:91], v[32:35], v[184:187], v[88:91]
    v_add_u32 v7, 4294868992, v7
    ds_read_b64_tr_b16 v[24:25], v7 offset:16384
    v_mfma_f32_16x16x32_bf16 v[92:95], v[32:35], v[188:191], v[92:95]
    ds_read_b64_tr_b16 v[26:27], v7 offset:17408
    s_waitcnt lgkmcnt(6)
    v_mfma_f32_16x16x32_bf16 v[64:67], v[36:39], v[192:195], v[64:67]
    ds_read_b64_tr_b16 v[28:29], v4 offset:24576
    v_mfma_f32_16x16x32_bf16 v[68:71], v[36:39], v[196:199], v[68:71]
    ds_read_b64_tr_b16 v[30:31], v4 offset:25600
    s_waitcnt lgkmcnt(6)
    v_mfma_f32_16x16x32_bf16 v[72:75], v[40:43], v[192:195], v[72:75]
    ds_read_b64_tr_b16 v[32:33], v5 offset:24576
    v_mfma_f32_16x16x32_bf16 v[76:79], v[40:43], v[196:199], v[76:79]
    ds_read_b64_tr_b16 v[34:35], v5 offset:25600
    s_waitcnt lgkmcnt(6)
    v_mfma_f32_16x16x32_bf16 v[80:83], v[20:23], v[192:195], v[80:83]
    ds_read_b64_tr_b16 v[36:37], v6 offset:24576
    v_mfma_f32_16x16x32_bf16 v[84:87], v[20:23], v[196:199], v[84:87]
    ds_read_b64_tr_b16 v[38:39], v6 offset:25600
    s_waitcnt lgkmcnt(6)
    v_mfma_f32_16x16x32_bf16 v[88:91], v[24:27], v[192:195], v[88:91]
    ds_read_b64_tr_b16 v[40:41], v7 offset:24576
    v_mfma_f32_16x16x32_bf16 v[92:95], v[24:27], v[196:199], v[92:95]
    ds_read_b64_tr_b16 v[42:43], v7 offset:25600
    s_waitcnt lgkmcnt(6)
    v_mfma_f32_16x16x32_bf16 v[64:67], v[28:31], v[200:203], v[64:67]
    v_add_u32 v8, 4294868992, v8
    ds_read_b64_tr_b16 v[20:21], v8 offset:16384
    v_mfma_f32_16x16x32_bf16 v[68:71], v[28:31], v[204:207], v[68:71]
    ds_read_b64_tr_b16 v[22:23], v8 offset:17408
    s_waitcnt lgkmcnt(6)
    v_mfma_f32_16x16x32_bf16 v[72:75], v[32:35], v[200:203], v[72:75]
    v_add_u32 v9, 4294868992, v9
    ds_read_b64_tr_b16 v[24:25], v9 offset:16384
    v_mfma_f32_16x16x32_bf16 v[76:79], v[32:35], v[204:207], v[76:79]
    ds_read_b64_tr_b16 v[26:27], v9 offset:17408
    s_waitcnt lgkmcnt(6)
    v_mfma_f32_16x16x32_bf16 v[80:83], v[36:39], v[200:203], v[80:83]
    v_add_u32 v10, 4294868992, v10
    ds_read_b64_tr_b16 v[28:29], v10 offset:16384
    v_mfma_f32_16x16x32_bf16 v[84:87], v[36:39], v[204:207], v[84:87]
    ds_read_b64_tr_b16 v[30:31], v10 offset:17408
    s_waitcnt lgkmcnt(6)
    v_mfma_f32_16x16x32_bf16 v[88:91], v[40:43], v[200:203], v[88:91]
    v_add_u32 v11, 4294868992, v11
    ds_read_b64_tr_b16 v[32:33], v11 offset:16384
    v_mfma_f32_16x16x32_bf16 v[92:95], v[40:43], v[204:207], v[92:95]
    ds_read_b64_tr_b16 v[34:35], v11 offset:17408
    s_waitcnt lgkmcnt(6)
    v_mfma_f32_16x16x32_bf16 v[64:67], v[20:23], v[208:211], v[64:67]
    ds_read_b64_tr_b16 v[36:37], v8 offset:24576
    v_mfma_f32_16x16x32_bf16 v[68:71], v[20:23], v[212:215], v[68:71]
    ds_read_b64_tr_b16 v[38:39], v8 offset:25600
    s_waitcnt lgkmcnt(6)
    v_mfma_f32_16x16x32_bf16 v[72:75], v[24:27], v[208:211], v[72:75]
    ds_read_b64_tr_b16 v[40:41], v9 offset:24576
    v_mfma_f32_16x16x32_bf16 v[76:79], v[24:27], v[212:215], v[76:79]
    ds_read_b64_tr_b16 v[42:43], v9 offset:25600
    s_waitcnt lgkmcnt(6)
    v_mfma_f32_16x16x32_bf16 v[80:83], v[28:31], v[208:211], v[80:83]
    ds_read_b64_tr_b16 v[20:21], v10 offset:24576
    v_mfma_f32_16x16x32_bf16 v[84:87], v[28:31], v[212:215], v[84:87]
    ds_read_b64_tr_b16 v[22:23], v10 offset:25600
    s_waitcnt lgkmcnt(6)
    v_mfma_f32_16x16x32_bf16 v[88:91], v[32:35], v[208:211], v[88:91]
    ds_read_b64_tr_b16 v[24:25], v11 offset:24576
    v_mfma_f32_16x16x32_bf16 v[92:95], v[32:35], v[212:215], v[92:95]
    ds_read_b64_tr_b16 v[26:27], v11 offset:25600
    s_waitcnt lgkmcnt(6)
    v_mfma_f32_16x16x32_bf16 v[64:67], v[36:39], v[216:219], v[64:67]
    s_barrier
    ds_read_b64_tr_b16 v[28:29], v4 offset:49152
    v_mfma_f32_16x16x32_bf16 v[68:71], v[36:39], v[220:223], v[68:71]
    ds_read_b64_tr_b16 v[30:31], v4 offset:50176
    s_waitcnt lgkmcnt(6)
    v_mfma_f32_16x16x32_bf16 v[72:75], v[40:43], v[216:219], v[72:75]
    ds_read_b64_tr_b16 v[32:33], v5 offset:49152
    v_mfma_f32_16x16x32_bf16 v[76:79], v[40:43], v[220:223], v[76:79]
    ds_read_b64_tr_b16 v[34:35], v5 offset:50176
    s_waitcnt lgkmcnt(6)
    v_mfma_f32_16x16x32_bf16 v[80:83], v[20:23], v[216:219], v[80:83]
    ds_read_b64_tr_b16 v[36:37], v6 offset:49152
    v_mfma_f32_16x16x32_bf16 v[84:87], v[20:23], v[220:223], v[84:87]
    ds_read_b64_tr_b16 v[38:39], v6 offset:50176
    s_waitcnt lgkmcnt(6)
    v_mfma_f32_16x16x32_bf16 v[88:91], v[24:27], v[216:219], v[88:91]
    ds_read_b64_tr_b16 v[40:41], v7 offset:49152
    v_mfma_f32_16x16x32_bf16 v[92:95], v[24:27], v[220:223], v[92:95]
    ds_read_b64_tr_b16 v[42:43], v7 offset:50176
    s_waitcnt lgkmcnt(6)
    v_mfma_f32_16x16x32_bf16 v[64:67], v[28:31], v[224:227], v[64:67]
    ds_read_b64_tr_b16 v[20:21], v4 offset:57344
    v_mfma_f32_16x16x32_bf16 v[68:71], v[28:31], v[228:231], v[68:71]
    ds_read_b64_tr_b16 v[22:23], v4 offset:58368
    s_waitcnt lgkmcnt(6)
    v_mfma_f32_16x16x32_bf16 v[72:75], v[32:35], v[224:227], v[72:75]
    ds_read_b64_tr_b16 v[24:25], v5 offset:57344
    v_mfma_f32_16x16x32_bf16 v[76:79], v[32:35], v[228:231], v[76:79]
    ds_read_b64_tr_b16 v[26:27], v5 offset:58368
    s_waitcnt lgkmcnt(6)
    v_mfma_f32_16x16x32_bf16 v[80:83], v[36:39], v[224:227], v[80:83]
    ds_read_b64_tr_b16 v[28:29], v6 offset:57344
    v_mfma_f32_16x16x32_bf16 v[84:87], v[36:39], v[228:231], v[84:87]
    ds_read_b64_tr_b16 v[30:31], v6 offset:58368
    s_waitcnt lgkmcnt(6)
    v_mfma_f32_16x16x32_bf16 v[88:91], v[40:43], v[224:227], v[88:91]
    ds_read_b64_tr_b16 v[32:33], v7 offset:57344
    v_mfma_f32_16x16x32_bf16 v[92:95], v[40:43], v[228:231], v[92:95]
    ds_read_b64_tr_b16 v[34:35], v7 offset:58368
    s_waitcnt lgkmcnt(6)
    v_mfma_f32_16x16x32_bf16 v[64:67], v[20:23], v[232:235], v[64:67]
    ds_read_b64_tr_b16 v[36:37], v8 offset:49152
    v_mfma_f32_16x16x32_bf16 v[68:71], v[20:23], v[236:239], v[68:71]
    ds_read_b64_tr_b16 v[38:39], v8 offset:50176
    s_waitcnt lgkmcnt(6)
    v_mfma_f32_16x16x32_bf16 v[72:75], v[24:27], v[232:235], v[72:75]
    ds_read_b64_tr_b16 v[40:41], v9 offset:49152
    v_mfma_f32_16x16x32_bf16 v[76:79], v[24:27], v[236:239], v[76:79]
    ds_read_b64_tr_b16 v[42:43], v9 offset:50176
    s_waitcnt lgkmcnt(6)
    v_mfma_f32_16x16x32_bf16 v[80:83], v[28:31], v[232:235], v[80:83]
    ds_read_b64_tr_b16 v[20:21], v10 offset:49152
    v_mfma_f32_16x16x32_bf16 v[84:87], v[28:31], v[236:239], v[84:87]
    ds_read_b64_tr_b16 v[22:23], v10 offset:50176
    s_waitcnt lgkmcnt(6)
    v_mfma_f32_16x16x32_bf16 v[88:91], v[32:35], v[232:235], v[88:91]
    ds_read_b64_tr_b16 v[24:25], v11 offset:49152
    v_mfma_f32_16x16x32_bf16 v[92:95], v[32:35], v[236:239], v[92:95]
    ds_read_b64_tr_b16 v[26:27], v11 offset:50176
    s_waitcnt lgkmcnt(6)
    v_mfma_f32_16x16x32_bf16 v[64:67], v[36:39], v[240:243], v[64:67]
    ds_read_b64_tr_b16 v[28:29], v8 offset:57344
    v_mfma_f32_16x16x32_bf16 v[68:71], v[36:39], v[244:247], v[68:71]
    ds_read_b64_tr_b16 v[30:31], v8 offset:58368
    s_waitcnt lgkmcnt(6)
    v_mfma_f32_16x16x32_bf16 v[72:75], v[40:43], v[240:243], v[72:75]
    ds_read_b64_tr_b16 v[32:33], v9 offset:57344
    v_mfma_f32_16x16x32_bf16 v[76:79], v[40:43], v[244:247], v[76:79]
    ds_read_b64_tr_b16 v[34:35], v9 offset:58368
    s_waitcnt lgkmcnt(6)
    v_mfma_f32_16x16x32_bf16 v[80:83], v[20:23], v[240:243], v[80:83]
    ds_read_b64_tr_b16 v[36:37], v10 offset:57344
    v_mfma_f32_16x16x32_bf16 v[84:87], v[20:23], v[244:247], v[84:87]
    ds_read_b64_tr_b16 v[38:39], v10 offset:58368
    s_waitcnt lgkmcnt(6)
    v_mfma_f32_16x16x32_bf16 v[88:91], v[24:27], v[240:243], v[88:91]
    ds_read_b64_tr_b16 v[40:41], v11 offset:57344
    v_mfma_f32_16x16x32_bf16 v[92:95], v[24:27], v[244:247], v[92:95]
    ds_read_b64_tr_b16 v[42:43], v11 offset:58368
    s_waitcnt lgkmcnt(6)
    v_mfma_f32_16x16x32_bf16 v[64:67], v[28:31], v[248:251], v[64:67]
    v_mfma_f32_16x16x32_bf16 v[68:71], v[28:31], v[252:255], v[68:71]
    s_waitcnt lgkmcnt(4)
    v_mfma_f32_16x16x32_bf16 v[72:75], v[32:35], v[248:251], v[72:75]
    v_mfma_f32_16x16x32_bf16 v[76:79], v[32:35], v[252:255], v[76:79]
    s_waitcnt lgkmcnt(2)
    v_mfma_f32_16x16x32_bf16 v[80:83], v[36:39], v[248:251], v[80:83]
    v_mfma_f32_16x16x32_bf16 v[84:87], v[36:39], v[252:255], v[84:87]
    s_waitcnt lgkmcnt(0)
    v_mfma_f32_16x16x32_bf16 v[88:91], v[40:43], v[248:251], v[88:91]
    v_mfma_f32_16x16x32_bf16 v[92:95], v[40:43], v[252:255], v[92:95]
    s_barrier
    s_lshl_b32 s69, s59, 12
    s_add_u32 s69, s69, 65536
    v_cvt_pk_bf16_f32 v64, v64, v65
    v_cvt_pk_bf16_f32 v65, v66, v67
    v_cvt_pk_bf16_f32 v66, v72, v73
    v_cvt_pk_bf16_f32 v67, v74, v75
    v_pk_max_i16 v64, v64, 0
    v_pk_max_i16 v65, v65, 0
    v_pk_max_i16 v66, v66, 0
    v_pk_max_i16 v67, v67, 0
    buffer_store_dwordx4 v[64:67], v12, s[24:27], s69 offen offset:0 sc1
    v_cvt_pk_bf16_f32 v68, v68, v69
    v_cvt_pk_bf16_f32 v69, v70, v71
    v_cvt_pk_bf16_f32 v70, v76, v77
    v_cvt_pk_bf16_f32 v71, v78, v79
    v_pk_max_i16 v68, v68, 0
    v_pk_max_i16 v69, v69, 0
    v_pk_max_i16 v70, v70, 0
    v_pk_max_i16 v71, v71, 0
    buffer_store_dwordx4 v[68:71], v12, s[24:27], s69 offen offset:1024 sc1
    v_cvt_pk_bf16_f32 v80, v80, v81
    v_cvt_pk_bf16_f32 v81, v82, v83
    v_cvt_pk_bf16_f32 v82, v88, v89
    v_cvt_pk_bf16_f32 v83, v90, v91
    v_pk_max_i16 v80, v80, 0
    v_pk_max_i16 v81, v81, 0
    v_pk_max_i16 v82, v82, 0
    v_pk_max_i16 v83, v83, 0
    buffer_store_dwordx4 v[80:83], v12, s[24:27], s69 offen offset:2048 sc1
    v_cvt_pk_bf16_f32 v84, v84, v85
    v_cvt_pk_bf16_f32 v85, v86, v87
    v_cvt_pk_bf16_f32 v86, v92, v93
    v_cvt_pk_bf16_f32 v87, v94, v95
    v_pk_max_i16 v84, v84, 0
    v_pk_max_i16 v85, v85, 0
    v_pk_max_i16 v86, v86, 0
    v_pk_max_i16 v87, v87, 0
    buffer_store_dwordx4 v[84:87], v12, s[24:27], s69 offen offset:3072 sc1
    s_branch JB_gated__49
L_st_skip:
    s_setpc_b64 s[6:7]
SKB_gated__48:
    s_cmp_lg_u32 s59, 6
    s_cbranch_scc1 NG_gated__50
    v_lshrrev_b32 v2, 4, v1
    v_lshlrev_b32 v2, 4, v2
    v_add_u32 v2, 148480, v2
    ds_read_b128 v[20:23], v2 offset:0
    ds_read_b128 v[24:27], v2 offset:64
    ds_read_b128 v[28:31], v2 offset:128
    ds_read_b128 v[32:35], v2 offset:192
    ds_read_b128 v[36:39], v2 offset:256
    s_waitcnt lgkmcnt(4)
    v_mfma_f32_16x16x32_bf16 v[64:67], v[20:23], v[128:131], 0
    v_mfma_f32_16x16x32_bf16 v[68:71], v[20:23], v[132:135], 0
    ds_read_b128 v[40:43], v2 offset:320
    s_waitcnt lgkmcnt(4)
    v_mfma_f32_16x16x32_bf16 v[64:67], v[24:27], v[136:139], v[64:67]
    v_mfma_f32_16x16x32_bf16 v[68:71], v[24:27], v[140:143], v[68:71]
    ds_read_b128 v[20:23], v2 offset:384
    s_waitcnt lgkmcnt(4)
    v_mfma_f32_16x16x32_bf16 v[64:67], v[28:31], v[144:147], v[64:67]
    v_mfma_f32_16x16x32_bf16 v[68:71], v[28:31], v[148:151], v[68:71]
    ds_read_b128 v[24:27], v2 offset:448
    s_waitcnt lgkmcnt(4)
    v_mfma_f32_16x16x32_bf16 v[64:67], v[32:35], v[152:155], v[64:67]
    v_mfma_f32_16x16x32_bf16 v[68:71], v[32:35], v[156:159], v[68:71]
    ds_read_b128 v[28:31], v2 offset:512
    s_waitcnt lgkmcnt(4)
    v_mfma_f32_16x16x32_bf16 v[64:67], v[36:39], v[160:163], v[64:67]
    v_mfma_f32_16x16x32_bf16 v[68:71], v[36:39], v[164:167], v[68:71]
    ds_read_b128 v[32:35], v2 offset:576
    s_waitcnt lgkmcnt(4)
    v_mfma_f32_16x16x32_bf16 v[64:67], v[40:43], v[168:171], v[64:67]
    v_mfma_f32_16x16x32_bf16 v[68:71], v[40:43], v[172:175], v[68:71]
    ds_read_b128 v[36:39], v2 offset:640
    s_waitcnt lgkmcnt(4)
    v_mfma_f32_16x16x32_bf16 v[64:67], v[20:23], v[176:179], v[64:67]
    v_mfma_f32_16x16x32_bf16 v[68:71], v[20:23], v[180:183], v[68:71]
    ds_read_b128 v[40:43], v2 offset:704
    s_waitcnt lgkmcnt(4)
    v_mfma_f32_16x16x32_bf16 v[64:67], v[24:27], v[184:187], v[64:67]
    v_mfma_f32_16x16x32_bf16 v[68:71], v[24:27], v[188:191], v[68:71]
    ds_read_b128 v[20:23], v2 offset:768
    s_waitcnt lgkmcnt(4)
    v_mfma_f32_16x16x32_bf16 v[64:67], v[28:31], v[192:195], v[64:67]
    v_mfma_f32_16x16x32_bf16 v[68:71], v[28:31], v[196:199], v[68:71]
    ds_read_b128 v[24:27], v2 offset:832
    s_waitcnt lgkmcnt(4)
    v_mfma_f32_16x16x32_bf16 v[64:67], v[32:35], v[200:203], v[64:67]
    v_mfma_f32_16x16x32_bf16 v[68:71], v[32:35], v[204:207], v[68:71]
    ds_read_b128 v[28:31], v2 offset:896
    s_waitcnt lgkmcnt(4)
    v_mfma_f32_16x16x32_bf16 v[64:67], v[36:39], v[208:211], v[64:67]
    v_mfma_f32_16x16x32_bf16 v[68:71], v[36:39], v[212:215], v[68:71]
    ds_read_b128 v[32:35], v2 offset:960
    s_waitcnt lgkmcnt(4)
    v_mfma_f32_16x16x32_bf16 v[64:67], v[40:43], v[216:219], v[64:67]
    v_mfma_f32_16x16x32_bf16 v[68:71], v[40:43], v[220:223], v[68:71]
    s_waitcnt lgkmcnt(3)
    v_mfma_f32_16x16x32_bf16 v[64:67], v[20:23], v[224:227], v[64:67]
    v_mfma_f32_16x16x32_bf16 v[68:71], v[20:23], v[228:231], v[68:71]
    s_waitcnt lgkmcnt(2)
    v_mfma_f32_16x16x32_bf16 v[64:67], v[24:27], v[232:235], v[64:67]
    v_mfma_f32_16x16x32_bf16 v[68:71], v[24:27], v[236:239], v[68:71]
    s_waitcnt lgkmcnt(1)
    v_mfma_f32_16x16x32_bf16 v[64:67], v[28:31], v[240:243], v[64:67]
    v_mfma_f32_16x16x32_bf16 v[68:71], v[28:31], v[244:247], v[68:71]
    s_waitcnt lgkmcnt(0)
    v_mfma_f32_16x16x32_bf16 v[64:67], v[32:35], v[248:251], v[64:67]
    v_mfma_f32_16x16x32_bf16 v[68:71], v[32:35], v[252:255], v[68:71]
    v_and_b32 v2, 16, v1
    v_cmp_eq_u32 vcc, 0, v2
    v_and_b32 v3, 31, v1
    v_lshlrev_b32 v3, 2, v3
    s_nop 3
    v_cndmask_b32 v2, v68, v64, vcc
    v_mul_f32 v2, 0xbfb8aa3b, v2
    v_exp_f32 v2, v2
    s_nop 0
    v_add_f32 v2, 1.0, v2
    v_rcp_f32 v2, v2
    s_add_u32 s67, s77, 8192
    buffer_store_dword v2, v3, s[24:27], s67 offen sc1
NG_gated__50:
    s_barrier
    s_barrier
    s_branch JB_gated__49
L_st_join:
    s_setpc_b64 s[6:7]
JB_gated__49:
    s_nop 1
    s_lshr_b32 s67, s56, 1
    s_lshl_b32 s67, s67, 13
    v_lshl_add_u32 v2, v1, 4, s67
    v_mov_b32 v4, v14
    v_xor_b32 v5, 32, v14
    v_xor_b32 v6, 128, v14
    v_xor_b32 v7, 160, v14
    s_barrier
    v_add_u32 v2, 98304, v2
    ds_read_b128 v[128:131], v2 offset:32768
    ds_read_b64_tr_b16 v[136:137], v4 offset:32768
    ds_read_b64_tr_b16 v[138:139], v4 offset:36864
    ds_read_b128 v[132:135], v2 offset:33792
    ds_read_b64_tr_b16 v[140:141], v5 offset:32768
    ds_read_b64_tr_b16 v[142:143], v5 offset:36864
    ds_read_b128 v[144:147], v2 offset:34816
    ds_read_b64_tr_b16 v[152:153], v4 offset:40960
    ds_read_b64_tr_b16 v[154:155], v4 offset:45056
    ds_read_b128 v[148:151], v2 offset:35840
    ds_read_b64_tr_b16 v[156:157], v5 offset:40960
    ds_read_b64_tr_b16 v[158:159], v5 offset:45056
    s_waitcnt lgkmcnt(6)
    v_mfma_f32_16x16x32_bf16 v[96:99], v[136:139], v[128:131], 0
    ds_read_b128 v[160:163], v2 offset:36864
    ds_read_b64_tr_b16 v[168:169], v6 offset:32768
    v_mfma_f32_16x16x32_bf16 v[100:103], v[136:139], v[132:135], 0
    ds_read_b64_tr_b16 v[170:171], v6 offset:36864
    ds_read_b128 v[164:167], v2 offset:37888
    v_mfma_f32_16x16x32_bf16 v[104:107], v[140:143], v[128:131], 0
    ds_read_b64_tr_b16 v[172:173], v7 offset:32768
    ds_read_b64_tr_b16 v[174:175], v7 offset:36864
    v_mfma_f32_16x16x32_bf16 v[108:111], v[140:143], v[132:135], 0
    s_waitcnt lgkmcnt(6)
    v_mfma_f32_16x16x32_bf16 v[96:99], v[152:155], v[144:147], v[96:99]
    ds_read_b128 v[176:179], v2 offset:38912
    ds_read_b64_tr_b16 v[184:185], v6 offset:40960
    v_mfma_f32_16x16x32_bf16 v[100:103], v[152:155], v[148:151], v[100:103]
    ds_read_b64_tr_b16 v[186:187], v6 offset:45056
    ds_read_b128 v[180:183], v2 offset:39936
    v_mfma_f32_16x16x32_bf16 v[104:107], v[156:159], v[144:147], v[104:107]
    ds_read_b64_tr_b16 v[188:189], v7 offset:40960
    ds_read_b64_tr_b16 v[190:191], v7 offset:45056
    v_mfma_f32_16x16x32_bf16 v[108:111], v[156:159], v[148:151], v[108:111]
    s_waitcnt lgkmcnt(6)
    v_mfma_f32_16x16x32_bf16 v[96:99], v[168:171], v[160:163], v[96:99]
    v_mfma_f32_16x16x32_bf16 v[100:103], v[168:171], v[164:167], v[100:103]
    v_mfma_f32_16x16x32_bf16 v[104:107], v[172:175], v[160:163], v[104:107]
    v_mfma_f32_16x16x32_bf16 v[108:111], v[172:175], v[164:167], v[108:111]
    s_waitcnt lgkmcnt(0)
    s_barrier
    v_mfma_f32_16x16x32_bf16 v[96:99], v[184:187], v[176:179], v[96:99]
    v_add_u32 v2, 4294868992, v2
    ds_read_b128 v[128:131], v2 offset:16384
    v_add_u32 v4, 65536, v4
    ds_read_b64_tr_b16 v[136:137], v4 offset:0
    ds_read_b64_tr_b16 v[138:139], v4 offset:4096
    v_mfma_f32_16x16x32_bf16 v[100:103], v[184:187], v[180:183], v[100:103]
    ds_read_b128 v[132:135], v2 offset:17408
    v_add_u32 v5, 65536, v5
    ds_read_b64_tr_b16 v[140:141], v5 offset:0
    ds_read_b64_tr_b16 v[142:143], v5 offset:4096
    v_mfma_f32_16x16x32_bf16 v[104:107], v[188:191], v[176:179], v[104:107]
    ds_read_b128 v[144:147], v2 offset:18432
    ds_read_b64_tr_b16 v[152:153], v4 offset:8192
    ds_read_b64_tr_b16 v[154:155], v4 offset:12288
    v_mfma_f32_16x16x32_bf16 v[108:111], v[188:191], v[180:183], v[108:111]
    ds_read_b128 v[148:151], v2 offset:19456
    ds_read_b64_tr_b16 v[156:157], v5 offset:8192
    ds_read_b64_tr_b16 v[158:159], v5 offset:12288
    s_waitcnt lgkmcnt(6)
    v_mfma_f32_16x16x32_bf16 v[96:99], v[136:139], v[128:131], v[96:99]
    ds_read_b128 v[160:163], v2 offset:20480
    v_add_u32 v6, 65536, v6
    ds_read_b64_tr_b16 v[168:169], v6 offset:0
    v_mfma_f32_16x16x32_bf16 v[100:103], v[136:139], v[132:135], v[100:103]
    ds_read_b64_tr_b16 v[170:171], v6 offset:4096
    ds_read_b128 v[164:167], v2 offset:21504
    v_mfma_f32_16x16x32_bf16 v[104:107], v[140:143], v[128:131], v[104:107]
    v_add_u32 v7, 65536, v7
    ds_read_b64_tr_b16 v[172:173], v7 offset:0
    ds_read_b64_tr_b16 v[174:175], v7 offset:4096
    v_mfma_f32_16x16x32_bf16 v[108:111], v[140:143], v[132:135], v[108:111]
    s_waitcnt lgkmcnt(6)
    v_mfma_f32_16x16x32_bf16 v[96:99], v[152:155], v[144:147], v[96:99]
    ds_read_b128 v[176:179], v2 offset:22528
    ds_read_b64_tr_b16 v[184:185], v6 offset:8192
    v_mfma_f32_16x16x32_bf16 v[100:103], v[152:155], v[148:151], v[100:103]
    ds_read_b64_tr_b16 v[186:187], v6 offset:12288
    ds_read_b128 v[180:183], v2 offset:23552
    v_mfma_f32_16x16x32_bf16 v[104:107], v[156:159], v[144:147], v[104:107]
    ds_read_b64_tr_b16 v[188:189], v7 offset:8192
    ds_read_b64_tr_b16 v[190:191], v7 offset:12288
    v_mfma_f32_16x16x32_bf16 v[108:111], v[156:159], v[148:151], v[108:111]
    s_waitcnt lgkmcnt(6)
    v_mfma_f32_16x16x32_bf16 v[96:99], v[168:171], v[160:163], v[96:99]
    v_mfma_f32_16x16x32_bf16 v[100:103], v[168:171], v[164:167], v[100:103]
    v_mfma_f32_16x16x32_bf16 v[104:107], v[172:175], v[160:163], v[104:107]
    v_mfma_f32_16x16x32_bf16 v[108:111], v[172:175], v[164:167], v[108:111]
    s_waitcnt lgkmcnt(0)
    s_waitcnt vmcnt(0)
    s_barrier
    v_mfma_f32_16x16x32_bf16 v[96:99], v[184:187], v[176:179], v[96:99]
    ds_read_b128 v[128:131], v2 offset:49152
    ds_read_b64_tr_b16 v[136:137], v4 offset:16384
    ds_read_b64_tr_b16 v[138:139], v4 offset:20480
    v_mfma_f32_16x16x32_bf16 v[100:103], v[184:187], v[180:183], v[100:103]
    ds_read_b128 v[132:135], v2 offset:50176
    ds_read_b64_tr_b16 v[140:141], v5 offset:16384
    ds_read_b64_tr_b16 v[142:143], v5 offset:20480
    v_mfma_f32_16x16x32_bf16 v[104:107], v[188:191], v[176:179], v[104:107]
    ds_read_b128 v[144:147], v2 offset:51200
    ds_read_b64_tr_b16 v[152:153], v4 offset:24576
    ds_read_b64_tr_b16 v[154:155], v4 offset:28672
    v_mfma_f32_16x16x32_bf16 v[108:111], v[188:191], v[180:183], v[108:111]
    ds_read_b128 v[148:151], v2 offset:52224
    ds_read_b64_tr_b16 v[156:157], v5 offset:24576
    ds_read_b64_tr_b16 v[158:159], v5 offset:28672
    s_waitcnt lgkmcnt(6)
    v_mfma_f32_16x16x32_bf16 v[96:99], v[136:139], v[128:131], v[96:99]
    ds_read_b128 v[160:163], v2 offset:53248
    ds_read_b64_tr_b16 v[168:169], v6 offset:16384
    v_mfma_f32_16x16x32_bf16 v[100:103], v[136:139], v[132:135], v[100:103]
    ds_read_b64_tr_b16 v[170:171], v6 offset:20480
    ds_read_b128 v[164:167], v2 offset:54272
    s_branch L_pg5x
L_pg5:
    s_setpc_b64 s[6:7]
L_pg5x:
    v_mfma_f32_16x16x32_bf16 v[104:107], v[140:143], v[128:131], v[104:107]
    ds_read_b64_tr_b16 v[172:173], v7 offset:16384
    ds_read_b64_tr_b16 v[174:175], v7 offset:20480
    v_mfma_f32_16x16x32_bf16 v[108:111], v[140:143], v[132:135], v[108:111]
    s_waitcnt lgkmcnt(6)
    v_mfma_f32_16x16x32_bf16 v[96:99], v[152:155], v[144:147], v[96:99]
    ds_read_b128 v[176:179], v2 offset:55296
    ds_read_b64_tr_b16 v[184:185], v6 offset:24576
    v_mfma_f32_16x16x32_bf16 v[100:103], v[152:155], v[148:151], v[100:103]
    ds_read_b64_tr_b16 v[186:187], v6 offset:28672
    ds_read_b128 v[180:183], v2 offset:56320
    v_mfma_f32_16x16x32_bf16 v[104:107], v[156:159], v[144:147], v[104:107]
    ds_read_b64_tr_b16 v[188:189], v7 offset:24576
    ds_read_b64_tr_b16 v[190:191], v7 offset:28672
    v_mfma_f32_16x16x32_bf16 v[108:111], v[156:159], v[148:151], v[108:111]
    s_waitcnt lgkmcnt(6)
    v_mfma_f32_16x16x32_bf16 v[96:99], v[168:171], v[160:163], v[96:99]
    v_mfma_f32_16x16x32_bf16 v[100:103], v[168:171], v[164:167], v[100:103]
    v_mfma_f32_16x16x32_bf16 v[104:107], v[172:175], v[160:163], v[104:107]
    v_mfma_f32_16x16x32_bf16 v[108:111], v[172:175], v[164:167], v[108:111]
    s_waitcnt lgkmcnt(0)
    s_barrier
    v_mfma_f32_16x16x32_bf16 v[96:99], v[184:187], v[176:179], v[96:99]
    ds_read_b128 v[128:131], v2 offset:32768
    ds_read_b64_tr_b16 v[136:137], v4 offset:32768
    ds_read_b64_tr_b16 v[138:139], v4 offset:36864
    v_mfma_f32_16x16x32_bf16 v[100:103], v[184:187], v[180:183], v[100:103]
    ds_read_b128 v[132:135], v2 offset:33792
    ds_read_b64_tr_b16 v[140:141], v5 offset:32768
    ds_read_b64_tr_b16 v[142:143], v5 offset:36864
    v_mfma_f32_16x16x32_bf16 v[104:107], v[188:191], v[176:179], v[104:107]
    ds_read_b128 v[144:147], v2 offset:34816
    ds_read_b64_tr_b16 v[152:153], v4 offset:40960
    ds_read_b64_tr_b16 v[154:155], v4 offset:45056
    v_mfma_f32_16x16x32_bf16 v[108:111], v[188:191], v[180:183], v[108:111]
    ds_read_b128 v[148:151], v2 offset:35840
    ds_read_b64_tr_b16 v[156:157], v5 offset:40960
    ds_read_b64_tr_b16 v[158:159], v5 offset:45056
    s_waitcnt lgkmcnt(6)
    v_mfma_f32_16x16x32_bf16 v[96:99], v[136:139], v[128:131], v[96:99]
    ds_read_b128 v[160:163], v2 offset:36864
    ds_read_b64_tr_b16 v[168:169], v6 offset:32768
    v_mfma_f32_16x16x32_bf16 v[100:103], v[136:139], v[132:135], v[100:103]
    ds_read_b64_tr_b16 v[170:171], v6 offset:36864
    ds_read_b128 v[164:167], v2 offset:37888
    v_mfma_f32_16x16x32_bf16 v[104:107], v[140:143], v[128:131], v[104:107]
    ds_read_b64_tr_b16 v[172:173], v7 offset:32768
    ds_read_b64_tr_b16 v[174:175], v7 offset:36864
    v_mfma_f32_16x16x32_bf16 v[108:111], v[140:143], v[132:135], v[108:111]
    s_waitcnt lgkmcnt(6)
    v_mfma_f32_16x16x32_bf16 v[96:99], v[152:155], v[144:147], v[96:99]
    ds_read_b128 v[176:179], v2 offset:38912
    ds_read_b64_tr_b16 v[184:185], v6 offset:40960
    v_mfma_f32_16x16x32_bf16 v[100:103], v[152:155], v[148:151], v[100:103]
    ds_read_b64_tr_b16 v[186:187], v6 offset:45056
    ds_read_b128 v[180:183], v2 offset:39936
    v_mfma_f32_16x16x32_bf16 v[104:107], v[156:159], v[144:147], v[104:107]
    ds_read_b64_tr_b16 v[188:189], v7 offset:40960
    ds_read_b64_tr_b16 v[190:191], v7 offset:45056
    v_mfma_f32_16x16x32_bf16 v[108:111], v[156:159], v[148:151], v[108:111]
    s_waitcnt lgkmcnt(6)
    v_mfma_f32_16x16x32_bf16 v[96:99], v[168:171], v[160:163], v[96:99]
    v_mfma_f32_16x16x32_bf16 v[100:103], v[168:171], v[164:167], v[100:103]
    v_mfma_f32_16x16x32_bf16 v[104:107], v[172:175], v[160:163], v[104:107]
    v_mfma_f32_16x16x32_bf16 v[108:111], v[172:175], v[164:167], v[108:111]
    s_waitcnt lgkmcnt(0)
    s_barrier
    v_mfma_f32_16x16x32_bf16 v[96:99], v[184:187], v[176:179], v[96:99]
    v_add_u32 v2, 98304, v2
    ds_read_b128 v[128:131], v2 offset:32768
    v_add_u32 v4, 4294901760, v4
    ds_read_b64_tr_b16 v[136:137], v4 offset:0
    ds_read_b64_tr_b16 v[138:139], v4 offset:4096
    v_mfma_f32_16x16x32_bf16 v[100:103], v[184:187], v[180:183], v[100:103]
    ds_read_b128 v[132:135], v2 offset:33792
    v_add_u32 v5, 4294901760, v5
    ds_read_b64_tr_b16 v[140:141], v5 offset:0
    ds_read_b64_tr_b16 v[142:143], v5 offset:4096
    v_mfma_f32_16x16x32_bf16 v[104:107], v[188:191], v[176:179], v[104:107]
    ds_read_b128 v[144:147], v2 offset:34816
    ds_read_b64_tr_b16 v[152:153], v4 offset:8192
    ds_read_b64_tr_b16 v[154:155], v4 offset:12288
    v_mfma_f32_16x16x32_bf16 v[108:111], v[188:191], v[180:183], v[108:111]
    ds_read_b128 v[148:151], v2 offset:35840
    ds_read_b64_tr_b16 v[156:157], v5 offset:8192
    ds_read_b64_tr_b16 v[158:159], v5 offset:12288
    s_waitcnt lgkmcnt(6)
    v_mfma_f32_16x16x32_bf16 v[96:99], v[136:139], v[128:131], v[96:99]
    ds_read_b128 v[160:163], v2 offset:36864
    v_add_u32 v6, 4294901760, v6
    ds_read_b64_tr_b16 v[168:169], v6 offset:0
    v_mfma_f32_16x16x32_bf16 v[100:103], v[136:139], v[132:135], v[100:103]
    ds_read_b64_tr_b16 v[170:171], v6 offset:4096
    ds_read_b128 v[164:167], v2 offset:37888
    v_mfma_f32_16x16x32_bf16 v[104:107], v[140:143], v[128:131], v[104:107]
    v_add_u32 v7, 4294901760, v7
    ds_read_b64_tr_b16 v[172:173], v7 offset:0
    ds_read_b64_tr_b16 v[174:175], v7 offset:4096
    v_mfma_f32_16x16x32_bf16 v[108:111], v[140:143], v[132:135], v[108:111]
    s_waitcnt lgkmcnt(6)
    v_mfma_f32_16x16x32_bf16 v[96:99], v[152:155], v[144:147], v[96:99]
    ds_read_b128 v[176:179], v2 offset:38912
    ds_read_b64_tr_b16 v[184:185], v6 offset:8192
    v_mfma_f32_16x16x32_bf16 v[100:103], v[152:155], v[148:151], v[100:103]
    ds_read_b64_tr_b16 v[186:187], v6 offset:12288
    ds_read_b128 v[180:183], v2 offset:39936
    v_mfma_f32_16x16x32_bf16 v[104:107], v[156:159], v[144:147], v[104:107]
    ds_read_b64_tr_b16 v[188:189], v7 offset:8192
    ds_read_b64_tr_b16 v[190:191], v7 offset:12288
    v_mfma_f32_16x16x32_bf16 v[108:111], v[156:159], v[148:151], v[108:111]
    s_waitcnt lgkmcnt(6)
    v_mfma_f32_16x16x32_bf16 v[96:99], v[168:171], v[160:163], v[96:99]
    v_mfma_f32_16x16x32_bf16 v[100:103], v[168:171], v[164:167], v[100:103]
    v_mfma_f32_16x16x32_bf16 v[104:107], v[172:175], v[160:163], v[104:107]
    v_mfma_f32_16x16x32_bf16 v[108:111], v[172:175], v[164:167], v[108:111]
    s_waitcnt lgkmcnt(0)
    s_barrier
    v_mfma_f32_16x16x32_bf16 v[96:99], v[184:187], v[176:179], v[96:99]
    v_add_u32 v2, 4294934528, v2
    ds_read_b128 v[128:131], v2 offset:0
    v_add_u32 v4, 65536, v4
    ds_read_b64_tr_b16 v[136:137], v4 offset:49152
    ds_read_b64_tr_b16 v[138:139], v4 offset:53248
    v_mfma_f32_16x16x32_bf16 v[100:103], v[184:187], v[180:183], v[100:103]
    ds_read_b128 v[132:135], v2 offset:1024
    v_add_u32 v5, 65536, v5
    ds_read_b64_tr_b16 v[140:141], v5 offset:49152
    ds_read_b64_tr_b16 v[142:143], v5 offset:53248
    v_mfma_f32_16x16x32_bf16 v[104:107], v[188:191], v[176:179], v[104:107]
    ds_read_b128 v[144:147], v2 offset:2048
    ds_read_b64_tr_b16 v[152:153], v4 offset:57344
    ds_read_b64_tr_b16 v[154:155], v4 offset:61440
    v_mfma_f32_16x16x32_bf16 v[108:111], v[188:191], v[180:183], v[108:111]
    ds_read_b128 v[148:151], v2 offset:3072
    ds_read_b64_tr_b16 v[156:157], v5 offset:57344
    ds_read_b64_tr_b16 v[158:159], v5 offset:61440
    s_waitcnt lgkmcnt(6)
    v_mfma_f32_16x16x32_bf16 v[96:99], v[136:139], v[128:131], v[96:99]
    ds_read_b128 v[160:163], v2 offset:4096
    v_add_u32 v6, 65536, v6
    ds_read_b64_tr_b16 v[168:169], v6 offset:49152
    v_mfma_f32_16x16x32_bf16 v[100:103], v[136:139], v[132:135], v[100:103]
    ds_read_b64_tr_b16 v[170:171], v6 offset:53248
    ds_read_b128 v[164:167], v2 offset:5120
    v_mfma_f32_16x16x32_bf16 v[104:107], v[140:143], v[128:131], v[104:107]
    v_add_u32 v7, 65536, v7
    ds_read_b64_tr_b16 v[172:173], v7 offset:49152
    ds_read_b64_tr_b16 v[174:175], v7 offset:53248
    v_mfma_f32_16x16x32_bf16 v[108:111], v[140:143], v[132:135], v[108:111]
    s_waitcnt lgkmcnt(6)
    v_mfma_f32_16x16x32_bf16 v[96:99], v[152:155], v[144:147], v[96:99]
    ds_read_b128 v[176:179], v2 offset:6144
    ds_read_b64_tr_b16 v[184:185], v6 offset:57344
    v_mfma_f32_16x16x32_bf16 v[100:103], v[152:155], v[148:151], v[100:103]
    ds_read_b64_tr_b16 v[186:187], v6 offset:61440
    ds_read_b128 v[180:183], v2 offset:7168
    v_mfma_f32_16x16x32_bf16 v[104:107], v[156:159], v[144:147], v[104:107]
    ds_read_b64_tr_b16 v[188:189], v7 offset:57344
    ds_read_b64_tr_b16 v[190:191], v7 offset:61440
    v_mfma_f32_16x16x32_bf16 v[108:111], v[156:159], v[148:151], v[108:111]
    s_waitcnt lgkmcnt(6)
    v_mfma_f32_16x16x32_bf16 v[96:99], v[168:171], v[160:163], v[96:99]
    v_mfma_f32_16x16x32_bf16 v[100:103], v[168:171], v[164:167], v[100:103]
    v_mfma_f32_16x16x32_bf16 v[104:107], v[172:175], v[160:163], v[104:107]
    v_mfma_f32_16x16x32_bf16 v[108:111], v[172:175], v[164:167], v[108:111]
    s_waitcnt lgkmcnt(0)
    s_barrier
    v_mfma_f32_16x16x32_bf16 v[96:99], v[184:187], v[176:179], v[96:99]
    ds_read_b128 v[128:131], v2 offset:16384
    v_add_u32 v4, 4294901760, v4
    ds_read_b64_tr_b16 v[136:137], v4 offset:16384
    ds_read_b64_tr_b16 v[138:139], v4 offset:20480
    v_mfma_f32_16x16x32_bf16 v[100:103], v[184:187], v[180:183], v[100:103]
    ds_read_b128 v[132:135], v2 offset:17408
    v_add_u32 v5, 4294901760, v5
    ds_read_b64_tr_b16 v[140:141], v5 offset:16384
    ds_read_b64_tr_b16 v[142:143], v5 offset:20480
    v_mfma_f32_16x16x32_bf16 v[104:107], v[188:191], v[176:179], v[104:107]
    ds_read_b128 v[144:147], v2 offset:18432
    ds_read_b64_tr_b16 v[152:153], v4 offset:24576
    ds_read_b64_tr_b16 v[154:155], v4 offset:28672
    v_mfma_f32_16x16x32_bf16 v[108:111], v[188:191], v[180:183], v[108:111]
    ds_read_b128 v[148:151], v2 offset:19456
    ds_read_b64_tr_b16 v[156:157], v5 offset:24576
    ds_read_b64_tr_b16 v[158:159], v5 offset:28672
    s_waitcnt lgkmcnt(6)
    v_mfma_f32_16x16x32_bf16 v[96:99], v[136:139], v[128:131], v[96:99]
    ds_read_b128 v[160:163], v2 offset:20480
    v_add_u32 v6, 4294901760, v6
    ds_read_b64_tr_b16 v[168:169], v6 offset:16384
    v_mfma_f32_16x16x32_bf16 v[100:103], v[136:139], v[132:135], v[100:103]
    ds_read_b64_tr_b16 v[170:171], v6 offset:20480
    ds_read_b128 v[164:167], v2 offset:21504
    v_mfma_f32_16x16x32_bf16 v[104:107], v[140:143], v[128:131], v[104:107]
    v_add_u32 v7, 4294901760, v7
    ds_read_b64_tr_b16 v[172:173], v7 offset:16384
    ds_read_b64_tr_b16 v[174:175], v7 offset:20480
    v_mfma_f32_16x16x32_bf16 v[108:111], v[140:143], v[132:135], v[108:111]
    s_waitcnt lgkmcnt(6)
    v_mfma_f32_16x16x32_bf16 v[96:99], v[152:155], v[144:147], v[96:99]
    ds_read_b128 v[176:179], v2 offset:22528
    ds_read_b64_tr_b16 v[184:185], v6 offset:24576
    v_mfma_f32_16x16x32_bf16 v[100:103], v[152:155], v[148:151], v[100:103]
    ds_read_b64_tr_b16 v[186:187], v6 offset:28672
    ds_read_b128 v[180:183], v2 offset:23552
    v_mfma_f32_16x16x32_bf16 v[104:107], v[156:159], v[144:147], v[104:107]
    ds_read_b64_tr_b16 v[188:189], v7 offset:24576
    ds_read_b64_tr_b16 v[190:191], v7 offset:28672
    v_mfma_f32_16x16x32_bf16 v[108:111], v[156:159], v[148:151], v[108:111]
    s_waitcnt lgkmcnt(6)
    v_mfma_f32_16x16x32_bf16 v[96:99], v[168:171], v[160:163], v[96:99]
    v_mfma_f32_16x16x32_bf16 v[100:103], v[168:171], v[164:167], v[100:103]
    v_mfma_f32_16x16x32_bf16 v[104:107], v[172:175], v[160:163], v[104:107]
    v_mfma_f32_16x16x32_bf16 v[108:111], v[172:175], v[164:167], v[108:111]
    s_waitcnt lgkmcnt(0)
    s_barrier
    v_mfma_f32_16x16x32_bf16 v[96:99], v[184:187], v[176:179], v[96:99]
    ds_read_b128 v[128:131], v2 offset:32768
    ds_read_b64_tr_b16 v[136:137], v4 offset:49152
    ds_read_b64_tr_b16 v[138:139], v4 offset:53248
    v_mfma_f32_16x16x32_bf16 v[100:103], v[184:187], v[180:183], v[100:103]
    ds_read_b128 v[132:135], v2 offset:33792
    ds_read_b64_tr_b16 v[140:141], v5 offset:49152
    ds_read_b64_tr_b16 v[142:143], v5 offset:53248
    v_mfma_f32_16x16x32_bf16 v[104:107], v[188:191], v[176:179], v[104:107]
    ds_read_b128 v[144:147], v2 offset:34816
    ds_read_b64_tr_b16 v[152:153], v4 offset:57344
    ds_read_b64_tr_b16 v[154:155], v4 offset:61440
    v_mfma_f32_16x16x32_bf16 v[108:111], v[188:191], v[180:183], v[108:111]
    ds_read_b128 v[148:151], v2 offset:35840
    ds_read_b64_tr_b16 v[156:157], v5 offset:57344
    ds_read_b64_tr_b16 v[158:159], v5 offset:61440
    s_waitcnt lgkmcnt(6)
    v_mfma_f32_16x16x32_bf16 v[96:99], v[136:139], v[128:131], v[96:99]
    ds_read_b128 v[160:163], v2 offset:36864
    ds_read_b64_tr_b16 v[168:169], v6 offset:49152
    v_mfma_f32_16x16x32_bf16 v[100:103], v[136:139], v[132:135], v[100:103]
    ds_read_b64_tr_b16 v[170:171], v6 offset:53248
    ds_read_b128 v[164:167], v2 offset:37888
    v_mfma_f32_16x16x32_bf16 v[104:107], v[140:143], v[128:131], v[104:107]
    ds_read_b64_tr_b16 v[172:173], v7 offset:49152
    ds_read_b64_tr_b16 v[174:175], v7 offset:53248
    v_mfma_f32_16x16x32_bf16 v[108:111], v[140:143], v[132:135], v[108:111]
    s_waitcnt lgkmcnt(6)
    v_mfma_f32_16x16x32_bf16 v[96:99], v[152:155], v[144:147], v[96:99]
    ds_read_b128 v[176:179], v2 offset:38912
    ds_read_b64_tr_b16 v[184:185], v6 offset:57344
    v_mfma_f32_16x16x32_bf16 v[100:103], v[152:155], v[148:151], v[100:103]
    ds_read_b64_tr_b16 v[186:187], v6 offset:61440
    ds_read_b128 v[180:183], v2 offset:39936
    v_mfma_f32_16x16x32_bf16 v[104:107], v[156:159], v[144:147], v[104:107]
    ds_read_b64_tr_b16 v[188:189], v7 offset:57344
    ds_read_b64_tr_b16 v[190:191], v7 offset:61440
    v_mfma_f32_16x16x32_bf16 v[108:111], v[156:159], v[148:151], v[108:111]
    s_waitcnt lgkmcnt(6)
    v_mfma_f32_16x16x32_bf16 v[96:99], v[168:171], v[160:163], v[96:99]
    v_mfma_f32_16x16x32_bf16 v[100:103], v[168:171], v[164:167], v[100:103]
    v_mfma_f32_16x16x32_bf16 v[104:107], v[172:175], v[160:163], v[104:107]
    v_mfma_f32_16x16x32_bf16 v[108:111], v[172:175], v[164:167], v[108:111]
    s_waitcnt lgkmcnt(0)
    s_barrier
    v_mfma_f32_16x16x32_bf16 v[96:99], v[184:187], v[176:179], v[96:99]
    v_add_u32 v2, 4294901760, v2
    ds_read_b128 v[128:131], v2 offset:0
    ds_read_b64_tr_b16 v[136:137], v4 offset:32768
    ds_read_b64_tr_b16 v[138:139], v4 offset:36864
    v_mfma_f32_16x16x32_bf16 v[100:103], v[184:187], v[180:183], v[100:103]
    ds_read_b128 v[132:135], v2 offset:1024
    ds_read_b64_tr_b16 v[140:141], v5 offset:32768
    ds_read_b64_tr_b16 v[142:143], v5 offset:36864
    v_mfma_f32_16x16x32_bf16 v[104:107], v[188:191], v[176:179], v[104:107]
    ds_read_b128 v[144:147], v2 offset:2048
    ds_read_b64_tr_b16 v[152:153], v4 offset:40960
    ds_read_b64_tr_b16 v[154:155], v4 offset:45056
    v_mfma_f32_16x16x32_bf16 v[108:111], v[188:191], v[180:183], v[108:111]
    ds_read_b128 v[148:151], v2 offset:3072
    ds_read_b64_tr_b16 v[156:157], v5 offset:40960
    ds_read_b64_tr_b16 v[158:159], v5 offset:45056
    s_waitcnt lgkmcnt(6)
    v_mfma_f32_16x16x32_bf16 v[96:99], v[136:139], v[128:131], v[96:99]
    ds_read_b128 v[160:163], v2 offset:4096
    ds_read_b64_tr_b16 v[168:169], v6 offset:32768
    v_mfma_f32_16x16x32_bf16 v[100:103], v[136:139], v[132:135], v[100:103]
    ds_read_b64_tr_b16 v[170:171], v6 offset:36864
    ds_read_b128 v[164:167], v2 offset:5120
    v_mfma_f32_16x16x32_bf16 v[104:107], v[140:143], v[128:131], v[104:107]
    ds_read_b64_tr_b16 v[172:173], v7 offset:32768
    ds_read_b64_tr_b16 v[174:175], v7 offset:36864
    v_mfma_f32_16x16x32_bf16 v[108:111], v[140:143], v[132:135], v[108:111]
    s_waitcnt lgkmcnt(6)
    v_mfma_f32_16x16x32_bf16 v[96:99], v[152:155], v[144:147], v[96:99]
    ds_read_b128 v[176:179], v2 offset:6144
    ds_read_b64_tr_b16 v[184:185], v6 offset:40960
    v_mfma_f32_16x16x32_bf16 v[100:103], v[152:155], v[148:151], v[100:103]
    ds_read_b64_tr_b16 v[186:187], v6 offset:45056
    ds_read_b128 v[180:183], v2 offset:7168
    v_mfma_f32_16x16x32_bf16 v[104:107], v[156:159], v[144:147], v[104:107]
    ds_read_b64_tr_b16 v[188:189], v7 offset:40960
    ds_read_b64_tr_b16 v[190:191], v7 offset:45056
    v_mfma_f32_16x16x32_bf16 v[108:111], v[156:159], v[148:151], v[108:111]
    s_waitcnt lgkmcnt(6)
    v_mfma_f32_16x16x32_bf16 v[96:99], v[168:171], v[160:163], v[96:99]
    v_mfma_f32_16x16x32_bf16 v[100:103], v[168:171], v[164:167], v[100:103]
    v_mfma_f32_16x16x32_bf16 v[104:107], v[172:175], v[160:163], v[104:107]
    v_mfma_f32_16x16x32_bf16 v[108:111], v[172:175], v[164:167], v[108:111]
    s_waitcnt lgkmcnt(0)
    s_barrier
    v_mfma_f32_16x16x32_bf16 v[96:99], v[184:187], v[176:179], v[96:99]
    v_add_u32 v2, 65536, v2
    ds_read_b128 v[128:131], v2 offset:49152
    v_add_u32 v4, 98304, v4
    ds_read_b64_tr_b16 v[136:137], v4 offset:32768
    ds_read_b64_tr_b16 v[138:139], v4 offset:36864
    v_mfma_f32_16x16x32_bf16 v[100:103], v[184:187], v[180:183], v[100:103]
    ds_read_b128 v[132:135], v2 offset:50176
    v_add_u32 v5, 98304, v5
    ds_read_b64_tr_b16 v[140:141], v5 offset:32768
    ds_read_b64_tr_b16 v[142:143], v5 offset:36864
    v_mfma_f32_16x16x32_bf16 v[104:107], v[188:191], v[176:179], v[104:107]
    ds_read_b128 v[144:147], v2 offset:51200
    ds_read_b64_tr_b16 v[152:153], v4 offset:40960
    ds_read_b64_tr_b16 v[154:155], v4 offset:45056
    v_mfma_f32_16x16x32_bf16 v[108:111], v[188:191], v[180:183], v[108:111]
    ds_read_b128 v[148:151], v2 offset:52224
    ds_read_b64_tr_b16 v[156:157], v5 offset:40960
    ds_read_b64_tr_b16 v[158:159], v5 offset:45056
    s_lshr_b32 s68, s56, 1
    s_lshl1_add_u32 s67, s60, s68
    s_lshl_b32 s68, s67, 7
    s_add_u32 s68, s68, 8192
    v_and_b32 v16, 15, v1
    v_lshlrev_b32 v17, 2, v16
    buffer_load_dword v8, v17, s[24:27], s68 offen sc1
    buffer_load_dword v10, v17, s[24:27], s68 offen offset:64 sc1
    s_lshl_b32 s67, s67, 15
    s_lshl_b32 s68, s61, 7
    s_add_u32 s67, s67, s68
    s_and_b32 s68, s56, 1
    s_lshl_b32 s68, s68, 6
    s_add_u32 s67, s67, s68
    v_lshl_add_u32 v3, v16, 10, s67
    v_bfe_u32 v16, v1, 4, 1
    v_lshl_add_u32 v3, v16, 5, v3
    v_lshrrev_b32 v16, 5, v1
    v_lshl_add_u32 v3, v16, 4, v3
    s_movk_i32 s69, 0x4000
    s_waitcnt lgkmcnt(6)
    v_mfma_f32_16x16x32_bf16 v[96:99], v[136:139], v[128:131], v[96:99]
    ds_read_b128 v[160:163], v2 offset:53248
    v_add_u32 v6, 98304, v6
    ds_read_b64_tr_b16 v[168:169], v6 offset:32768
    v_mfma_f32_16x16x32_bf16 v[100:103], v[136:139], v[132:135], v[100:103]
    ds_read_b64_tr_b16 v[170:171], v6 offset:36864
    ds_read_b128 v[164:167], v2 offset:54272
    v_mfma_f32_16x16x32_bf16 v[104:107], v[140:143], v[128:131], v[104:107]
    v_add_u32 v7, 98304, v7
    ds_read_b64_tr_b16 v[172:173], v7 offset:32768
    ds_read_b64_tr_b16 v[174:175], v7 offset:36864
    v_mfma_f32_16x16x32_bf16 v[108:111], v[140:143], v[132:135], v[108:111]
    s_waitcnt lgkmcnt(6)
    v_mfma_f32_16x16x32_bf16 v[96:99], v[152:155], v[144:147], v[96:99]
    ds_read_b128 v[176:179], v2 offset:55296
    ds_read_b64_tr_b16 v[184:185], v6 offset:40960
    v_mfma_f32_16x16x32_bf16 v[100:103], v[152:155], v[148:151], v[100:103]
    ds_read_b64_tr_b16 v[186:187], v6 offset:45056
    ds_read_b128 v[180:183], v2 offset:56320
    v_mfma_f32_16x16x32_bf16 v[104:107], v[156:159], v[144:147], v[104:107]
    ds_read_b64_tr_b16 v[188:189], v7 offset:40960
    ds_read_b64_tr_b16 v[190:191], v7 offset:45056
    v_mfma_f32_16x16x32_bf16 v[108:111], v[156:159], v[148:151], v[108:111]
    s_waitcnt lgkmcnt(6)
    v_mfma_f32_16x16x32_bf16 v[96:99], v[168:171], v[160:163], v[96:99]
    v_mfma_f32_16x16x32_bf16 v[100:103], v[168:171], v[164:167], v[100:103]
    v_mfma_f32_16x16x32_bf16 v[104:107], v[172:175], v[160:163], v[104:107]
    v_mfma_f32_16x16x32_bf16 v[108:111], v[172:175], v[164:167], v[108:111]
    s_waitcnt lgkmcnt(0)
    s_barrier
    v_mfma_f32_16x16x32_bf16 v[96:99], v[184:187], v[176:179], v[96:99]
    v_add_u32 v2, 4294901760, v2
    ds_read_b128 v[128:131], v2 offset:16384
    v_add_u32 v4, 4294934528, v4
    ds_read_b64_tr_b16 v[136:137], v4 offset:0
    ds_read_b64_tr_b16 v[138:139], v4 offset:4096
    v_mfma_f32_16x16x32_bf16 v[100:103], v[184:187], v[180:183], v[100:103]
    ds_read_b128 v[132:135], v2 offset:17408
    v_add_u32 v5, 4294934528, v5
    ds_read_b64_tr_b16 v[140:141], v5 offset:0
    ds_read_b64_tr_b16 v[142:143], v5 offset:4096
    v_mfma_f32_16x16x32_bf16 v[104:107], v[188:191], v[176:179], v[104:107]
    ds_read_b128 v[144:147], v2 offset:18432
    ds_read_b64_tr_b16 v[152:153], v4 offset:8192
    ds_read_b64_tr_b16 v[154:155], v4 offset:12288
    v_mfma_f32_16x16x32_bf16 v[108:111], v[188:191], v[180:183], v[108:111]
    ds_read_b128 v[148:151], v2 offset:19456
    ds_read_b64_tr_b16 v[156:157], v5 offset:8192
    ds_read_b64_tr_b16 v[158:159], v5 offset:12288
    s_waitcnt lgkmcnt(6)
    v_mfma_f32_16x16x32_bf16 v[96:99], v[136:139], v[128:131], v[96:99]
    ds_read_b128 v[160:163], v2 offset:20480
    v_add_u32 v6, 4294934528, v6
    ds_read_b64_tr_b16 v[168:169], v6 offset:0
    v_mfma_f32_16x16x32_bf16 v[100:103], v[136:139], v[132:135], v[100:103]
    ds_read_b64_tr_b16 v[170:171], v6 offset:4096
    ds_read_b128 v[164:167], v2 offset:21504
    v_mfma_f32_16x16x32_bf16 v[104:107], v[140:143], v[128:131], v[104:107]
    v_add_u32 v7, 4294934528, v7
    ds_read_b64_tr_b16 v[172:173], v7 offset:0
    ds_read_b64_tr_b16 v[174:175], v7 offset:4096
    v_mfma_f32_16x16x32_bf16 v[108:111], v[140:143], v[132:135], v[108:111]
    s_waitcnt lgkmcnt(6)
    v_mfma_f32_16x16x32_bf16 v[96:99], v[152:155], v[144:147], v[96:99]
    ds_read_b128 v[176:179], v2 offset:22528
    ds_read_b64_tr_b16 v[184:185], v6 offset:8192
    v_mfma_f32_16x16x32_bf16 v[100:103], v[152:155], v[148:151], v[100:103]
    ds_read_b64_tr_b16 v[186:187], v6 offset:12288
    ds_read_b128 v[180:183], v2 offset:23552
    v_mfma_f32_16x16x32_bf16 v[104:107], v[156:159], v[144:147], v[104:107]
    ds_read_b64_tr_b16 v[188:189], v7 offset:8192
    ds_read_b64_tr_b16 v[190:191], v7 offset:12288
    v_mfma_f32_16x16x32_bf16 v[108:111], v[156:159], v[148:151], v[108:111]
    s_waitcnt lgkmcnt(6)
    v_mfma_f32_16x16x32_bf16 v[96:99], v[168:171], v[160:163], v[96:99]
    v_mfma_f32_16x16x32_bf16 v[100:103], v[168:171], v[164:167], v[100:103]
    v_mfma_f32_16x16x32_bf16 v[104:107], v[172:175], v[160:163], v[104:107]
    v_mfma_f32_16x16x32_bf16 v[108:111], v[172:175], v[164:167], v[108:111]
    s_waitcnt lgkmcnt(0)
    s_barrier
    v_mfma_f32_16x16x32_bf16 v[96:99], v[184:187], v[176:179], v[96:99]
    v_add_u32 v2, 65536, v2
    ds_read_b128 v[128:131], v2 offset:32768
    ds_read_b64_tr_b16 v[136:137], v4 offset:16384
    ds_read_b64_tr_b16 v[138:139], v4 offset:20480
    v_mfma_f32_16x16x32_bf16 v[100:103], v[184:187], v[180:183], v[100:103]
    ds_read_b128 v[132:135], v2 offset:33792
    ds_read_b64_tr_b16 v[140:141], v5 offset:16384
    ds_read_b64_tr_b16 v[142:143], v5 offset:20480
    v_mfma_f32_16x16x32_bf16 v[104:107], v[188:191], v[176:179], v[104:107]
    ds_read_b128 v[144:147], v2 offset:34816
    ds_read_b64_tr_b16 v[152:153], v4 offset:24576
    ds_read_b64_tr_b16 v[154:155], v4 offset:28672
    v_mfma_f32_16x16x32_bf16 v[108:111], v[188:191], v[180:183], v[108:111]
    ds_read_b128 v[148:151], v2 offset:35840
    ds_read_b64_tr_b16 v[156:157], v5 offset:24576
    ds_read_b64_tr_b16 v[158:159], v5 offset:28672
    s_waitcnt lgkmcnt(6)
    v_mfma_f32_16x16x32_bf16 v[112:115], v[136:139], v[128:131], 0
    ds_read_b128 v[160:163], v2 offset:36864
    ds_read_b64_tr_b16 v[168:169], v6 offset:16384
    v_mfma_f32_16x16x32_bf16 v[116:119], v[136:139], v[132:135], 0
    ds_read_b64_tr_b16 v[170:171], v6 offset:20480
    ds_read_b128 v[164:167], v2 offset:37888
    v_mfma_f32_16x16x32_bf16 v[120:123], v[140:143], v[128:131], 0
    ds_read_b64_tr_b16 v[172:173], v7 offset:16384
    ds_read_b64_tr_b16 v[174:175], v7 offset:20480
    v_mfma_f32_16x16x32_bf16 v[124:127], v[140:143], v[132:135], 0
    s_waitcnt lgkmcnt(6)
    v_mfma_f32_16x16x32_bf16 v[112:115], v[152:155], v[144:147], v[112:115]
    ds_read_b128 v[176:179], v2 offset:38912
    ds_read_b64_tr_b16 v[184:185], v6 offset:24576
    v_mfma_f32_16x16x32_bf16 v[116:119], v[152:155], v[148:151], v[116:119]
    ds_read_b64_tr_b16 v[186:187], v6 offset:28672
    ds_read_b128 v[180:183], v2 offset:39936
    v_mfma_f32_16x16x32_bf16 v[120:123], v[156:159], v[144:147], v[120:123]
    ds_read_b64_tr_b16 v[188:189], v7 offset:24576
    ds_read_b64_tr_b16 v[190:191], v7 offset:28672
    v_mfma_f32_16x16x32_bf16 v[124:127], v[156:159], v[148:151], v[124:127]
    s_waitcnt lgkmcnt(6)
    v_mfma_f32_16x16x32_bf16 v[112:115], v[168:171], v[160:163], v[112:115]
    v_mfma_f32_16x16x32_bf16 v[116:119], v[168:171], v[164:167], v[116:119]
    v_mfma_f32_16x16x32_bf16 v[120:123], v[172:175], v[160:163], v[120:123]
    v_mfma_f32_16x16x32_bf16 v[124:127], v[172:175], v[164:167], v[124:127]
    s_waitcnt lgkmcnt(0)
    s_barrier
    v_mfma_f32_16x16x32_bf16 v[112:115], v[184:187], v[176:179], v[112:115]
    v_add_u32 v2, 4294901760, v2
    ds_read_b128 v[128:131], v2 offset:0
    v_add_u32 v4, 4294901760, v4
    ds_read_b64_tr_b16 v[136:137], v4 offset:49152
    ds_read_b64_tr_b16 v[138:139], v4 offset:53248
    v_mfma_f32_16x16x32_bf16 v[116:119], v[184:187], v[180:183], v[116:119]
    ds_read_b128 v[132:135], v2 offset:1024
    v_add_u32 v5, 4294901760, v5
    ds_read_b64_tr_b16 v[140:141], v5 offset:49152
    ds_read_b64_tr_b16 v[142:143], v5 offset:53248
    v_mfma_f32_16x16x32_bf16 v[120:123], v[188:191], v[176:179], v[120:123]
    ds_read_b128 v[144:147], v2 offset:2048
    ds_read_b64_tr_b16 v[152:153], v4 offset:57344
    ds_read_b64_tr_b16 v[154:155], v4 offset:61440
    v_mfma_f32_16x16x32_bf16 v[124:127], v[188:191], v[180:183], v[124:127]
    ds_read_b128 v[148:151], v2 offset:3072
    ds_read_b64_tr_b16 v[156:157], v5 offset:57344
    ds_read_b64_tr_b16 v[158:159], v5 offset:61440
    s_waitcnt vmcnt(0)
    v_sub_f32 v16, 1.0, v8
    v_sub_f32 v17, 1.0, v10
    v_mul_f32 v96, v16, v96
    v_mul_f32 v97, v16, v97
    v_mul_f32 v98, v16, v98
    v_mul_f32 v99, v16, v99
    v_mul_f32 v100, v17, v100
    v_mul_f32 v101, v17, v101
    v_mul_f32 v102, v17, v102
    v_mul_f32 v103, v17, v103
    v_mul_f32 v104, v16, v104
    v_mul_f32 v105, v16, v105
    v_mul_f32 v106, v16, v106
    v_mul_f32 v107, v16, v107
    v_mul_f32 v108, v17, v108
    v_mul_f32 v109, v17, v109
    v_mul_f32 v110, v17, v110
    v_mul_f32 v111, v17, v111
    s_waitcnt lgkmcnt(6)
    v_mfma_f32_16x16x32_bf16 v[112:115], v[136:139], v[128:131], v[112:115]
    ds_read_b128 v[160:163], v2 offset:4096
    v_add_u32 v6, 4294901760, v6
    ds_read_b64_tr_b16 v[168:169], v6 offset:49152
    v_mfma_f32_16x16x32_bf16 v[116:119], v[136:139], v[132:135], v[116:119]
    ds_read_b64_tr_b16 v[170:171], v6 offset:53248
    ds_read_b128 v[164:167], v2 offset:5120
    v_mfma_f32_16x16x32_bf16 v[120:123], v[140:143], v[128:131], v[120:123]
    v_add_u32 v7, 4294901760, v7
    ds_read_b64_tr_b16 v[172:173], v7 offset:49152
    ds_read_b64_tr_b16 v[174:175], v7 offset:53248
    v_mfma_f32_16x16x32_bf16 v[124:127], v[140:143], v[132:135], v[124:127]
    s_waitcnt lgkmcnt(6)
    v_mfma_f32_16x16x32_bf16 v[112:115], v[152:155], v[144:147], v[112:115]
    ds_read_b128 v[176:179], v2 offset:6144
    ds_read_b64_tr_b16 v[184:185], v6 offset:57344
    v_mfma_f32_16x16x32_bf16 v[116:119], v[152:155], v[148:151], v[116:119]
    ds_read_b64_tr_b16 v[186:187], v6 offset:61440
    ds_read_b128 v[180:183], v2 offset:7168
    v_mfma_f32_16x16x32_bf16 v[120:123], v[156:159], v[144:147], v[120:123]
    ds_read_b64_tr_b16 v[188:189], v7 offset:57344
    ds_read_b64_tr_b16 v[190:191], v7 offset:61440
    v_mfma_f32_16x16x32_bf16 v[124:127], v[156:159], v[148:151], v[124:127]
    s_waitcnt lgkmcnt(6)
    v_mfma_f32_16x16x32_bf16 v[112:115], v[168:171], v[160:163], v[112:115]
    v_mfma_f32_16x16x32_bf16 v[116:119], v[168:171], v[164:167], v[116:119]
    v_mfma_f32_16x16x32_bf16 v[120:123], v[172:175], v[160:163], v[120:123]
    v_mfma_f32_16x16x32_bf16 v[124:127], v[172:175], v[164:167], v[124:127]
    s_waitcnt lgkmcnt(0)
    s_barrier
    v_mfma_f32_16x16x32_bf16 v[112:115], v[184:187], v[176:179], v[112:115]
    v_add_u32 v2, 65536, v2
    ds_read_b128 v[128:131], v2 offset:49152
    ds_read_b64_tr_b16 v[136:137], v4 offset:32768
    ds_read_b64_tr_b16 v[138:139], v4 offset:36864
    v_mfma_f32_16x16x32_bf16 v[116:119], v[184:187], v[180:183], v[116:119]
    ds_read_b128 v[132:135], v2 offset:50176
    ds_read_b64_tr_b16 v[140:141], v5 offset:32768
    ds_read_b64_tr_b16 v[142:143], v5 offset:36864
    v_mfma_f32_16x16x32_bf16 v[120:123], v[188:191], v[176:179], v[120:123]
    ds_read_b128 v[144:147], v2 offset:51200
    ds_read_b64_tr_b16 v[152:153], v4 offset:40960
    s_branch L_pg6x
L_pg6:
    s_setpc_b64 s[6:7]
L_pg6x:
    ds_read_b64_tr_b16 v[154:155], v4 offset:45056
    v_mfma_f32_16x16x32_bf16 v[124:127], v[188:191], v[180:183], v[124:127]
    ds_read_b128 v[148:151], v2 offset:52224
    ds_read_b64_tr_b16 v[156:157], v5 offset:40960
    ds_read_b64_tr_b16 v[158:159], v5 offset:45056
    s_waitcnt lgkmcnt(6)
    v_mfma_f32_16x16x32_bf16 v[112:115], v[136:139], v[128:131], v[112:115]
    ds_read_b128 v[160:163], v2 offset:53248
    ds_read_b64_tr_b16 v[168:169], v6 offset:32768
    v_mfma_f32_16x16x32_bf16 v[116:119], v[136:139], v[132:135], v[116:119]
    ds_read_b64_tr_b16 v[170:171], v6 offset:36864
    ds_read_b128 v[164:167], v2 offset:54272
    v_mfma_f32_16x16x32_bf16 v[120:123], v[140:143], v[128:131], v[120:123]
    ds_read_b64_tr_b16 v[172:173], v7 offset:32768
    ds_read_b64_tr_b16 v[174:175], v7 offset:36864
    v_mfma_f32_16x16x32_bf16 v[124:127], v[140:143], v[132:135], v[124:127]
    s_waitcnt lgkmcnt(6)
    v_mfma_f32_16x16x32_bf16 v[112:115], v[152:155], v[144:147], v[112:115]
    ds_read_b128 v[176:179], v2 offset:55296
    ds_read_b64_tr_b16 v[184:185], v6 offset:40960
    v_mfma_f32_16x16x32_bf16 v[116:119], v[152:155], v[148:151], v[116:119]
    ds_read_b64_tr_b16 v[186:187], v6 offset:45056
    ds_read_b128 v[180:183], v2 offset:56320
    v_mfma_f32_16x16x32_bf16 v[120:123], v[156:159], v[144:147], v[120:123]
    ds_read_b64_tr_b16 v[188:189], v7 offset:40960
    ds_read_b64_tr_b16 v[190:191], v7 offset:45056
    v_mfma_f32_16x16x32_bf16 v[124:127], v[156:159], v[148:151], v[124:127]
    s_waitcnt lgkmcnt(6)
    v_mfma_f32_16x16x32_bf16 v[112:115], v[168:171], v[160:163], v[112:115]
    v_mfma_f32_16x16x32_bf16 v[116:119], v[168:171], v[164:167], v[116:119]
    v_mfma_f32_16x16x32_bf16 v[120:123], v[172:175], v[160:163], v[120:123]
    v_mfma_f32_16x16x32_bf16 v[124:127], v[172:175], v[164:167], v[124:127]
    s_waitcnt lgkmcnt(0)
    s_barrier
    v_mfma_f32_16x16x32_bf16 v[112:115], v[184:187], v[176:179], v[112:115]
    ds_read_b128 v[128:131], v2 offset:0
    v_add_u32 v4, 98304, v4
    ds_read_b64_tr_b16 v[136:137], v4 offset:32768
    ds_read_b64_tr_b16 v[138:139], v4 offset:36864
    v_mfma_f32_16x16x32_bf16 v[116:119], v[184:187], v[180:183], v[116:119]
    ds_read_b128 v[132:135], v2 offset:1024
    v_add_u32 v5, 98304, v5
    ds_read_b64_tr_b16 v[140:141], v5 offset:32768
    ds_read_b64_tr_b16 v[142:143], v5 offset:36864
    v_mfma_f32_16x16x32_bf16 v[120:123], v[188:191], v[176:179], v[120:123]
    ds_read_b128 v[144:147], v2 offset:2048
    ds_read_b64_tr_b16 v[152:153], v4 offset:40960
    ds_read_b64_tr_b16 v[154:155], v4 offset:45056
    v_mfma_f32_16x16x32_bf16 v[124:127], v[188:191], v[180:183], v[124:127]
    ds_read_b128 v[148:151], v2 offset:3072
    ds_read_b64_tr_b16 v[156:157], v5 offset:40960
    ds_read_b64_tr_b16 v[158:159], v5 offset:45056
    s_waitcnt lgkmcnt(6)
    v_mfma_f32_16x16x32_bf16 v[112:115], v[136:139], v[128:131], v[112:115]
    ds_read_b128 v[160:163], v2 offset:4096
    v_add_u32 v6, 98304, v6
    ds_read_b64_tr_b16 v[168:169], v6 offset:32768
    v_mfma_f32_16x16x32_bf16 v[116:119], v[136:139], v[132:135], v[116:119]
    ds_read_b64_tr_b16 v[170:171], v6 offset:36864
    ds_read_b128 v[164:167], v2 offset:5120
    v_mfma_f32_16x16x32_bf16 v[120:123], v[140:143], v[128:131], v[120:123]
    v_add_u32 v7, 98304, v7
    ds_read_b64_tr_b16 v[172:173], v7 offset:32768
    ds_read_b64_tr_b16 v[174:175], v7 offset:36864
    v_mfma_f32_16x16x32_bf16 v[124:127], v[140:143], v[132:135], v[124:127]
    s_waitcnt lgkmcnt(6)
    v_mfma_f32_16x16x32_bf16 v[112:115], v[152:155], v[144:147], v[112:115]
    ds_read_b128 v[176:179], v2 offset:6144
    ds_read_b64_tr_b16 v[184:185], v6 offset:40960
    v_mfma_f32_16x16x32_bf16 v[116:119], v[152:155], v[148:151], v[116:119]
    ds_read_b64_tr_b16 v[186:187], v6 offset:45056
    ds_read_b128 v[180:183], v2 offset:7168
    v_mfma_f32_16x16x32_bf16 v[120:123], v[156:159], v[144:147], v[120:123]
    ds_read_b64_tr_b16 v[188:189], v7 offset:40960
    ds_read_b64_tr_b16 v[190:191], v7 offset:45056
    v_mfma_f32_16x16x32_bf16 v[124:127], v[156:159], v[148:151], v[124:127]
    s_waitcnt lgkmcnt(6)
    v_mfma_f32_16x16x32_bf16 v[112:115], v[168:171], v[160:163], v[112:115]
    v_mfma_f32_16x16x32_bf16 v[116:119], v[168:171], v[164:167], v[116:119]
    v_mfma_f32_16x16x32_bf16 v[120:123], v[172:175], v[160:163], v[120:123]
    v_mfma_f32_16x16x32_bf16 v[124:127], v[172:175], v[164:167], v[124:127]
    s_waitcnt lgkmcnt(0)
    v_mfma_f32_16x16x32_bf16 v[112:115], v[184:187], v[176:179], v[112:115]
    v_mfma_f32_16x16x32_bf16 v[116:119], v[184:187], v[180:183], v[116:119]
    v_mfma_f32_16x16x32_bf16 v[120:123], v[188:191], v[176:179], v[120:123]
    v_mfma_f32_16x16x32_bf16 v[124:127], v[188:191], v[180:183], v[124:127]
    s_nop 4
    v_pk_fma_f32 v[112:113], v[112:113], v[8:9], v[96:97] op_sel_hi:[1,0,1]
    v_pk_fma_f32 v[114:115], v[114:115], v[8:9], v[98:99] op_sel_hi:[1,0,1]
    v_pk_fma_f32 v[120:121], v[120:121], v[8:9], v[104:105] op_sel_hi:[1,0,1]
    v_pk_fma_f32 v[122:123], v[122:123], v[8:9], v[106:107] op_sel_hi:[1,0,1]
    v_cvt_pk_bf16_f32 v64, v112, v113
    v_cvt_pk_bf16_f32 v65, v114, v115
    v_cvt_pk_bf16_f32 v66, v120, v121
    v_cvt_pk_bf16_f32 v67, v122, v123
    s_nop 0
    v_permlane16_swap_b32 v64, v66
    v_permlane16_swap_b32 v65, v67
    buffer_store_dwordx4 v[64:67], v3, s[28:31], 0 offen sc1
    v_pk_fma_f32 v[116:117], v[116:117], v[10:11], v[100:101] op_sel_hi:[1,0,1]
    v_pk_fma_f32 v[118:119], v[118:119], v[10:11], v[102:103] op_sel_hi:[1,0,1]
    v_pk_fma_f32 v[124:125], v[124:125], v[10:11], v[108:109] op_sel_hi:[1,0,1]
    v_pk_fma_f32 v[126:127], v[126:127], v[10:11], v[110:111] op_sel_hi:[1,0,1]
    v_cvt_pk_bf16_f32 v68, v116, v117
    v_cvt_pk_bf16_f32 v69, v118, v119
    v_cvt_pk_bf16_f32 v70, v124, v125
    v_cvt_pk_bf16_f32 v71, v126, v127
    s_nop 0
    v_permlane16_swap_b32 v68, v70
    v_permlane16_swap_b32 v69, v71
    buffer_store_dwordx4 v[68:71], v3, s[28:31], s69 offen sc1
    s_endpgm
L_cons1:
    s_barrier
    ds_read_b64_tr_b16 v[20:21], v4 offset:0
    ds_read_b128 v[128:131], v2 offset:16384
    ds_read_b64_tr_b16 v[22:23], v4 offset:1024
    ds_read_b64_tr_b16 v[24:25], v5 offset:0
    ds_read_b128 v[132:135], v2 offset:18432
    ds_read_b64_tr_b16 v[26:27], v5 offset:1024
    ds_read_b64_tr_b16 v[28:29], v6 offset:0
    ds_read_b128 v[136:139], v3 offset:16384
    ds_read_b64_tr_b16 v[30:31], v6 offset:1024
    ds_read_b64_tr_b16 v[32:33], v7 offset:0
    ds_read_b128 v[140:143], v3 offset:18432
    ds_read_b64_tr_b16 v[34:35], v7 offset:1024
    s_waitcnt lgkmcnt(7)
    v_mfma_f32_16x16x32_bf16 v[64:67], v[20:23], v[128:131], 0
    ds_read_b64_tr_b16 v[36:37], v8 offset:0
    v_mfma_f32_16x16x32_bf16 v[68:71], v[20:23], v[132:135], 0
    ds_read_b64_tr_b16 v[38:39], v8 offset:1024
    s_waitcnt lgkmcnt(8)
    v_mfma_f32_16x16x32_bf16 v[72:75], v[24:27], v[128:131], 0
    ds_read_b64_tr_b16 v[40:41], v9 offset:0
    v_mfma_f32_16x16x32_bf16 v[76:79], v[24:27], v[132:135], 0
    ds_read_b64_tr_b16 v[42:43], v9 offset:1024
    s_waitcnt lgkmcnt(7)
    v_mfma_f32_16x16x32_bf16 v[80:83], v[28:31], v[128:131], 0
    ds_read_b64_tr_b16 v[20:21], v10 offset:0
    v_mfma_f32_16x16x32_bf16 v[84:87], v[28:31], v[132:135], 0
    ds_read_b64_tr_b16 v[22:23], v10 offset:1024
    s_waitcnt lgkmcnt(6)
    v_mfma_f32_16x16x32_bf16 v[88:91], v[32:35], v[128:131], 0
    ds_read_b64_tr_b16 v[24:25], v11 offset:0
    v_mfma_f32_16x16x32_bf16 v[92:95], v[32:35], v[132:135], 0
    ds_read_b64_tr_b16 v[26:27], v11 offset:1024
    s_waitcnt lgkmcnt(6)
    v_mfma_f32_16x16x32_bf16 v[96:99], v[36:39], v[128:131], 0
    ds_read_b64_tr_b16 v[28:29], v4 offset:8192
    v_mfma_f32_16x16x32_bf16 v[100:103], v[36:39], v[132:135], 0
    ds_read_b64_tr_b16 v[30:31], v4 offset:9216
    s_waitcnt lgkmcnt(6)
    v_mfma_f32_16x16x32_bf16 v[104:107], v[40:43], v[128:131], 0
    ds_read_b64_tr_b16 v[32:33], v5 offset:8192
    v_mfma_f32_16x16x32_bf16 v[108:111], v[40:43], v[132:135], 0
    ds_read_b64_tr_b16 v[34:35], v5 offset:9216
    s_waitcnt lgkmcnt(6)
    v_mfma_f32_16x16x32_bf16 v[112:115], v[20:23], v[128:131], 0
    ds_read_b64_tr_b16 v[36:37], v6 offset:8192
    v_mfma_f32_16x16x32_bf16 v[116:119], v[20:23], v[132:135], 0
    ds_read_b64_tr_b16 v[38:39], v6 offset:9216
    s_waitcnt lgkmcnt(6)
    v_mfma_f32_16x16x32_bf16 v[120:123], v[24:27], v[128:131], 0
    ds_read_b64_tr_b16 v[40:41], v7 offset:8192
    v_mfma_f32_16x16x32_bf16 v[124:127], v[24:27], v[132:135], 0
    ds_read_b64_tr_b16 v[42:43], v7 offset:9216
    s_waitcnt lgkmcnt(6)
    v_mfma_f32_16x16x32_bf16 v[64:67], v[28:31], v[136:139], v[64:67]
    ds_read_b64_tr_b16 v[20:21], v8 offset:8192
    v_mfma_f32_16x16x32_bf16 v[68:71], v[28:31], v[140:143], v[68:71]
    ds_read_b64_tr_b16 v[22:23], v8 offset:9216
    s_waitcnt lgkmcnt(6)
    v_mfma_f32_16x16x32_bf16 v[72:75], v[32:35], v[136:139], v[72:75]
    ds_read_b64_tr_b16 v[24:25], v9 offset:8192
    v_mfma_f32_16x16x32_bf16 v[76:79], v[32:35], v[140:143], v[76:79]
    ds_read_b64_tr_b16 v[26:27], v9 offset:9216
    s_waitcnt lgkmcnt(6)
    v_mfma_f32_16x16x32_bf16 v[80:83], v[36:39], v[136:139], v[80:83]
    ds_read_b64_tr_b16 v[28:29], v10 offset:8192
    v_mfma_f32_16x16x32_bf16 v[84:87], v[36:39], v[140:143], v[84:87]
    ds_read_b64_tr_b16 v[30:31], v10 offset:9216
    s_waitcnt lgkmcnt(6)
    v_mfma_f32_16x16x32_bf16 v[88:91], v[40:43], v[136:139], v[88:91]
    ds_read_b64_tr_b16 v[32:33], v11 offset:8192
    v_mfma_f32_16x16x32_bf16 v[92:95], v[40:43], v[140:143], v[92:95]
    ds_read_b64_tr_b16 v[34:35], v11 offset:9216
    s_waitcnt lgkmcnt(6)
    v_mfma_f32_16x16x32_bf16 v[96:99], v[20:23], v[136:139], v[96:99]
    s_barrier
    ds_read_b64_tr_b16 v[36:37], v4 offset:32768
    ds_read_b128 v[144:147], v2 offset:49152
    v_mfma_f32_16x16x32_bf16 v[100:103], v[20:23], v[140:143], v[100:103]
    ds_read_b64_tr_b16 v[38:39], v4 offset:33792
    s_waitcnt lgkmcnt(7)
    v_mfma_f32_16x16x32_bf16 v[104:107], v[24:27], v[136:139], v[104:107]
    ds_read_b64_tr_b16 v[40:41], v5 offset:32768
    ds_read_b128 v[148:151], v2 offset:51200
    v_mfma_f32_16x16x32_bf16 v[108:111], v[24:27], v[140:143], v[108:111]
    ds_read_b64_tr_b16 v[42:43], v5 offset:33792
    s_waitcnt lgkmcnt(8)
    v_mfma_f32_16x16x32_bf16 v[112:115], v[28:31], v[136:139], v[112:115]
    ds_read_b64_tr_b16 v[20:21], v6 offset:32768
    ds_read_b128 v[152:155], v3 offset:49152
    v_mfma_f32_16x16x32_bf16 v[116:119], v[28:31], v[140:143], v[116:119]
    ds_read_b64_tr_b16 v[22:23], v6 offset:33792
    s_waitcnt lgkmcnt(9)
    v_mfma_f32_16x16x32_bf16 v[120:123], v[32:35], v[136:139], v[120:123]
    ds_read_b64_tr_b16 v[24:25], v7 offset:32768
    ds_read_b128 v[156:159], v3 offset:51200
    v_mfma_f32_16x16x32_bf16 v[124:127], v[32:35], v[140:143], v[124:127]
    ds_read_b64_tr_b16 v[26:27], v7 offset:33792
    s_waitcnt lgkmcnt(7)
    v_mfma_f32_16x16x32_bf16 v[64:67], v[36:39], v[144:147], v[64:67]
    ds_read_b64_tr_b16 v[28:29], v8 offset:32768
    v_mfma_f32_16x16x32_bf16 v[68:71], v[36:39], v[148:151], v[68:71]
    ds_read_b64_tr_b16 v[30:31], v8 offset:33792
    s_waitcnt lgkmcnt(8)
    v_mfma_f32_16x16x32_bf16 v[72:75], v[40:43], v[144:147], v[72:75]
    ds_read_b64_tr_b16 v[32:33], v9 offset:32768
    v_mfma_f32_16x16x32_bf16 v[76:79], v[40:43], v[148:151], v[76:79]
    ds_read_b64_tr_b16 v[34:35], v9 offset:33792
    s_waitcnt lgkmcnt(7)
    v_mfma_f32_16x16x32_bf16 v[80:83], v[20:23], v[144:147], v[80:83]
    ds_read_b64_tr_b16 v[36:37], v10 offset:32768
    v_mfma_f32_16x16x32_bf16 v[84:87], v[20:23], v[148:151], v[84:87]
    ds_read_b64_tr_b16 v[38:39], v10 offset:33792
    s_waitcnt lgkmcnt(6)
    v_mfma_f32_16x16x32_bf16 v[88:91], v[24:27], v[144:147], v[88:91]
    ds_read_b64_tr_b16 v[40:41], v11 offset:32768
    v_mfma_f32_16x16x32_bf16 v[92:95], v[24:27], v[148:151], v[92:95]
    ds_read_b64_tr_b16 v[42:43], v11 offset:33792
    s_waitcnt lgkmcnt(6)
    v_mfma_f32_16x16x32_bf16 v[96:99], v[28:31], v[144:147], v[96:99]
    ds_read_b64_tr_b16 v[20:21], v4 offset:40960
    v_mfma_f32_16x16x32_bf16 v[100:103], v[28:31], v[148:151], v[100:103]
    ds_read_b64_tr_b16 v[22:23], v4 offset:41984
    s_waitcnt lgkmcnt(6)
    v_mfma_f32_16x16x32_bf16 v[104:107], v[32:35], v[144:147], v[104:107]
    ds_read_b64_tr_b16 v[24:25], v5 offset:40960
    v_mfma_f32_16x16x32_bf16 v[108:111], v[32:35], v[148:151], v[108:111]
    ds_read_b64_tr_b16 v[26:27], v5 offset:41984
    s_waitcnt lgkmcnt(6)
    v_mfma_f32_16x16x32_bf16 v[112:115], v[36:39], v[144:147], v[112:115]
    ds_read_b64_tr_b16 v[28:29], v6 offset:40960
    v_mfma_f32_16x16x32_bf16 v[116:119], v[36:39], v[148:151], v[116:119]
    ds_read_b64_tr_b16 v[30:31], v6 offset:41984
    s_waitcnt lgkmcnt(6)
    v_mfma_f32_16x16x32_bf16 v[120:123], v[40:43], v[144:147], v[120:123]
    ds_read_b64_tr_b16 v[32:33], v7 offset:40960
    v_mfma_f32_16x16x32_bf16 v[124:127], v[40:43], v[148:151], v[124:127]
    ds_read_b64_tr_b16 v[34:35], v7 offset:41984
    s_waitcnt lgkmcnt(6)
    v_mfma_f32_16x16x32_bf16 v[64:67], v[20:23], v[152:155], v[64:67]
    ds_read_b64_tr_b16 v[36:37], v8 offset:40960
    v_mfma_f32_16x16x32_bf16 v[68:71], v[20:23], v[156:159], v[68:71]
    ds_read_b64_tr_b16 v[38:39], v8 offset:41984
    s_waitcnt lgkmcnt(6)
    v_mfma_f32_16x16x32_bf16 v[72:75], v[24:27], v[152:155], v[72:75]
    ds_read_b64_tr_b16 v[40:41], v9 offset:40960
    v_mfma_f32_16x16x32_bf16 v[76:79], v[24:27], v[156:159], v[76:79]
    ds_read_b64_tr_b16 v[42:43], v9 offset:41984
    s_waitcnt lgkmcnt(6)
    v_mfma_f32_16x16x32_bf16 v[80:83], v[28:31], v[152:155], v[80:83]
    ds_read_b64_tr_b16 v[20:21], v10 offset:40960
    v_mfma_f32_16x16x32_bf16 v[84:87], v[28:31], v[156:159], v[84:87]
    ds_read_b64_tr_b16 v[22:23], v10 offset:41984
    s_waitcnt lgkmcnt(6)
    v_mfma_f32_16x16x32_bf16 v[88:91], v[32:35], v[152:155], v[88:91]
    ds_read_b64_tr_b16 v[24:25], v11 offset:40960
    v_mfma_f32_16x16x32_bf16 v[92:95], v[32:35], v[156:159], v[92:95]
    ds_read_b64_tr_b16 v[26:27], v11 offset:41984
    s_waitcnt lgkmcnt(6)
    v_mfma_f32_16x16x32_bf16 v[96:99], v[36:39], v[152:155], v[96:99]
    s_barrier
    v_add_u32 v4, 65536, v4
    ds_read_b64_tr_b16 v[28:29], v4 offset:16384
    v_add_u32 v2, 65536, v2
    ds_read_b128 v[160:163], v2 offset:0
    v_mfma_f32_16x16x32_bf16 v[100:103], v[36:39], v[156:159], v[100:103]
    ds_read_b64_tr_b16 v[30:31], v4 offset:17408
    s_waitcnt lgkmcnt(7)
    v_mfma_f32_16x16x32_bf16 v[104:107], v[40:43], v[152:155], v[104:107]
    v_add_u32 v5, 65536, v5
    ds_read_b64_tr_b16 v[32:33], v5 offset:16384
    ds_read_b128 v[164:167], v2 offset:2048
    v_mfma_f32_16x16x32_bf16 v[108:111], v[40:43], v[156:159], v[108:111]
    ds_read_b64_tr_b16 v[34:35], v5 offset:17408
    s_waitcnt lgkmcnt(8)
    v_mfma_f32_16x16x32_bf16 v[112:115], v[20:23], v[152:155], v[112:115]
    v_add_u32 v6, 65536, v6
    ds_read_b64_tr_b16 v[36:37], v6 offset:16384
    v_add_u32 v3, 65536, v3
    ds_read_b128 v[168:171], v3 offset:0
    v_mfma_f32_16x16x32_bf16 v[116:119], v[20:23], v[156:159], v[116:119]
    ds_read_b64_tr_b16 v[38:39], v6 offset:17408
    s_waitcnt lgkmcnt(9)
    v_mfma_f32_16x16x32_bf16 v[120:123], v[24:27], v[152:155], v[120:123]
    v_add_u32 v7, 65536, v7
    ds_read_b64_tr_b16 v[40:41], v7 offset:16384
    ds_read_b128 v[172:175], v3 offset:2048
    v_mfma_f32_16x16x32_bf16 v[124:127], v[24:27], v[156:159], v[124:127]
    ds_read_b64_tr_b16 v[42:43], v7 offset:17408
    s_waitcnt lgkmcnt(7)
    v_mfma_f32_16x16x32_bf16 v[64:67], v[28:31], v[160:163], v[64:67]
    v_add_u32 v8, 65536, v8
    ds_read_b64_tr_b16 v[20:21], v8 offset:16384
    v_mfma_f32_16x16x32_bf16 v[68:71], v[28:31], v[164:167], v[68:71]
    ds_read_b64_tr_b16 v[22:23], v8 offset:17408
    s_waitcnt lgkmcnt(8)
    v_mfma_f32_16x16x32_bf16 v[72:75], v[32:35], v[160:163], v[72:75]
    v_add_u32 v9, 65536, v9
    ds_read_b64_tr_b16 v[24:25], v9 offset:16384
    v_mfma_f32_16x16x32_bf16 v[76:79], v[32:35], v[164:167], v[76:79]
    ds_read_b64_tr_b16 v[26:27], v9 offset:17408
    s_waitcnt lgkmcnt(7)
    v_mfma_f32_16x16x32_bf16 v[80:83], v[36:39], v[160:163], v[80:83]
    v_add_u32 v10, 65536, v10
    ds_read_b64_tr_b16 v[28:29], v10 offset:16384
    v_mfma_f32_16x16x32_bf16 v[84:87], v[36:39], v[164:167], v[84:87]
    ds_read_b64_tr_b16 v[30:31], v10 offset:17408
    s_waitcnt lgkmcnt(6)
    v_mfma_f32_16x16x32_bf16 v[88:91], v[40:43], v[160:163], v[88:91]
    v_add_u32 v11, 65536, v11
    ds_read_b64_tr_b16 v[32:33], v11 offset:16384
    v_mfma_f32_16x16x32_bf16 v[92:95], v[40:43], v[164:167], v[92:95]
    ds_read_b64_tr_b16 v[34:35], v11 offset:17408
    s_waitcnt lgkmcnt(6)
    v_mfma_f32_16x16x32_bf16 v[96:99], v[20:23], v[160:163], v[96:99]
    ds_read_b64_tr_b16 v[36:37], v4 offset:24576
    v_mfma_f32_16x16x32_bf16 v[100:103], v[20:23], v[164:167], v[100:103]
    ds_read_b64_tr_b16 v[38:39], v4 offset:25600
    s_waitcnt lgkmcnt(6)
    v_mfma_f32_16x16x32_bf16 v[104:107], v[24:27], v[160:163], v[104:107]
    ds_read_b64_tr_b16 v[40:41], v5 offset:24576
    v_mfma_f32_16x16x32_bf16 v[108:111], v[24:27], v[164:167], v[108:111]
    ds_read_b64_tr_b16 v[42:43], v5 offset:25600
    s_waitcnt lgkmcnt(6)
    v_mfma_f32_16x16x32_bf16 v[112:115], v[28:31], v[160:163], v[112:115]
    ds_read_b64_tr_b16 v[20:21], v6 offset:24576
    v_mfma_f32_16x16x32_bf16 v[116:119], v[28:31], v[164:167], v[116:119]
    ds_read_b64_tr_b16 v[22:23], v6 offset:25600
    s_waitcnt lgkmcnt(6)
    v_mfma_f32_16x16x32_bf16 v[120:123], v[32:35], v[160:163], v[120:123]
    ds_read_b64_tr_b16 v[24:25], v7 offset:24576
    v_mfma_f32_16x16x32_bf16 v[124:127], v[32:35], v[164:167], v[124:127]
    ds_read_b64_tr_b16 v[26:27], v7 offset:25600
    s_waitcnt lgkmcnt(6)
    v_mfma_f32_16x16x32_bf16 v[64:67], v[36:39], v[168:171], v[64:67]
    ds_read_b64_tr_b16 v[28:29], v8 offset:24576
    v_mfma_f32_16x16x32_bf16 v[68:71], v[36:39], v[172:175], v[68:71]
    ds_read_b64_tr_b16 v[30:31], v8 offset:25600
    s_waitcnt lgkmcnt(6)
    v_mfma_f32_16x16x32_bf16 v[72:75], v[40:43], v[168:171], v[72:75]
    ds_read_b64_tr_b16 v[32:33], v9 offset:24576
    v_mfma_f32_16x16x32_bf16 v[76:79], v[40:43], v[172:175], v[76:79]
    ds_read_b64_tr_b16 v[34:35], v9 offset:25600
    s_waitcnt lgkmcnt(6)
    v_mfma_f32_16x16x32_bf16 v[80:83], v[20:23], v[168:171], v[80:83]
    ds_read_b64_tr_b16 v[36:37], v10 offset:24576
    v_mfma_f32_16x16x32_bf16 v[84:87], v[20:23], v[172:175], v[84:87]
    ds_read_b64_tr_b16 v[38:39], v10 offset:25600
    s_waitcnt lgkmcnt(6)
    v_mfma_f32_16x16x32_bf16 v[88:91], v[24:27], v[168:171], v[88:91]
    ds_read_b64_tr_b16 v[40:41], v11 offset:24576
    v_mfma_f32_16x16x32_bf16 v[92:95], v[24:27], v[172:175], v[92:95]
    ds_read_b64_tr_b16 v[42:43], v11 offset:25600
    s_waitcnt lgkmcnt(6)
    v_mfma_f32_16x16x32_bf16 v[96:99], v[28:31], v[168:171], v[96:99]
    s_barrier
    ds_read_b64_tr_b16 v[20:21], v4 offset:49152
    ds_read_b128 v[176:179], v2 offset:32768
    v_mfma_f32_16x16x32_bf16 v[100:103], v[28:31], v[172:175], v[100:103]
    ds_read_b64_tr_b16 v[22:23], v4 offset:50176
    s_waitcnt lgkmcnt(7)
    v_mfma_f32_16x16x32_bf16 v[104:107], v[32:35], v[168:171], v[104:107]
    ds_read_b64_tr_b16 v[24:25], v5 offset:49152
    ds_read_b128 v[180:183], v2 offset:34816
    v_mfma_f32_16x16x32_bf16 v[108:111], v[32:35], v[172:175], v[108:111]
    ds_read_b64_tr_b16 v[26:27], v5 offset:50176
    s_waitcnt lgkmcnt(8)
    v_mfma_f32_16x16x32_bf16 v[112:115], v[36:39], v[168:171], v[112:115]
    ds_read_b64_tr_b16 v[28:29], v6 offset:49152
    ds_read_b128 v[184:187], v3 offset:32768
    v_mfma_f32_16x16x32_bf16 v[116:119], v[36:39], v[172:175], v[116:119]
    ds_read_b64_tr_b16 v[30:31], v6 offset:50176
    s_waitcnt lgkmcnt(9)
    v_mfma_f32_16x16x32_bf16 v[120:123], v[40:43], v[168:171], v[120:123]
    ds_read_b64_tr_b16 v[32:33], v7 offset:49152
    ds_read_b128 v[188:191], v3 offset:34816
    v_mfma_f32_16x16x32_bf16 v[124:127], v[40:43], v[172:175], v[124:127]
    ds_read_b64_tr_b16 v[34:35], v7 offset:50176
    s_waitcnt lgkmcnt(7)
    v_mfma_f32_16x16x32_bf16 v[64:67], v[20:23], v[176:179], v[64:67]
    ds_read_b64_tr_b16 v[36:37], v8 offset:49152
    v_mfma_f32_16x16x32_bf16 v[68:71], v[20:23], v[180:183], v[68:71]
    ds_read_b64_tr_b16 v[38:39], v8 offset:50176
    s_waitcnt lgkmcnt(8)
    v_mfma_f32_16x16x32_bf16 v[72:75], v[24:27], v[176:179], v[72:75]
    ds_read_b64_tr_b16 v[40:41], v9 offset:49152
    v_mfma_f32_16x16x32_bf16 v[76:79], v[24:27], v[180:183], v[76:79]
    ds_read_b64_tr_b16 v[42:43], v9 offset:50176
    s_waitcnt lgkmcnt(7)
    v_mfma_f32_16x16x32_bf16 v[80:83], v[28:31], v[176:179], v[80:83]
    ds_read_b64_tr_b16 v[20:21], v10 offset:49152
    v_mfma_f32_16x16x32_bf16 v[84:87], v[28:31], v[180:183], v[84:87]
    ds_read_b64_tr_b16 v[22:23], v10 offset:50176
    s_waitcnt lgkmcnt(6)
    v_mfma_f32_16x16x32_bf16 v[88:91], v[32:35], v[176:179], v[88:91]
    ds_read_b64_tr_b16 v[24:25], v11 offset:49152
    v_mfma_f32_16x16x32_bf16 v[92:95], v[32:35], v[180:183], v[92:95]
    ds_read_b64_tr_b16 v[26:27], v11 offset:50176
    s_waitcnt lgkmcnt(6)
    v_mfma_f32_16x16x32_bf16 v[96:99], v[36:39], v[176:179], v[96:99]
    ds_read_b64_tr_b16 v[28:29], v4 offset:57344
    v_mfma_f32_16x16x32_bf16 v[100:103], v[36:39], v[180:183], v[100:103]
    ds_read_b64_tr_b16 v[30:31], v4 offset:58368
    s_waitcnt lgkmcnt(6)
    v_mfma_f32_16x16x32_bf16 v[104:107], v[40:43], v[176:179], v[104:107]
    ds_read_b64_tr_b16 v[32:33], v5 offset:57344
    v_mfma_f32_16x16x32_bf16 v[108:111], v[40:43], v[180:183], v[108:111]
    ds_read_b64_tr_b16 v[34:35], v5 offset:58368
    s_waitcnt lgkmcnt(6)
    v_mfma_f32_16x16x32_bf16 v[112:115], v[20:23], v[176:179], v[112:115]
    ds_read_b64_tr_b16 v[36:37], v6 offset:57344
    v_mfma_f32_16x16x32_bf16 v[116:119], v[20:23], v[180:183], v[116:119]
    ds_read_b64_tr_b16 v[38:39], v6 offset:58368
    s_waitcnt lgkmcnt(6)
    v_mfma_f32_16x16x32_bf16 v[120:123], v[24:27], v[176:179], v[120:123]
    ds_read_b64_tr_b16 v[40:41], v7 offset:57344
    v_mfma_f32_16x16x32_bf16 v[124:127], v[24:27], v[180:183], v[124:127]
    ds_read_b64_tr_b16 v[42:43], v7 offset:58368
    s_waitcnt lgkmcnt(6)
    v_mfma_f32_16x16x32_bf16 v[64:67], v[28:31], v[184:187], v[64:67]
    ds_read_b64_tr_b16 v[20:21], v8 offset:57344
    v_mfma_f32_16x16x32_bf16 v[68:71], v[28:31], v[188:191], v[68:71]
    ds_read_b64_tr_b16 v[22:23], v8 offset:58368
    s_waitcnt lgkmcnt(6)
    v_mfma_f32_16x16x32_bf16 v[72:75], v[32:35], v[184:187], v[72:75]
    ds_read_b64_tr_b16 v[24:25], v9 offset:57344
    v_mfma_f32_16x16x32_bf16 v[76:79], v[32:35], v[188:191], v[76:79]
    ds_read_b64_tr_b16 v[26:27], v9 offset:58368
    s_waitcnt lgkmcnt(6)
    v_mfma_f32_16x16x32_bf16 v[80:83], v[36:39], v[184:187], v[80:83]
    ds_read_b64_tr_b16 v[28:29], v10 offset:57344
    v_mfma_f32_16x16x32_bf16 v[84:87], v[36:39], v[188:191], v[84:87]
    ds_read_b64_tr_b16 v[30:31], v10 offset:58368
    s_waitcnt lgkmcnt(6)
    v_mfma_f32_16x16x32_bf16 v[88:91], v[40:43], v[184:187], v[88:91]
    ds_read_b64_tr_b16 v[32:33], v11 offset:57344
    v_mfma_f32_16x16x32_bf16 v[92:95], v[40:43], v[188:191], v[92:95]
    ds_read_b64_tr_b16 v[34:35], v11 offset:58368
    s_waitcnt lgkmcnt(6)
    v_mfma_f32_16x16x32_bf16 v[96:99], v[20:23], v[184:187], v[96:99]
    s_barrier
    v_add_u32 v4, 4294901760, v4
    ds_read_b64_tr_b16 v[36:37], v4 offset:16384
    v_add_u32 v2, 32768, v2
    ds_read_b128 v[192:195], v2 offset:32768
    v_mfma_f32_16x16x32_bf16 v[100:103], v[20:23], v[188:191], v[100:103]
    ds_read_b64_tr_b16 v[38:39], v4 offset:17408
    s_waitcnt lgkmcnt(7)
    v_mfma_f32_16x16x32_bf16 v[104:107], v[24:27], v[184:187], v[104:107]
    v_add_u32 v5, 4294901760, v5
    ds_read_b64_tr_b16 v[40:41], v5 offset:16384
    ds_read_b128 v[196:199], v2 offset:34816
    v_mfma_f32_16x16x32_bf16 v[108:111], v[24:27], v[188:191], v[108:111]
    ds_read_b64_tr_b16 v[42:43], v5 offset:17408
    s_waitcnt lgkmcnt(8)
    v_mfma_f32_16x16x32_bf16 v[112:115], v[28:31], v[184:187], v[112:115]
    v_add_u32 v6, 4294901760, v6
    ds_read_b64_tr_b16 v[20:21], v6 offset:16384
    v_add_u32 v3, 32768, v3
    ds_read_b128 v[200:203], v3 offset:32768
    v_mfma_f32_16x16x32_bf16 v[116:119], v[28:31], v[188:191], v[116:119]
    ds_read_b64_tr_b16 v[22:23], v6 offset:17408
    s_waitcnt lgkmcnt(9)
    v_mfma_f32_16x16x32_bf16 v[120:123], v[32:35], v[184:187], v[120:123]
    v_add_u32 v7, 4294901760, v7
    ds_read_b64_tr_b16 v[24:25], v7 offset:16384
    ds_read_b128 v[204:207], v3 offset:34816
    v_mfma_f32_16x16x32_bf16 v[124:127], v[32:35], v[188:191], v[124:127]
    ds_read_b64_tr_b16 v[26:27], v7 offset:17408
    s_waitcnt lgkmcnt(7)
    v_mfma_f32_16x16x32_bf16 v[64:67], v[36:39], v[192:195], v[64:67]
    v_add_u32 v8, 4294901760, v8
    ds_read_b64_tr_b16 v[28:29], v8 offset:16384
    v_mfma_f32_16x16x32_bf16 v[68:71], v[36:39], v[196:199], v[68:71]
    ds_read_b64_tr_b16 v[30:31], v8 offset:17408
    s_waitcnt lgkmcnt(8)
    v_mfma_f32_16x16x32_bf16 v[72:75], v[40:43], v[192:195], v[72:75]
    v_add_u32 v9, 4294901760, v9
    ds_read_b64_tr_b16 v[32:33], v9 offset:16384
    v_mfma_f32_16x16x32_bf16 v[76:79], v[40:43], v[196:199], v[76:79]
    ds_read_b64_tr_b16 v[34:35], v9 offset:17408
    s_waitcnt lgkmcnt(7)
    v_mfma_f32_16x16x32_bf16 v[80:83], v[20:23], v[192:195], v[80:83]
    v_add_u32 v10, 4294901760, v10
    ds_read_b64_tr_b16 v[36:37], v10 offset:16384
    v_mfma_f32_16x16x32_bf16 v[84:87], v[20:23], v[196:199], v[84:87]
    ds_read_b64_tr_b16 v[38:39], v10 offset:17408
    s_waitcnt lgkmcnt(6)
    v_mfma_f32_16x16x32_bf16 v[88:91], v[24:27], v[192:195], v[88:91]
    v_add_u32 v11, 4294901760, v11
    ds_read_b64_tr_b16 v[40:41], v11 offset:16384
    v_mfma_f32_16x16x32_bf16 v[92:95], v[24:27], v[196:199], v[92:95]
    ds_read_b64_tr_b16 v[42:43], v11 offset:17408
    s_waitcnt lgkmcnt(6)
    v_mfma_f32_16x16x32_bf16 v[96:99], v[28:31], v[192:195], v[96:99]
    ds_read_b64_tr_b16 v[20:21], v4 offset:24576
    v_mfma_f32_16x16x32_bf16 v[100:103], v[28:31], v[196:199], v[100:103]
    ds_read_b64_tr_b16 v[22:23], v4 offset:25600
    s_waitcnt lgkmcnt(6)
    v_mfma_f32_16x16x32_bf16 v[104:107], v[32:35], v[192:195], v[104:107]
    ds_read_b64_tr_b16 v[24:25], v5 offset:24576
    v_mfma_f32_16x16x32_bf16 v[108:111], v[32:35], v[196:199], v[108:111]
    ds_read_b64_tr_b16 v[26:27], v5 offset:25600
    s_waitcnt lgkmcnt(6)
    v_mfma_f32_16x16x32_bf16 v[112:115], v[36:39], v[192:195], v[112:115]
    ds_read_b64_tr_b16 v[28:29], v6 offset:24576
    v_mfma_f32_16x16x32_bf16 v[116:119], v[36:39], v[196:199], v[116:119]
    ds_read_b64_tr_b16 v[30:31], v6 offset:25600
    s_waitcnt lgkmcnt(6)
    v_mfma_f32_16x16x32_bf16 v[120:123], v[40:43], v[192:195], v[120:123]
    ds_read_b64_tr_b16 v[32:33], v7 offset:24576
    v_mfma_f32_16x16x32_bf16 v[124:127], v[40:43], v[196:199], v[124:127]
    ds_read_b64_tr_b16 v[34:35], v7 offset:25600
    s_waitcnt lgkmcnt(6)
    v_mfma_f32_16x16x32_bf16 v[64:67], v[20:23], v[200:203], v[64:67]
    ds_read_b64_tr_b16 v[36:37], v8 offset:24576
    v_mfma_f32_16x16x32_bf16 v[68:71], v[20:23], v[204:207], v[68:71]
    ds_read_b64_tr_b16 v[38:39], v8 offset:25600
    s_waitcnt lgkmcnt(6)
    v_mfma_f32_16x16x32_bf16 v[72:75], v[24:27], v[200:203], v[72:75]
    ds_read_b64_tr_b16 v[40:41], v9 offset:24576
    v_mfma_f32_16x16x32_bf16 v[76:79], v[24:27], v[204:207], v[76:79]
    ds_read_b64_tr_b16 v[42:43], v9 offset:25600
    s_waitcnt lgkmcnt(6)
    v_mfma_f32_16x16x32_bf16 v[80:83], v[28:31], v[200:203], v[80:83]
    ds_read_b64_tr_b16 v[20:21], v10 offset:24576
    v_mfma_f32_16x16x32_bf16 v[84:87], v[28:31], v[204:207], v[84:87]
    ds_read_b64_tr_b16 v[22:23], v10 offset:25600
    s_waitcnt lgkmcnt(6)
    v_mfma_f32_16x16x32_bf16 v[88:91], v[32:35], v[200:203], v[88:91]
    ds_read_b64_tr_b16 v[24:25], v11 offset:24576
    v_mfma_f32_16x16x32_bf16 v[92:95], v[32:35], v[204:207], v[92:95]
    ds_read_b64_tr_b16 v[26:27], v11 offset:25600
    s_waitcnt lgkmcnt(6)
    v_mfma_f32_16x16x32_bf16 v[96:99], v[36:39], v[200:203], v[96:99]
    s_barrier
    ds_read_b64_tr_b16 v[28:29], v4 offset:49152
    v_add_u32 v2, 4294868992, v2
    ds_read_b128 v[208:211], v2 offset:0
    v_mfma_f32_16x16x32_bf16 v[100:103], v[36:39], v[204:207], v[100:103]
    ds_read_b64_tr_b16 v[30:31], v4 offset:50176
    s_waitcnt lgkmcnt(7)
    v_mfma_f32_16x16x32_bf16 v[104:107], v[40:43], v[200:203], v[104:107]
    ds_read_b64_tr_b16 v[32:33], v5 offset:49152
    ds_read_b128 v[212:215], v2 offset:2048
    v_mfma_f32_16x16x32_bf16 v[108:111], v[40:43], v[204:207], v[108:111]
    ds_read_b64_tr_b16 v[34:35], v5 offset:50176
    s_waitcnt lgkmcnt(8)
    v_mfma_f32_16x16x32_bf16 v[112:115], v[20:23], v[200:203], v[112:115]
    ds_read_b64_tr_b16 v[36:37], v6 offset:49152
    s_branch L_pg7x
L_pg7:
    s_setpc_b64 s[6:7]
L_pg7x:
    v_add_u32 v3, 4294868992, v3
    ds_read_b128 v[216:219], v3 offset:0
    v_mfma_f32_16x16x32_bf16 v[116:119], v[20:23], v[204:207], v[116:119]
    ds_read_b64_tr_b16 v[38:39], v6 offset:50176
    s_waitcnt lgkmcnt(9)
    v_mfma_f32_16x16x32_bf16 v[120:123], v[24:27], v[200:203], v[120:123]
    ds_read_b64_tr_b16 v[40:41], v7 offset:49152
    ds_read_b128 v[220:223], v3 offset:2048
    v_mfma_f32_16x16x32_bf16 v[124:127], v[24:27], v[204:207], v[124:127]
    ds_read_b64_tr_b16 v[42:43], v7 offset:50176
    s_waitcnt lgkmcnt(7)
    v_mfma_f32_16x16x32_bf16 v[64:67], v[28:31], v[208:211], v[64:67]
    ds_read_b64_tr_b16 v[20:21], v8 offset:49152
    v_mfma_f32_16x16x32_bf16 v[68:71], v[28:31], v[212:215], v[68:71]
    ds_read_b64_tr_b16 v[22:23], v8 offset:50176
    s_waitcnt lgkmcnt(8)
    v_mfma_f32_16x16x32_bf16 v[72:75], v[32:35], v[208:211], v[72:75]
    ds_read_b64_tr_b16 v[24:25], v9 offset:49152
    v_mfma_f32_16x16x32_bf16 v[76:79], v[32:35], v[212:215], v[76:79]
    ds_read_b64_tr_b16 v[26:27], v9 offset:50176
    s_waitcnt lgkmcnt(7)
    v_mfma_f32_16x16x32_bf16 v[80:83], v[36:39], v[208:211], v[80:83]
    ds_read_b64_tr_b16 v[28:29], v10 offset:49152
    v_mfma_f32_16x16x32_bf16 v[84:87], v[36:39], v[212:215], v[84:87]
    ds_read_b64_tr_b16 v[30:31], v10 offset:50176
    s_waitcnt lgkmcnt(6)
    v_mfma_f32_16x16x32_bf16 v[88:91], v[40:43], v[208:211], v[88:91]
    ds_read_b64_tr_b16 v[32:33], v11 offset:49152
    v_mfma_f32_16x16x32_bf16 v[92:95], v[40:43], v[212:215], v[92:95]
    ds_read_b64_tr_b16 v[34:35], v11 offset:50176
    s_waitcnt lgkmcnt(6)
    v_mfma_f32_16x16x32_bf16 v[96:99], v[20:23], v[208:211], v[96:99]
    ds_read_b64_tr_b16 v[36:37], v4 offset:57344
    v_mfma_f32_16x16x32_bf16 v[100:103], v[20:23], v[212:215], v[100:103]
    ds_read_b64_tr_b16 v[38:39], v4 offset:58368
    s_waitcnt lgkmcnt(6)
    v_mfma_f32_16x16x32_bf16 v[104:107], v[24:27], v[208:211], v[104:107]
    ds_read_b64_tr_b16 v[40:41], v5 offset:57344
    v_mfma_f32_16x16x32_bf16 v[108:111], v[24:27], v[212:215], v[108:111]
    ds_read_b64_tr_b16 v[42:43], v5 offset:58368
    s_waitcnt lgkmcnt(6)
    v_mfma_f32_16x16x32_bf16 v[112:115], v[28:31], v[208:211], v[112:115]
    ds_read_b64_tr_b16 v[20:21], v6 offset:57344
    v_mfma_f32_16x16x32_bf16 v[116:119], v[28:31], v[212:215], v[116:119]
    ds_read_b64_tr_b16 v[22:23], v6 offset:58368
    s_waitcnt lgkmcnt(6)
    v_mfma_f32_16x16x32_bf16 v[120:123], v[32:35], v[208:211], v[120:123]
    ds_read_b64_tr_b16 v[24:25], v7 offset:57344
    v_mfma_f32_16x16x32_bf16 v[124:127], v[32:35], v[212:215], v[124:127]
    ds_read_b64_tr_b16 v[26:27], v7 offset:58368
    s_waitcnt lgkmcnt(6)
    v_mfma_f32_16x16x32_bf16 v[64:67], v[36:39], v[216:219], v[64:67]
    ds_read_b64_tr_b16 v[28:29], v8 offset:57344
    v_mfma_f32_16x16x32_bf16 v[68:71], v[36:39], v[220:223], v[68:71]
    ds_read_b64_tr_b16 v[30:31], v8 offset:58368
    s_waitcnt lgkmcnt(6)
    v_mfma_f32_16x16x32_bf16 v[72:75], v[40:43], v[216:219], v[72:75]
    ds_read_b64_tr_b16 v[32:33], v9 offset:57344
    v_mfma_f32_16x16x32_bf16 v[76:79], v[40:43], v[220:223], v[76:79]
    ds_read_b64_tr_b16 v[34:35], v9 offset:58368
    s_waitcnt lgkmcnt(6)
    v_mfma_f32_16x16x32_bf16 v[80:83], v[20:23], v[216:219], v[80:83]
    ds_read_b64_tr_b16 v[36:37], v10 offset:57344
    v_mfma_f32_16x16x32_bf16 v[84:87], v[20:23], v[220:223], v[84:87]
    ds_read_b64_tr_b16 v[38:39], v10 offset:58368
    s_waitcnt lgkmcnt(6)
    v_mfma_f32_16x16x32_bf16 v[88:91], v[24:27], v[216:219], v[88:91]
    ds_read_b64_tr_b16 v[40:41], v11 offset:57344
    v_mfma_f32_16x16x32_bf16 v[92:95], v[24:27], v[220:223], v[92:95]
    ds_read_b64_tr_b16 v[42:43], v11 offset:58368
    s_waitcnt lgkmcnt(6)
    v_mfma_f32_16x16x32_bf16 v[96:99], v[28:31], v[216:219], v[96:99]
    s_barrier
    v_add_u32 v4, 65536, v4
    ds_read_b64_tr_b16 v[20:21], v4 offset:0
    ds_read_b128 v[224:227], v2 offset:32768
    v_mfma_f32_16x16x32_bf16 v[100:103], v[28:31], v[220:223], v[100:103]
    ds_read_b64_tr_b16 v[22:23], v4 offset:1024
    s_waitcnt lgkmcnt(7)
    v_mfma_f32_16x16x32_bf16 v[104:107], v[32:35], v[216:219], v[104:107]
    v_add_u32 v5, 65536, v5
    ds_read_b64_tr_b16 v[24:25], v5 offset:0
    ds_read_b128 v[228:231], v2 offset:34816
    v_mfma_f32_16x16x32_bf16 v[108:111], v[32:35], v[220:223], v[108:111]
    ds_read_b64_tr_b16 v[26:27], v5 offset:1024
    s_waitcnt lgkmcnt(8)
    v_mfma_f32_16x16x32_bf16 v[112:115], v[36:39], v[216:219], v[112:115]
    v_add_u32 v6, 65536, v6
    ds_read_b64_tr_b16 v[28:29], v6 offset:0
    ds_read_b128 v[232:235], v3 offset:32768
    v_mfma_f32_16x16x32_bf16 v[116:119], v[36:39], v[220:223], v[116:119]
    ds_read_b64_tr_b16 v[30:31], v6 offset:1024
    s_waitcnt lgkmcnt(9)
    v_mfma_f32_16x16x32_bf16 v[120:123], v[40:43], v[216:219], v[120:123]
    v_add_u32 v7, 65536, v7
    ds_read_b64_tr_b16 v[32:33], v7 offset:0
    ds_read_b128 v[236:239], v3 offset:34816
    v_mfma_f32_16x16x32_bf16 v[124:127], v[40:43], v[220:223], v[124:127]
    ds_read_b64_tr_b16 v[34:35], v7 offset:1024
    s_waitcnt lgkmcnt(7)
    v_mfma_f32_16x16x32_bf16 v[64:67], v[20:23], v[224:227], v[64:67]
    v_add_u32 v8, 65536, v8
    ds_read_b64_tr_b16 v[36:37], v8 offset:0
    v_mfma_f32_16x16x32_bf16 v[68:71], v[20:23], v[228:231], v[68:71]
    ds_read_b64_tr_b16 v[38:39], v8 offset:1024
    s_waitcnt lgkmcnt(8)
    v_mfma_f32_16x16x32_bf16 v[72:75], v[24:27], v[224:227], v[72:75]
    v_add_u32 v9, 65536, v9
    ds_read_b64_tr_b16 v[40:41], v9 offset:0
    v_mfma_f32_16x16x32_bf16 v[76:79], v[24:27], v[228:231], v[76:79]
    ds_read_b64_tr_b16 v[42:43], v9 offset:1024
    s_waitcnt lgkmcnt(7)
    v_mfma_f32_16x16x32_bf16 v[80:83], v[28:31], v[224:227], v[80:83]
    v_add_u32 v10, 65536, v10
    ds_read_b64_tr_b16 v[20:21], v10 offset:0
    v_mfma_f32_16x16x32_bf16 v[84:87], v[28:31], v[228:231], v[84:87]
    ds_read_b64_tr_b16 v[22:23], v10 offset:1024
    s_waitcnt lgkmcnt(6)
    v_mfma_f32_16x16x32_bf16 v[88:91], v[32:35], v[224:227], v[88:91]
    v_add_u32 v11, 65536, v11
    ds_read_b64_tr_b16 v[24:25], v11 offset:0
    v_mfma_f32_16x16x32_bf16 v[92:95], v[32:35], v[228:231], v[92:95]
    ds_read_b64_tr_b16 v[26:27], v11 offset:1024
    s_waitcnt lgkmcnt(6)
    v_mfma_f32_16x16x32_bf16 v[96:99], v[36:39], v[224:227], v[96:99]
    ds_read_b64_tr_b16 v[28:29], v4 offset:8192
    v_mfma_f32_16x16x32_bf16 v[100:103], v[36:39], v[228:231], v[100:103]
    ds_read_b64_tr_b16 v[30:31], v4 offset:9216
    s_waitcnt lgkmcnt(6)
    v_mfma_f32_16x16x32_bf16 v[104:107], v[40:43], v[224:227], v[104:107]
    ds_read_b64_tr_b16 v[32:33], v5 offset:8192
    v_mfma_f32_16x16x32_bf16 v[108:111], v[40:43], v[228:231], v[108:111]
    ds_read_b64_tr_b16 v[34:35], v5 offset:9216
    s_waitcnt lgkmcnt(6)
    v_mfma_f32_16x16x32_bf16 v[112:115], v[20:23], v[224:227], v[112:115]
    ds_read_b64_tr_b16 v[36:37], v6 offset:8192
    v_mfma_f32_16x16x32_bf16 v[116:119], v[20:23], v[228:231], v[116:119]
    ds_read_b64_tr_b16 v[38:39], v6 offset:9216
    s_waitcnt lgkmcnt(6)
    v_mfma_f32_16x16x32_bf16 v[120:123], v[24:27], v[224:227], v[120:123]
    ds_read_b64_tr_b16 v[40:41], v7 offset:8192
    v_mfma_f32_16x16x32_bf16 v[124:127], v[24:27], v[228:231], v[124:127]
    ds_read_b64_tr_b16 v[42:43], v7 offset:9216
    s_waitcnt lgkmcnt(6)
    v_mfma_f32_16x16x32_bf16 v[64:67], v[28:31], v[232:235], v[64:67]
    ds_read_b64_tr_b16 v[20:21], v8 offset:8192
    v_mfma_f32_16x16x32_bf16 v[68:71], v[28:31], v[236:239], v[68:71]
    ds_read_b64_tr_b16 v[22:23], v8 offset:9216
    s_waitcnt lgkmcnt(6)
    v_mfma_f32_16x16x32_bf16 v[72:75], v[32:35], v[232:235], v[72:75]
    ds_read_b64_tr_b16 v[24:25], v9 offset:8192
    v_mfma_f32_16x16x32_bf16 v[76:79], v[32:35], v[236:239], v[76:79]
    ds_read_b64_tr_b16 v[26:27], v9 offset:9216
    s_waitcnt lgkmcnt(6)
    v_mfma_f32_16x16x32_bf16 v[80:83], v[36:39], v[232:235], v[80:83]
    ds_read_b64_tr_b16 v[28:29], v10 offset:8192
    v_mfma_f32_16x16x32_bf16 v[84:87], v[36:39], v[236:239], v[84:87]
    ds_read_b64_tr_b16 v[30:31], v10 offset:9216
    s_waitcnt lgkmcnt(6)
    v_mfma_f32_16x16x32_bf16 v[88:91], v[40:43], v[232:235], v[88:91]
    ds_read_b64_tr_b16 v[32:33], v11 offset:8192
    v_mfma_f32_16x16x32_bf16 v[92:95], v[40:43], v[236:239], v[92:95]
    ds_read_b64_tr_b16 v[34:35], v11 offset:9216
    s_waitcnt lgkmcnt(6)
    v_mfma_f32_16x16x32_bf16 v[96:99], v[20:23], v[232:235], v[96:99]
    s_barrier
    ds_read_b64_tr_b16 v[36:37], v4 offset:32768
    v_add_u32 v2, 65536, v2
    ds_read_b128 v[240:243], v2 offset:16384
    v_mfma_f32_16x16x32_bf16 v[100:103], v[20:23], v[236:239], v[100:103]
    ds_read_b64_tr_b16 v[38:39], v4 offset:33792
    s_waitcnt lgkmcnt(7)
    v_mfma_f32_16x16x32_bf16 v[104:107], v[24:27], v[232:235], v[104:107]
    ds_read_b64_tr_b16 v[40:41], v5 offset:32768
    ds_read_b128 v[244:247], v2 offset:18432
    v_mfma_f32_16x16x32_bf16 v[108:111], v[24:27], v[236:239], v[108:111]
    ds_read_b64_tr_b16 v[42:43], v5 offset:33792
    s_waitcnt lgkmcnt(8)
    v_mfma_f32_16x16x32_bf16 v[112:115], v[28:31], v[232:235], v[112:115]
    ds_read_b64_tr_b16 v[20:21], v6 offset:32768
    v_add_u32 v3, 65536, v3
    ds_read_b128 v[248:251], v3 offset:16384
    v_mfma_f32_16x16x32_bf16 v[116:119], v[28:31], v[236:239], v[116:119]
    ds_read_b64_tr_b16 v[22:23], v6 offset:33792
    s_waitcnt lgkmcnt(9)
    v_mfma_f32_16x16x32_bf16 v[120:123], v[32:35], v[232:235], v[120:123]
    ds_read_b64_tr_b16 v[24:25], v7 offset:32768
    ds_read_b128 v[252:255], v3 offset:18432
    v_mfma_f32_16x16x32_bf16 v[124:127], v[32:35], v[236:239], v[124:127]
    ds_read_b64_tr_b16 v[26:27], v7 offset:33792
    s_waitcnt lgkmcnt(7)
    v_mfma_f32_16x16x32_bf16 v[64:67], v[36:39], v[240:243], v[64:67]
    ds_read_b64_tr_b16 v[28:29], v8 offset:32768
    v_mfma_f32_16x16x32_bf16 v[68:71], v[36:39], v[244:247], v[68:71]
    ds_read_b64_tr_b16 v[30:31], v8 offset:33792
    s_waitcnt lgkmcnt(8)
    v_mfma_f32_16x16x32_bf16 v[72:75], v[40:43], v[240:243], v[72:75]
    ds_read_b64_tr_b16 v[32:33], v9 offset:32768
    v_mfma_f32_16x16x32_bf16 v[76:79], v[40:43], v[244:247], v[76:79]
    ds_read_b64_tr_b16 v[34:35], v9 offset:33792
    s_waitcnt lgkmcnt(7)
    v_mfma_f32_16x16x32_bf16 v[80:83], v[20:23], v[240:243], v[80:83]
    ds_read_b64_tr_b16 v[36:37], v10 offset:32768
    v_mfma_f32_16x16x32_bf16 v[84:87], v[20:23], v[244:247], v[84:87]
    ds_read_b64_tr_b16 v[38:39], v10 offset:33792
    s_waitcnt lgkmcnt(6)
    v_mfma_f32_16x16x32_bf16 v[88:91], v[24:27], v[240:243], v[88:91]
    ds_read_b64_tr_b16 v[40:41], v11 offset:32768
    v_mfma_f32_16x16x32_bf16 v[92:95], v[24:27], v[244:247], v[92:95]
    ds_read_b64_tr_b16 v[42:43], v11 offset:33792
    s_waitcnt lgkmcnt(6)
    v_mfma_f32_16x16x32_bf16 v[96:99], v[28:31], v[240:243], v[96:99]
    ds_read_b64_tr_b16 v[20:21], v4 offset:40960
    v_mfma_f32_16x16x32_bf16 v[100:103], v[28:31], v[244:247], v[100:103]
    ds_read_b64_tr_b16 v[22:23], v4 offset:41984
    s_waitcnt lgkmcnt(6)
    v_mfma_f32_16x16x32_bf16 v[104:107], v[32:35], v[240:243], v[104:107]
    ds_read_b64_tr_b16 v[24:25], v5 offset:40960
    v_mfma_f32_16x16x32_bf16 v[108:111], v[32:35], v[244:247], v[108:111]
    ds_read_b64_tr_b16 v[26:27], v5 offset:41984
    s_waitcnt lgkmcnt(6)
    v_mfma_f32_16x16x32_bf16 v[112:115], v[36:39], v[240:243], v[112:115]
    ds_read_b64_tr_b16 v[28:29], v6 offset:40960
    v_mfma_f32_16x16x32_bf16 v[116:119], v[36:39], v[244:247], v[116:119]
    ds_read_b64_tr_b16 v[30:31], v6 offset:41984
    s_waitcnt lgkmcnt(6)
    v_mfma_f32_16x16x32_bf16 v[120:123], v[40:43], v[240:243], v[120:123]
    ds_read_b64_tr_b16 v[32:33], v7 offset:40960
    v_mfma_f32_16x16x32_bf16 v[124:127], v[40:43], v[244:247], v[124:127]
    ds_read_b64_tr_b16 v[34:35], v7 offset:41984
    s_waitcnt lgkmcnt(6)
    v_mfma_f32_16x16x32_bf16 v[64:67], v[20:23], v[248:251], v[64:67]
    ds_read_b64_tr_b16 v[36:37], v8 offset:40960
    v_mfma_f32_16x16x32_bf16 v[68:71], v[20:23], v[252:255], v[68:71]
    ds_read_b64_tr_b16 v[38:39], v8 offset:41984
    s_waitcnt lgkmcnt(6)
    v_mfma_f32_16x16x32_bf16 v[72:75], v[24:27], v[248:251], v[72:75]
    ds_read_b64_tr_b16 v[40:41], v9 offset:40960
    v_mfma_f32_16x16x32_bf16 v[76:79], v[24:27], v[252:255], v[76:79]
    ds_read_b64_tr_b16 v[42:43], v9 offset:41984
    s_waitcnt lgkmcnt(6)
    v_mfma_f32_16x16x32_bf16 v[80:83], v[28:31], v[248:251], v[80:83]
    ds_read_b64_tr_b16 v[20:21], v10 offset:40960
    v_mfma_f32_16x16x32_bf16 v[84:87], v[28:31], v[252:255], v[84:87]
    ds_read_b64_tr_b16 v[22:23], v10 offset:41984
    s_waitcnt lgkmcnt(6)
    v_mfma_f32_16x16x32_bf16 v[88:91], v[32:35], v[248:251], v[88:91]
    ds_read_b64_tr_b16 v[24:25], v11 offset:40960
    v_mfma_f32_16x16x32_bf16 v[92:95], v[32:35], v[252:255], v[92:95]
    ds_read_b64_tr_b16 v[26:27], v11 offset:41984
    s_waitcnt lgkmcnt(6)
    v_mfma_f32_16x16x32_bf16 v[96:99], v[36:39], v[248:251], v[96:99]
    s_barrier
    ds_read_b64_tr_b16 v[28:29], v4 offset:49152
    v_mfma_f32_16x16x32_bf16 v[100:103], v[36:39], v[252:255], v[100:103]
    ds_read_b64_tr_b16 v[30:31], v4 offset:50176
    s_waitcnt lgkmcnt(6)
    v_mfma_f32_16x16x32_bf16 v[104:107], v[40:43], v[248:251], v[104:107]
    ds_read_b64_tr_b16 v[32:33], v5 offset:49152
    v_mfma_f32_16x16x32_bf16 v[108:111], v[40:43], v[252:255], v[108:111]
    ds_read_b64_tr_b16 v[34:35], v5 offset:50176
    s_waitcnt lgkmcnt(6)
    v_mfma_f32_16x16x32_bf16 v[112:115], v[20:23], v[248:251], v[112:115]
    ds_read_b64_tr_b16 v[36:37], v6 offset:49152
    v_mfma_f32_16x16x32_bf16 v[116:119], v[20:23], v[252:255], v[116:119]
    ds_read_b64_tr_b16 v[38:39], v6 offset:50176
    s_waitcnt lgkmcnt(6)
    v_mfma_f32_16x16x32_bf16 v[120:123], v[24:27], v[248:251], v[120:123]
    ds_read_b64_tr_b16 v[40:41], v7 offset:49152
    v_mfma_f32_16x16x32_bf16 v[124:127], v[24:27], v[252:255], v[124:127]
    ds_read_b64_tr_b16 v[42:43], v7 offset:50176
    s_lshl_b32 s69, s59, 13
    s_add_u32 s68, s69, 4096
    v_cvt_pk_bf16_f32 v64, v64, v65
    v_cvt_pk_bf16_f32 v65, v66, v67
    v_cvt_pk_bf16_f32 v66, v72, v73
    v_cvt_pk_bf16_f32 v67, v74, v75
    v_pk_max_i16 v64, v64, 0
    v_pk_max_i16 v65, v65, 0
    v_pk_max_i16 v66, v66, 0
    v_pk_max_i16 v67, v67, 0
    buffer_store_dwordx4 v[64:67], v12, s[24:27], s69 offen offset:0 sc1
    v_cvt_pk_bf16_f32 v68, v68, v69
    v_cvt_pk_bf16_f32 v69, v70, v71
    v_cvt_pk_bf16_f32 v70, v76, v77
    v_cvt_pk_bf16_f32 v71, v78, v79
    v_pk_max_i16 v68, v68, 0
    v_pk_max_i16 v69, v69, 0
    v_pk_max_i16 v70, v70, 0
    v_pk_max_i16 v71, v71, 0
    buffer_store_dwordx4 v[68:71], v12, s[24:27], s69 offen offset:1024 sc1
    v_cvt_pk_bf16_f32 v80, v80, v81
    v_cvt_pk_bf16_f32 v81, v82, v83
    v_cvt_pk_bf16_f32 v82, v88, v89
    v_cvt_pk_bf16_f32 v83, v90, v91
    v_pk_max_i16 v80, v80, 0
    v_pk_max_i16 v81, v81, 0
    v_pk_max_i16 v82, v82, 0
    v_pk_max_i16 v83, v83, 0
    buffer_store_dwordx4 v[80:83], v12, s[24:27], s69 offen offset:2048 sc1
    v_cvt_pk_bf16_f32 v84, v84, v85
    v_cvt_pk_bf16_f32 v85, v86, v87
    v_cvt_pk_bf16_f32 v86, v92, v93
    v_cvt_pk_bf16_f32 v87, v94, v95
    v_pk_max_i16 v84, v84, 0
    v_pk_max_i16 v85, v85, 0
    v_pk_max_i16 v86, v86, 0
    v_pk_max_i16 v87, v87, 0
    buffer_store_dwordx4 v[84:87], v12, s[24:27], s69 offen offset:3072 sc1
    s_waitcnt lgkmcnt(6)
    v_mfma_f32_16x16x32_bf16 v[64:67], v[28:31], v[128:131], 0
    ds_read_b64_tr_b16 v[20:21], v4 offset:57344
    v_cvt_pk_bf16_f32 v96, v96, v97
    v_cvt_pk_bf16_f32 v97, v98, v99
    v_mfma_f32_16x16x32_bf16 v[68:71], v[28:31], v[132:135], 0
    ds_read_b64_tr_b16 v[22:23], v4 offset:58368
    v_cvt_pk_bf16_f32 v98, v104, v105
    v_cvt_pk_bf16_f32 v99, v106, v107
    s_waitcnt lgkmcnt(6)
    v_mfma_f32_16x16x32_bf16 v[72:75], v[32:35], v[128:131], 0
    ds_read_b64_tr_b16 v[24:25], v5 offset:57344
    v_pk_max_i16 v96, v96, 0
    v_pk_max_i16 v97, v97, 0
    v_mfma_f32_16x16x32_bf16 v[76:79], v[32:35], v[132:135], 0
    ds_read_b64_tr_b16 v[26:27], v5 offset:58368
    v_pk_max_i16 v98, v98, 0
    v_pk_max_i16 v99, v99, 0
    s_waitcnt lgkmcnt(6)
    v_mfma_f32_16x16x32_bf16 v[80:83], v[36:39], v[128:131], 0
    ds_read_b64_tr_b16 v[28:29], v6 offset:57344
    buffer_store_dwordx4 v[96:99], v12, s[24:27], s68 offen offset:0 sc1
    v_cvt_pk_bf16_f32 v100, v100, v101
    v_mfma_f32_16x16x32_bf16 v[84:87], v[36:39], v[132:135], 0
    ds_read_b64_tr_b16 v[30:31], v6 offset:58368
    v_cvt_pk_bf16_f32 v101, v102, v103
    v_cvt_pk_bf16_f32 v102, v108, v109
    s_waitcnt lgkmcnt(6)
    v_mfma_f32_16x16x32_bf16 v[88:91], v[40:43], v[128:131], 0
    ds_read_b64_tr_b16 v[32:33], v7 offset:57344
    v_cvt_pk_bf16_f32 v103, v110, v111
    v_pk_max_i16 v100, v100, 0
    v_mfma_f32_16x16x32_bf16 v[92:95], v[40:43], v[132:135], 0
    ds_read_b64_tr_b16 v[34:35], v7 offset:58368
    v_pk_max_i16 v101, v101, 0
    v_pk_max_i16 v102, v102, 0
    s_waitcnt lgkmcnt(6)
    v_mfma_f32_16x16x32_bf16 v[64:67], v[20:23], v[136:139], v[64:67]
    ds_read_b64_tr_b16 v[36:37], v8 offset:49152
    v_pk_max_i16 v103, v103, 0
    buffer_store_dwordx4 v[100:103], v12, s[24:27], s68 offen offset:1024 sc1
    v_mfma_f32_16x16x32_bf16 v[68:71], v[20:23], v[140:143], v[68:71]
    ds_read_b64_tr_b16 v[38:39], v8 offset:50176
    v_cvt_pk_bf16_f32 v112, v112, v113
    v_cvt_pk_bf16_f32 v113, v114, v115
    s_waitcnt lgkmcnt(6)
    v_mfma_f32_16x16x32_bf16 v[72:75], v[24:27], v[136:139], v[72:75]
    ds_read_b64_tr_b16 v[40:41], v9 offset:49152
    v_cvt_pk_bf16_f32 v114, v120, v121
    v_cvt_pk_bf16_f32 v115, v122, v123
    v_mfma_f32_16x16x32_bf16 v[76:79], v[24:27], v[140:143], v[76:79]
    ds_read_b64_tr_b16 v[42:43], v9 offset:50176
    v_pk_max_i16 v112, v112, 0
    v_pk_max_i16 v113, v113, 0
    s_waitcnt lgkmcnt(6)
    v_mfma_f32_16x16x32_bf16 v[80:83], v[28:31], v[136:139], v[80:83]
    ds_read_b64_tr_b16 v[20:21], v10 offset:49152
    v_pk_max_i16 v114, v114, 0
    v_pk_max_i16 v115, v115, 0
    v_mfma_f32_16x16x32_bf16 v[84:87], v[28:31], v[140:143], v[84:87]
    ds_read_b64_tr_b16 v[22:23], v10 offset:50176
    buffer_store_dwordx4 v[112:115], v12, s[24:27], s68 offen offset:2048 sc1
    v_cvt_pk_bf16_f32 v116, v116, v117
    s_waitcnt lgkmcnt(6)
    v_mfma_f32_16x16x32_bf16 v[88:91], v[32:35], v[136:139], v[88:91]
    ds_read_b64_tr_b16 v[24:25], v11 offset:49152
    v_cvt_pk_bf16_f32 v117, v118, v119
    v_cvt_pk_bf16_f32 v118, v124, v125
    v_mfma_f32_16x16x32_bf16 v[92:95], v[32:35], v[140:143], v[92:95]
    ds_read_b64_tr_b16 v[26:27], v11 offset:50176
    v_cvt_pk_bf16_f32 v119, v126, v127
    v_pk_max_i16 v116, v116, 0
    s_waitcnt lgkmcnt(6)
    v_mfma_f32_16x16x32_bf16 v[64:67], v[36:39], v[144:147], v[64:67]
    ds_read_b64_tr_b16 v[28:29], v8 offset:57344
    v_pk_max_i16 v117, v117, 0
    v_pk_max_i16 v118, v118, 0
    v_mfma_f32_16x16x32_bf16 v[68:71], v[36:39], v[148:151], v[68:71]
    ds_read_b64_tr_b16 v[30:31], v8 offset:58368
    v_pk_max_i16 v119, v119, 0
    buffer_store_dwordx4 v[116:119], v12, s[24:27], s68 offen offset:3072 sc1
    s_waitcnt lgkmcnt(6)
    v_mfma_f32_16x16x32_bf16 v[72:75], v[40:43], v[144:147], v[72:75]
    ds_read_b64_tr_b16 v[32:33], v9 offset:57344
    v_mfma_f32_16x16x32_bf16 v[76:79], v[40:43], v[148:151], v[76:79]
    ds_read_b64_tr_b16 v[34:35], v9 offset:58368
    s_waitcnt lgkmcnt(6)
    v_mfma_f32_16x16x32_bf16 v[80:83], v[20:23], v[144:147], v[80:83]
    ds_read_b64_tr_b16 v[36:37], v10 offset:57344
    v_mfma_f32_16x16x32_bf16 v[84:87], v[20:23], v[148:151], v[84:87]
    ds_read_b64_tr_b16 v[38:39], v10 offset:58368
    s_waitcnt lgkmcnt(6)
    v_mfma_f32_16x16x32_bf16 v[88:91], v[24:27], v[144:147], v[88:91]
    ds_read_b64_tr_b16 v[40:41], v11 offset:57344
    v_mfma_f32_16x16x32_bf16 v[92:95], v[24:27], v[148:151], v[92:95]
    ds_read_b64_tr_b16 v[42:43], v11 offset:58368
    s_waitcnt lgkmcnt(6)
    v_mfma_f32_16x16x32_bf16 v[64:67], v[28:31], v[152:155], v[64:67]
    s_barrier
    v_add_u32 v4, 32768, v4
    ds_read_b64_tr_b16 v[20:21], v4 offset:32768
    v_mfma_f32_16x16x32_bf16 v[68:71], v[28:31], v[156:159], v[68:71]
    ds_read_b64_tr_b16 v[22:23], v4 offset:33792
    s_waitcnt lgkmcnt(6)
    v_mfma_f32_16x16x32_bf16 v[72:75], v[32:35], v[152:155], v[72:75]
    v_add_u32 v5, 32768, v5
    ds_read_b64_tr_b16 v[24:25], v5 offset:32768
    v_mfma_f32_16x16x32_bf16 v[76:79], v[32:35], v[156:159], v[76:79]
    ds_read_b64_tr_b16 v[26:27], v5 offset:33792
    s_waitcnt lgkmcnt(6)
    v_mfma_f32_16x16x32_bf16 v[80:83], v[36:39], v[152:155], v[80:83]
    v_add_u32 v6, 32768, v6
    ds_read_b64_tr_b16 v[28:29], v6 offset:32768
    v_mfma_f32_16x16x32_bf16 v[84:87], v[36:39], v[156:159], v[84:87]
    ds_read_b64_tr_b16 v[30:31], v6 offset:33792
    s_waitcnt lgkmcnt(6)
    v_mfma_f32_16x16x32_bf16 v[88:91], v[40:43], v[152:155], v[88:91]
    v_add_u32 v7, 32768, v7
    ds_read_b64_tr_b16 v[32:33], v7 offset:32768
    v_mfma_f32_16x16x32_bf16 v[92:95], v[40:43], v[156:159], v[92:95]
    ds_read_b64_tr_b16 v[34:35], v7 offset:33792
    s_waitcnt lgkmcnt(6)
    v_mfma_f32_16x16x32_bf16 v[64:67], v[20:23], v[160:163], v[64:67]
    ds_read_b64_tr_b16 v[36:37], v4 offset:40960
    v_mfma_f32_16x16x32_bf16 v[68:71], v[20:23], v[164:167], v[68:71]
    ds_read_b64_tr_b16 v[38:39], v4 offset:41984
    s_waitcnt lgkmcnt(6)
    v_mfma_f32_16x16x32_bf16 v[72:75], v[24:27], v[160:163], v[72:75]
    ds_read_b64_tr_b16 v[40:41], v5 offset:40960
    v_mfma_f32_16x16x32_bf16 v[76:79], v[24:27], v[164:167], v[76:79]
    ds_read_b64_tr_b16 v[42:43], v5 offset:41984
    s_waitcnt lgkmcnt(6)
    v_mfma_f32_16x16x32_bf16 v[80:83], v[28:31], v[160:163], v[80:83]
    ds_read_b64_tr_b16 v[20:21], v6 offset:40960
    v_mfma_f32_16x16x32_bf16 v[84:87], v[28:31], v[164:167], v[84:87]
    ds_read_b64_tr_b16 v[22:23], v6 offset:41984
    s_waitcnt lgkmcnt(6)
    v_mfma_f32_16x16x32_bf16 v[88:91], v[32:35], v[160:163], v[88:91]
    ds_read_b64_tr_b16 v[24:25], v7 offset:40960
    v_mfma_f32_16x16x32_bf16 v[92:95], v[32:35], v[164:167], v[92:95]
    ds_read_b64_tr_b16 v[26:27], v7 offset:41984
    s_waitcnt lgkmcnt(6)
    v_mfma_f32_16x16x32_bf16 v[64:67], v[36:39], v[168:171], v[64:67]
    v_add_u32 v8, 32768, v8
    ds_read_b64_tr_b16 v[28:29], v8 offset:32768
    v_mfma_f32_16x16x32_bf16 v[68:71], v[36:39], v[172:175], v[68:71]
    ds_read_b64_tr_b16 v[30:31], v8 offset:33792
    s_waitcnt lgkmcnt(6)
    v_mfma_f32_16x16x32_bf16 v[72:75], v[40:43], v[168:171], v[72:75]
    v_add_u32 v9, 32768, v9
    ds_read_b64_tr_b16 v[32:33], v9 offset:32768
    v_mfma_f32_16x16x32_bf16 v[76:79], v[40:43], v[172:175], v[76:79]
    ds_read_b64_tr_b16 v[34:35], v9 offset:33792
    s_waitcnt lgkmcnt(6)
    v_mfma_f32_16x16x32_bf16 v[80:83], v[20:23], v[168:171], v[80:83]
    v_add_u32 v10, 32768, v10
    ds_read_b64_tr_b16 v[36:37], v10 offset:32768
    v_mfma_f32_16x16x32_bf16 v[84:87], v[20:23], v[172:175], v[84:87]
    ds_read_b64_tr_b16 v[38:39], v10 offset:33792
    s_waitcnt lgkmcnt(6)
    v_mfma_f32_16x16x32_bf16 v[88:91], v[24:27], v[168:171], v[88:91]
    v_add_u32 v11, 32768, v11
    ds_read_b64_tr_b16 v[40:41], v11 offset:32768
    v_mfma_f32_16x16x32_bf16 v[92:95], v[24:27], v[172:175], v[92:95]
    ds_read_b64_tr_b16 v[42:43], v11 offset:33792
    s_waitcnt lgkmcnt(6)
    v_mfma_f32_16x16x32_bf16 v[64:67], v[28:31], v[176:179], v[64:67]
    ds_read_b64_tr_b16 v[20:21], v8 offset:40960
    v_mfma_f32_16x16x32_bf16 v[68:71], v[28:31], v[180:183], v[68:71]
    ds_read_b64_tr_b16 v[22:23], v8 offset:41984
    s_waitcnt lgkmcnt(6)
    v_mfma_f32_16x16x32_bf16 v[72:75], v[32:35], v[176:179], v[72:75]
    ds_read_b64_tr_b16 v[24:25], v9 offset:40960
    v_mfma_f32_16x16x32_bf16 v[76:79], v[32:35], v[180:183], v[76:79]
    ds_read_b64_tr_b16 v[26:27], v9 offset:41984
    s_waitcnt lgkmcnt(6)
    v_mfma_f32_16x16x32_bf16 v[80:83], v[36:39], v[176:179], v[80:83]
    ds_read_b64_tr_b16 v[28:29], v10 offset:40960
    v_mfma_f32_16x16x32_bf16 v[84:87], v[36:39], v[180:183], v[84:87]
    ds_read_b64_tr_b16 v[30:31], v10 offset:41984
    s_waitcnt lgkmcnt(6)
    v_mfma_f32_16x16x32_bf16 v[88:91], v[40:43], v[176:179], v[88:91]
    ds_read_b64_tr_b16 v[32:33], v11 offset:40960
    v_mfma_f32_16x16x32_bf16 v[92:95], v[40:43], v[180:183], v[92:95]
    ds_read_b64_tr_b16 v[34:35], v11 offset:41984
    s_waitcnt lgkmcnt(6)
    v_mfma_f32_16x16x32_bf16 v[64:67], v[20:23], v[184:187], v[64:67]
    s_waitcnt vmcnt(0)
    s_barrier
    v_add_u32 v4, 4294868992, v4
    ds_read_b64_tr_b16 v[36:37], v4 offset:16384
    v_mfma_f32_16x16x32_bf16 v[68:71], v[20:23], v[188:191], v[68:71]
    ds_read_b64_tr_b16 v[38:39], v4 offset:17408
    s_waitcnt lgkmcnt(6)
    v_mfma_f32_16x16x32_bf16 v[72:75], v[24:27], v[184:187], v[72:75]
    v_add_u32 v5, 4294868992, v5
    ds_read_b64_tr_b16 v[40:41], v5 offset:16384
    v_mfma_f32_16x16x32_bf16 v[76:79], v[24:27], v[188:191], v[76:79]
    ds_read_b64_tr_b16 v[42:43], v5 offset:17408
    s_waitcnt lgkmcnt(6)
    v_mfma_f32_16x16x32_bf16 v[80:83], v[28:31], v[184:187], v[80:83]
    v_add_u32 v6, 4294868992, v6
    ds_read_b64_tr_b16 v[20:21], v6 offset:16384
    v_mfma_f32_16x16x32_bf16 v[84:87], v[28:31], v[188:191], v[84:87]
    ds_read_b64_tr_b16 v[22:23], v6 offset:17408
    s_waitcnt lgkmcnt(6)
    v_mfma_f32_16x16x32_bf16 v[88:91], v[32:35], v[184:187], v[88:91]
    v_add_u32 v7, 4294868992, v7
    ds_read_b64_tr_b16 v[24:25], v7 offset:16384
    v_mfma_f32_16x16x32_bf16 v[92:95], v[32:35], v[188:191], v[92:95]
    ds_read_b64_tr_b16 v[26:27], v7 offset:17408
    s_waitcnt lgkmcnt(6)
    v_mfma_f32_16x16x32_bf16 v[64:67], v[36:39], v[192:195], v[64:67]
    ds_read_b64_tr_b16 v[28:29], v4 offset:24576
    v_mfma_f32_16x16x32_bf16 v[68:71], v[36:39], v[196:199], v[68:71]
    ds_read_b64_tr_b16 v[30:31], v4 offset:25600
    s_waitcnt lgkmcnt(6)
    v_mfma_f32_16x16x32_bf16 v[72:75], v[40:43], v[192:195], v[72:75]
    ds_read_b64_tr_b16 v[32:33], v5 offset:24576
    v_mfma_f32_16x16x32_bf16 v[76:79], v[40:43], v[196:199], v[76:79]
    ds_read_b64_tr_b16 v[34:35], v5 offset:25600
    s_waitcnt lgkmcnt(6)
    v_mfma_f32_16x16x32_bf16 v[80:83], v[20:23], v[192:195], v[80:83]
    ds_read_b64_tr_b16 v[36:37], v6 offset:24576
    v_mfma_f32_16x16x32_bf16 v[84:87], v[20:23], v[196:199], v[84:87]
    ds_read_b64_tr_b16 v[38:39], v6 offset:25600
    s_waitcnt lgkmcnt(6)
    v_mfma_f32_16x16x32_bf16 v[88:91], v[24:27], v[192:195], v[88:91]
    ds_read_b64_tr_b16 v[40:41], v7 offset:24576
    v_mfma_f32_16x16x32_bf16 v[92:95], v[24:27], v[196:199], v[92:95]
    ds_read_b64_tr_b16 v[42:43], v7 offset:25600
    s_waitcnt lgkmcnt(6)
    v_mfma_f32_16x16x32_bf16 v[64:67], v[28:31], v[200:203], v[64:67]
    v_add_u32 v8, 4294868992, v8
    ds_read_b64_tr_b16 v[20:21], v8 offset:16384
    v_mfma_f32_16x16x32_bf16 v[68:71], v[28:31], v[204:207], v[68:71]
    ds_read_b64_tr_b16 v[22:23], v8 offset:17408
    s_waitcnt lgkmcnt(6)
    v_mfma_f32_16x16x32_bf16 v[72:75], v[32:35], v[200:203], v[72:75]
    v_add_u32 v9, 4294868992, v9
    ds_read_b64_tr_b16 v[24:25], v9 offset:16384
    v_mfma_f32_16x16x32_bf16 v[76:79], v[32:35], v[204:207], v[76:79]
    ds_read_b64_tr_b16 v[26:27], v9 offset:17408
    s_waitcnt lgkmcnt(6)
    v_mfma_f32_16x16x32_bf16 v[80:83], v[36:39], v[200:203], v[80:83]
    v_add_u32 v10, 4294868992, v10
    ds_read_b64_tr_b16 v[28:29], v10 offset:16384
    v_mfma_f32_16x16x32_bf16 v[84:87], v[36:39], v[204:207], v[84:87]
    ds_read_b64_tr_b16 v[30:31], v10 offset:17408
    s_branch L_pg8x
L_pg8:
    s_setpc_b64 s[6:7]
L_pg8x:
    s_waitcnt lgkmcnt(6)
    v_mfma_f32_16x16x32_bf16 v[88:91], v[40:43], v[200:203], v[88:91]
    v_add_u32 v11, 4294868992, v11
    ds_read_b64_tr_b16 v[32:33], v11 offset:16384
    v_mfma_f32_16x16x32_bf16 v[92:95], v[40:43], v[204:207], v[92:95]
    ds_read_b64_tr_b16 v[34:35], v11 offset:17408
    s_waitcnt lgkmcnt(6)
    v_mfma_f32_16x16x32_bf16 v[64:67], v[20:23], v[208:211], v[64:67]
    ds_read_b64_tr_b16 v[36:37], v8 offset:24576
    v_mfma_f32_16x16x32_bf16 v[68:71], v[20:23], v[212:215], v[68:71]
    ds_read_b64_tr_b16 v[38:39], v8 offset:25600
    s_waitcnt lgkmcnt(6)
    v_mfma_f32_16x16x32_bf16 v[72:75], v[24:27], v[208:211], v[72:75]
    ds_read_b64_tr_b16 v[40:41], v9 offset:24576
    v_mfma_f32_16x16x32_bf16 v[76:79], v[24:27], v[212:215], v[76:79]
    ds_read_b64_tr_b16 v[42:43], v9 offset:25600
    s_waitcnt lgkmcnt(6)
    v_mfma_f32_16x16x32_bf16 v[80:83], v[28:31], v[208:211], v[80:83]
    ds_read_b64_tr_b16 v[20:21], v10 offset:24576
    v_mfma_f32_16x16x32_bf16 v[84:87], v[28:31], v[212:215], v[84:87]
    ds_read_b64_tr_b16 v[22:23], v10 offset:25600
    s_waitcnt lgkmcnt(6)
    v_mfma_f32_16x16x32_bf16 v[88:91], v[32:35], v[208:211], v[88:91]
    ds_read_b64_tr_b16 v[24:25], v11 offset:24576
    v_mfma_f32_16x16x32_bf16 v[92:95], v[32:35], v[212:215], v[92:95]
    ds_read_b64_tr_b16 v[26:27], v11 offset:25600
    s_waitcnt lgkmcnt(6)
    v_mfma_f32_16x16x32_bf16 v[64:67], v[36:39], v[216:219], v[64:67]
    s_barrier
    ds_read_b64_tr_b16 v[28:29], v4 offset:0
    v_mfma_f32_16x16x32_bf16 v[68:71], v[36:39], v[220:223], v[68:71]
    ds_read_b64_tr_b16 v[30:31], v4 offset:1024
    s_waitcnt lgkmcnt(6)
    v_mfma_f32_16x16x32_bf16 v[72:75], v[40:43], v[216:219], v[72:75]
    ds_read_b64_tr_b16 v[32:33], v5 offset:0
    v_mfma_f32_16x16x32_bf16 v[76:79], v[40:43], v[220:223], v[76:79]
    ds_read_b64_tr_b16 v[34:35], v5 offset:1024
    s_waitcnt lgkmcnt(6)
    v_mfma_f32_16x16x32_bf16 v[80:83], v[20:23], v[216:219], v[80:83]
    ds_read_b64_tr_b16 v[36:37], v6 offset:0
    v_mfma_f32_16x16x32_bf16 v[84:87], v[20:23], v[220:223], v[84:87]
    ds_read_b64_tr_b16 v[38:39], v6 offset:1024
    s_waitcnt lgkmcnt(6)
    v_mfma_f32_16x16x32_bf16 v[88:91], v[24:27], v[216:219], v[88:91]
    ds_read_b64_tr_b16 v[40:41], v7 offset:0
    v_mfma_f32_16x16x32_bf16 v[92:95], v[24:27], v[220:223], v[92:95]
    ds_read_b64_tr_b16 v[42:43], v7 offset:1024
    s_waitcnt lgkmcnt(6)
    v_mfma_f32_16x16x32_bf16 v[64:67], v[28:31], v[224:227], v[64:67]
    ds_read_b64_tr_b16 v[20:21], v4 offset:8192
    v_mfma_f32_16x16x32_bf16 v[68:71], v[28:31], v[228:231], v[68:71]
    ds_read_b64_tr_b16 v[22:23], v4 offset:9216
    s_waitcnt lgkmcnt(6)
    v_mfma_f32_16x16x32_bf16 v[72:75], v[32:35], v[224:227], v[72:75]
    ds_read_b64_tr_b16 v[24:25], v5 offset:8192
    v_mfma_f32_16x16x32_bf16 v[76:79], v[32:35], v[228:231], v[76:79]
    ds_read_b64_tr_b16 v[26:27], v5 offset:9216
    s_waitcnt lgkmcnt(6)
    v_mfma_f32_16x16x32_bf16 v[80:83], v[36:39], v[224:227], v[80:83]
    ds_read_b64_tr_b16 v[28:29], v6 offset:8192
    v_mfma_f32_16x16x32_bf16 v[84:87], v[36:39], v[228:231], v[84:87]
    ds_read_b64_tr_b16 v[30:31], v6 offset:9216
    s_waitcnt lgkmcnt(6)
    v_mfma_f32_16x16x32_bf16 v[88:91], v[40:43], v[224:227], v[88:91]
    ds_read_b64_tr_b16 v[32:33], v7 offset:8192
    v_mfma_f32_16x16x32_bf16 v[92:95], v[40:43], v[228:231], v[92:95]
    ds_read_b64_tr_b16 v[34:35], v7 offset:9216
    s_waitcnt lgkmcnt(6)
    v_mfma_f32_16x16x32_bf16 v[64:67], v[20:23], v[232:235], v[64:67]
    ds_read_b64_tr_b16 v[36:37], v8 offset:0
    v_mfma_f32_16x16x32_bf16 v[68:71], v[20:23], v[236:239], v[68:71]
    ds_read_b64_tr_b16 v[38:39], v8 offset:1024
    s_waitcnt lgkmcnt(6)
    v_mfma_f32_16x16x32_bf16 v[72:75], v[24:27], v[232:235], v[72:75]
    ds_read_b64_tr_b16 v[40:41], v9 offset:0
    v_mfma_f32_16x16x32_bf16 v[76:79], v[24:27], v[236:239], v[76:79]
    ds_read_b64_tr_b16 v[42:43], v9 offset:1024
    s_waitcnt lgkmcnt(6)
    v_mfma_f32_16x16x32_bf16 v[80:83], v[28:31], v[232:235], v[80:83]
    ds_read_b64_tr_b16 v[20:21], v10 offset:0
    v_mfma_f32_16x16x32_bf16 v[84:87], v[28:31], v[236:239], v[84:87]
    ds_read_b64_tr_b16 v[22:23], v10 offset:1024
    s_waitcnt lgkmcnt(6)
    v_mfma_f32_16x16x32_bf16 v[88:91], v[32:35], v[232:235], v[88:91]
    ds_read_b64_tr_b16 v[24:25], v11 offset:0
    v_mfma_f32_16x16x32_bf16 v[92:95], v[32:35], v[236:239], v[92:95]
    ds_read_b64_tr_b16 v[26:27], v11 offset:1024
    s_waitcnt lgkmcnt(6)
    v_mfma_f32_16x16x32_bf16 v[64:67], v[36:39], v[240:243], v[64:67]
    ds_read_b64_tr_b16 v[28:29], v8 offset:8192
    v_mfma_f32_16x16x32_bf16 v[68:71], v[36:39], v[244:247], v[68:71]
    ds_read_b64_tr_b16 v[30:31], v8 offset:9216
    s_waitcnt lgkmcnt(6)
    v_mfma_f32_16x16x32_bf16 v[72:75], v[40:43], v[240:243], v[72:75]
    ds_read_b64_tr_b16 v[32:33], v9 offset:8192
    v_mfma_f32_16x16x32_bf16 v[76:79], v[40:43], v[244:247], v[76:79]
    ds_read_b64_tr_b16 v[34:35], v9 offset:9216
    s_waitcnt lgkmcnt(6)
    v_mfma_f32_16x16x32_bf16 v[80:83], v[20:23], v[240:243], v[80:83]
    ds_read_b64_tr_b16 v[36:37], v10 offset:8192
    v_mfma_f32_16x16x32_bf16 v[84:87], v[20:23], v[244:247], v[84:87]
    ds_read_b64_tr_b16 v[38:39], v10 offset:9216
    s_waitcnt lgkmcnt(6)
    v_mfma_f32_16x16x32_bf16 v[88:91], v[24:27], v[240:243], v[88:91]
    ds_read_b64_tr_b16 v[40:41], v11 offset:8192
    v_mfma_f32_16x16x32_bf16 v[92:95], v[24:27], v[244:247], v[92:95]
    ds_read_b64_tr_b16 v[42:43], v11 offset:9216
    s_waitcnt lgkmcnt(6)
    v_mfma_f32_16x16x32_bf16 v[64:67], v[28:31], v[248:251], v[64:67]
    v_mfma_f32_16x16x32_bf16 v[68:71], v[28:31], v[252:255], v[68:71]
    s_waitcnt lgkmcnt(4)
    v_mfma_f32_16x16x32_bf16 v[72:75], v[32:35], v[248:251], v[72:75]
    v_mfma_f32_16x16x32_bf16 v[76:79], v[32:35], v[252:255], v[76:79]
    s_waitcnt lgkmcnt(2)
    v_mfma_f32_16x16x32_bf16 v[80:83], v[36:39], v[248:251], v[80:83]
    v_mfma_f32_16x16x32_bf16 v[84:87], v[36:39], v[252:255], v[84:87]
    s_waitcnt lgkmcnt(0)
    v_mfma_f32_16x16x32_bf16 v[88:91], v[40:43], v[248:251], v[88:91]
    v_mfma_f32_16x16x32_bf16 v[92:95], v[40:43], v[252:255], v[92:95]
    s_barrier
    v_pk_mul_f32 v[16:17], v[64:65], s[52:53]
    v_pk_mul_f32 v[18:19], v[66:67], s[52:53]
    v_exp_f32_e64 v16, v16 clamp
    v_max_f32 v64, s42, v64
    v_exp_f32_e64 v17, v17 clamp
    v_max_f32 v65, s42, v65
    v_exp_f32_e64 v18, v18 clamp
    v_max_f32 v66, s42, v66
    v_exp_f32_e64 v19, v19 clamp
    v_max_f32 v67, s42, v67
    v_pk_add_f32 v[16:17], v[16:17], v[64:65]
    v_pk_add_f32 v[18:19], v[18:19], v[66:67]
    v_cvt_pk_bf16_f32 v64, v16, v17
    v_cvt_pk_bf16_f32 v65, v18, v19
    v_pk_mul_f32 v[16:17], v[72:73], s[52:53]
    v_pk_mul_f32 v[18:19], v[74:75], s[52:53]
    v_exp_f32_e64 v16, v16 clamp
    v_max_f32 v72, s42, v72
    v_exp_f32_e64 v17, v17 clamp
    v_max_f32 v73, s42, v73
    v_exp_f32_e64 v18, v18 clamp
    v_max_f32 v74, s42, v74
    v_exp_f32_e64 v19, v19 clamp
    v_max_f32 v75, s42, v75
    v_pk_add_f32 v[16:17], v[16:17], v[72:73]
    v_pk_add_f32 v[18:19], v[18:19], v[74:75]
    v_cvt_pk_bf16_f32 v66, v16, v17
    v_cvt_pk_bf16_f32 v67, v18, v19
    v_pk_mul_f32 v[16:17], v[68:69], s[52:53]
    v_pk_mul_f32 v[18:19], v[70:71], s[52:53]
    v_exp_f32_e64 v16, v16 clamp
    v_max_f32 v68, s42, v68
    v_exp_f32_e64 v17, v17 clamp
    v_max_f32 v69, s42, v69
    v_exp_f32_e64 v18, v18 clamp
    v_max_f32 v70, s42, v70
    v_exp_f32_e64 v19, v19 clamp
    v_max_f32 v71, s42, v71
    v_pk_add_f32 v[16:17], v[16:17], v[68:69]
    v_pk_add_f32 v[18:19], v[18:19], v[70:71]
    v_cvt_pk_bf16_f32 v68, v16, v17
    v_cvt_pk_bf16_f32 v69, v18, v19
    v_pk_mul_f32 v[16:17], v[76:77], s[52:53]
    v_pk_mul_f32 v[18:19], v[78:79], s[52:53]
    v_exp_f32_e64 v16, v16 clamp
    v_max_f32 v76, s42, v76
    v_exp_f32_e64 v17, v17 clamp
    v_max_f32 v77, s42, v77
    v_exp_f32_e64 v18, v18 clamp
    v_max_f32 v78, s42, v78
    v_exp_f32_e64 v19, v19 clamp
    v_max_f32 v79, s42, v79
    v_pk_add_f32 v[16:17], v[16:17], v[76:77]
    v_pk_add_f32 v[18:19], v[18:19], v[78:79]
    v_cvt_pk_bf16_f32 v70, v16, v17
    v_cvt_pk_bf16_f32 v71, v18, v19
    v_pk_mul_f32 v[16:17], v[80:81], s[52:53]
    v_pk_mul_f32 v[18:19], v[82:83], s[52:53]
    v_exp_f32_e64 v16, v16 clamp
    v_max_f32 v80, s42, v80
    v_exp_f32_e64 v17, v17 clamp
    v_max_f32 v81, s42, v81
    v_exp_f32_e64 v18, v18 clamp
    v_max_f32 v82, s42, v82
    v_exp_f32_e64 v19, v19 clamp
    v_max_f32 v83, s42, v83
    v_pk_add_f32 v[16:17], v[16:17], v[80:81]
    v_pk_add_f32 v[18:19], v[18:19], v[82:83]
    v_cvt_pk_bf16_f32 v72, v16, v17
    v_cvt_pk_bf16_f32 v73, v18, v19
    v_pk_mul_f32 v[16:17], v[88:89], s[52:53]
    v_pk_mul_f32 v[18:19], v[90:91], s[52:53]
    v_exp_f32_e64 v16, v16 clamp
    v_max_f32 v88, s42, v88
    v_exp_f32_e64 v17, v17 clamp
    v_max_f32 v89, s42, v89
    v_exp_f32_e64 v18, v18 clamp
    v_max_f32 v90, s42, v90
    v_exp_f32_e64 v19, v19 clamp
    v_max_f32 v91, s42, v91
    v_pk_add_f32 v[16:17], v[16:17], v[88:89]
    v_pk_add_f32 v[18:19], v[18:19], v[90:91]
    v_cvt_pk_bf16_f32 v74, v16, v17
    v_cvt_pk_bf16_f32 v75, v18, v19
    v_pk_mul_f32 v[16:17], v[84:85], s[52:53]
    v_pk_mul_f32 v[18:19], v[86:87], s[52:53]
    v_exp_f32_e64 v16, v16 clamp
    v_max_f32 v84, s42, v84
    v_exp_f32_e64 v17, v17 clamp
    v_max_f32 v85, s42, v85
    v_exp_f32_e64 v18, v18 clamp
    v_max_f32 v86, s42, v86
    v_exp_f32_e64 v19, v19 clamp
    v_max_f32 v87, s42, v87
    v_pk_add_f32 v[16:17], v[16:17], v[84:85]
    v_pk_add_f32 v[18:19], v[18:19], v[86:87]
    v_cvt_pk_bf16_f32 v76, v16, v17
    v_cvt_pk_bf16_f32 v77, v18, v19
    v_pk_mul_f32 v[16:17], v[92:93], s[52:53]
    v_pk_mul_f32 v[18:19], v[94:95], s[52:53]
    v_exp_f32_e64 v16, v16 clamp
    v_max_f32 v92, s42, v92
    v_exp_f32_e64 v17, v17 clamp
    v_max_f32 v93, s42, v93
    v_exp_f32_e64 v18, v18 clamp
    v_max_f32 v94, s42, v94
    v_exp_f32_e64 v19, v19 clamp
    v_max_f32 v95, s42, v95
    v_pk_add_f32 v[16:17], v[16:17], v[92:93]
    v_pk_add_f32 v[18:19], v[18:19], v[94:95]
    v_cvt_pk_bf16_f32 v78, v16, v17
    v_cvt_pk_bf16_f32 v79, v18, v19
    s_lshr_b32 s67, s56, 1
    s_lshl_b32 s67, s67, 13
    v_lshl_add_u32 v2, v1, 4, s67
    v_mov_b32 v4, v14
    v_xor_b32 v5, 32, v14
    v_xor_b32 v6, 128, v14
    v_xor_b32 v7, 160, v14
    s_barrier
    v_add_u32 v2, 65536, v2
    ds_read_b128 v[128:131], v2 offset:49152
    ds_read_b64_tr_b16 v[136:137], v4 offset:49152
    ds_read_b64_tr_b16 v[138:139], v4 offset:53248
    ds_read_b128 v[132:135], v2 offset:50176
    ds_read_b64_tr_b16 v[140:141], v5 offset:49152
    ds_read_b64_tr_b16 v[142:143], v5 offset:53248
    ds_read_b128 v[144:147], v2 offset:51200
    ds_read_b64_tr_b16 v[152:153], v4 offset:57344
    ds_read_b64_tr_b16 v[154:155], v4 offset:61440
    ds_read_b128 v[148:151], v2 offset:52224
    ds_read_b64_tr_b16 v[156:157], v5 offset:57344
    ds_read_b64_tr_b16 v[158:159], v5 offset:61440
    s_waitcnt lgkmcnt(6)
    v_mfma_f32_16x16x32_bf16 v[96:99], v[136:139], v[128:131], 0
    ds_read_b128 v[160:163], v2 offset:53248
    ds_read_b64_tr_b16 v[168:169], v6 offset:49152
    v_mfma_f32_16x16x32_bf16 v[100:103], v[136:139], v[132:135], 0
    ds_read_b64_tr_b16 v[170:171], v6 offset:53248
    ds_read_b128 v[164:167], v2 offset:54272
    v_mfma_f32_16x16x32_bf16 v[104:107], v[140:143], v[128:131], 0
    ds_read_b64_tr_b16 v[172:173], v7 offset:49152
    ds_read_b64_tr_b16 v[174:175], v7 offset:53248
    v_mfma_f32_16x16x32_bf16 v[108:111], v[140:143], v[132:135], 0
    s_waitcnt lgkmcnt(6)
    v_mfma_f32_16x16x32_bf16 v[96:99], v[152:155], v[144:147], v[96:99]
    ds_read_b128 v[176:179], v2 offset:55296
    ds_read_b64_tr_b16 v[184:185], v6 offset:57344
    v_mfma_f32_16x16x32_bf16 v[100:103], v[152:155], v[148:151], v[100:103]
    ds_read_b64_tr_b16 v[186:187], v6 offset:61440
    ds_read_b128 v[180:183], v2 offset:56320
    v_mfma_f32_16x16x32_bf16 v[104:107], v[156:159], v[144:147], v[104:107]
    ds_read_b64_tr_b16 v[188:189], v7 offset:57344
    ds_read_b64_tr_b16 v[190:191], v7 offset:61440
    v_mfma_f32_16x16x32_bf16 v[108:111], v[156:159], v[148:151], v[108:111]
    s_waitcnt lgkmcnt(6)
    v_mfma_f32_16x16x32_bf16 v[96:99], v[168:171], v[160:163], v[96:99]
    v_mfma_f32_16x16x32_bf16 v[100:103], v[168:171], v[164:167], v[100:103]
    v_mfma_f32_16x16x32_bf16 v[104:107], v[172:175], v[160:163], v[104:107]
    v_mfma_f32_16x16x32_bf16 v[108:111], v[172:175], v[164:167], v[108:111]
    s_waitcnt lgkmcnt(0)
    s_barrier
    v_mfma_f32_16x16x32_bf16 v[96:99], v[184:187], v[176:179], v[96:99]
    v_add_u32 v2, 32768, v2
    ds_read_b128 v[128:131], v2 offset:32768
    ds_read_b64_tr_b16 v[136:137], v4 offset:32768
    ds_read_b64_tr_b16 v[138:139], v4 offset:36864
    v_mfma_f32_16x16x32_bf16 v[100:103], v[184:187], v[180:183], v[100:103]
    ds_read_b128 v[132:135], v2 offset:33792
    ds_read_b64_tr_b16 v[140:141], v5 offset:32768
    ds_read_b64_tr_b16 v[142:143], v5 offset:36864
    v_mfma_f32_16x16x32_bf16 v[104:107], v[188:191], v[176:179], v[104:107]
    ds_read_b128 v[144:147], v2 offset:34816
    ds_read_b64_tr_b16 v[152:153], v4 offset:40960
    ds_read_b64_tr_b16 v[154:155], v4 offset:45056
    v_mfma_f32_16x16x32_bf16 v[108:111], v[188:191], v[180:183], v[108:111]
    ds_read_b128 v[148:151], v2 offset:35840
    ds_read_b64_tr_b16 v[156:157], v5 offset:40960
    ds_read_b64_tr_b16 v[158:159], v5 offset:45056
    s_waitcnt lgkmcnt(6)
    v_mfma_f32_16x16x32_bf16 v[96:99], v[136:139], v[128:131], v[96:99]
    ds_read_b128 v[160:163], v2 offset:36864
    ds_read_b64_tr_b16 v[168:169], v6 offset:32768
    v_mfma_f32_16x16x32_bf16 v[100:103], v[136:139], v[132:135], v[100:103]
    ds_read_b64_tr_b16 v[170:171], v6 offset:36864
    ds_read_b128 v[164:167], v2 offset:37888
    v_mfma_f32_16x16x32_bf16 v[104:107], v[140:143], v[128:131], v[104:107]
    ds_read_b64_tr_b16 v[172:173], v7 offset:32768
    ds_read_b64_tr_b16 v[174:175], v7 offset:36864
    v_mfma_f32_16x16x32_bf16 v[108:111], v[140:143], v[132:135], v[108:111]
    s_waitcnt lgkmcnt(6)
    v_mfma_f32_16x16x32_bf16 v[96:99], v[152:155], v[144:147], v[96:99]
    ds_read_b128 v[176:179], v2 offset:38912
    ds_read_b64_tr_b16 v[184:185], v6 offset:40960
    v_mfma_f32_16x16x32_bf16 v[100:103], v[152:155], v[148:151], v[100:103]
    ds_read_b64_tr_b16 v[186:187], v6 offset:45056
    ds_read_b128 v[180:183], v2 offset:39936
    v_mfma_f32_16x16x32_bf16 v[104:107], v[156:159], v[144:147], v[104:107]
    ds_read_b64_tr_b16 v[188:189], v7 offset:40960
    ds_read_b64_tr_b16 v[190:191], v7 offset:45056
    v_mfma_f32_16x16x32_bf16 v[108:111], v[156:159], v[148:151], v[108:111]
    s_waitcnt lgkmcnt(6)
    v_mfma_f32_16x16x32_bf16 v[96:99], v[168:171], v[160:163], v[96:99]
    v_mfma_f32_16x16x32_bf16 v[100:103], v[168:171], v[164:167], v[100:103]
    v_mfma_f32_16x16x32_bf16 v[104:107], v[172:175], v[160:163], v[104:107]
    v_mfma_f32_16x16x32_bf16 v[108:111], v[172:175], v[164:167], v[108:111]
    s_waitcnt lgkmcnt(0)
    s_barrier
    v_mfma_f32_16x16x32_bf16 v[96:99], v[184:187], v[176:179], v[96:99]
    v_add_u32 v2, 4294868992, v2
    ds_read_b128 v[128:131], v2 offset:16384
    v_add_u32 v4, 65536, v4
    ds_read_b64_tr_b16 v[136:137], v4 offset:0
    ds_read_b64_tr_b16 v[138:139], v4 offset:4096
    v_mfma_f32_16x16x32_bf16 v[100:103], v[184:187], v[180:183], v[100:103]
    ds_read_b128 v[132:135], v2 offset:17408
    v_add_u32 v5, 65536, v5
    ds_read_b64_tr_b16 v[140:141], v5 offset:0
    ds_read_b64_tr_b16 v[142:143], v5 offset:4096
    v_mfma_f32_16x16x32_bf16 v[104:107], v[188:191], v[176:179], v[104:107]
    ds_read_b128 v[144:147], v2 offset:18432
    ds_read_b64_tr_b16 v[152:153], v4 offset:8192
    ds_read_b64_tr_b16 v[154:155], v4 offset:12288
    v_mfma_f32_16x16x32_bf16 v[108:111], v[188:191], v[180:183], v[108:111]
    ds_read_b128 v[148:151], v2 offset:19456
    ds_read_b64_tr_b16 v[156:157], v5 offset:8192
    ds_read_b64_tr_b16 v[158:159], v5 offset:12288
    s_waitcnt lgkmcnt(6)
    v_mfma_f32_16x16x32_bf16 v[96:99], v[136:139], v[128:131], v[96:99]
    ds_read_b128 v[160:163], v2 offset:20480
    v_add_u32 v6, 65536, v6
    ds_read_b64_tr_b16 v[168:169], v6 offset:0
    v_mfma_f32_16x16x32_bf16 v[100:103], v[136:139], v[132:135], v[100:103]
    ds_read_b64_tr_b16 v[170:171], v6 offset:4096
    ds_read_b128 v[164:167], v2 offset:21504
    v_mfma_f32_16x16x32_bf16 v[104:107], v[140:143], v[128:131], v[104:107]
    v_add_u32 v7, 65536, v7
    ds_read_b64_tr_b16 v[172:173], v7 offset:0
    ds_read_b64_tr_b16 v[174:175], v7 offset:4096
    v_mfma_f32_16x16x32_bf16 v[108:111], v[140:143], v[132:135], v[108:111]
    s_waitcnt lgkmcnt(6)
    v_mfma_f32_16x16x32_bf16 v[96:99], v[152:155], v[144:147], v[96:99]
    ds_read_b128 v[176:179], v2 offset:22528
    ds_read_b64_tr_b16 v[184:185], v6 offset:8192
    v_mfma_f32_16x16x32_bf16 v[100:103], v[152:155], v[148:151], v[100:103]
    ds_read_b64_tr_b16 v[186:187], v6 offset:12288
    ds_read_b128 v[180:183], v2 offset:23552
    v_mfma_f32_16x16x32_bf16 v[104:107], v[156:159], v[144:147], v[104:107]
    ds_read_b64_tr_b16 v[188:189], v7 offset:8192
    ds_read_b64_tr_b16 v[190:191], v7 offset:12288
    v_mfma_f32_16x16x32_bf16 v[108:111], v[156:159], v[148:151], v[108:111]
    s_waitcnt lgkmcnt(6)
    v_mfma_f32_16x16x32_bf16 v[96:99], v[168:171], v[160:163], v[96:99]
    v_mfma_f32_16x16x32_bf16 v[100:103], v[168:171], v[164:167], v[100:103]
    v_mfma_f32_16x16x32_bf16 v[104:107], v[172:175], v[160:163], v[104:107]
    v_mfma_f32_16x16x32_bf16 v[108:111], v[172:175], v[164:167], v[108:111]
    s_waitcnt lgkmcnt(0)
    s_barrier
    v_mfma_f32_16x16x32_bf16 v[96:99], v[184:187], v[176:179], v[96:99]
    ds_read_b128 v[128:131], v2 offset:0
    ds_read_b64_tr_b16 v[136:137], v4 offset:16384
    ds_read_b64_tr_b16 v[138:139], v4 offset:20480
    v_mfma_f32_16x16x32_bf16 v[100:103], v[184:187], v[180:183], v[100:103]
    ds_read_b128 v[132:135], v2 offset:1024
    ds_read_b64_tr_b16 v[140:141], v5 offset:16384
    ds_read_b64_tr_b16 v[142:143], v5 offset:20480
    v_mfma_f32_16x16x32_bf16 v[104:107], v[188:191], v[176:179], v[104:107]
    ds_read_b128 v[144:147], v2 offset:2048
    ds_read_b64_tr_b16 v[152:153], v4 offset:24576
    ds_read_b64_tr_b16 v[154:155], v4 offset:28672
    v_mfma_f32_16x16x32_bf16 v[108:111], v[188:191], v[180:183], v[108:111]
    ds_read_b128 v[148:151], v2 offset:3072
    ds_read_b64_tr_b16 v[156:157], v5 offset:24576
    ds_read_b64_tr_b16 v[158:159], v5 offset:28672
    v_lshlrev_b32 v16, 2, v1
    v_add_u32 v16, 149504, v16
    v_and_b32 v17, 48, v1
    v_add_u32 v17, 150528, v17
    ds_read2st64_b32 v[20:21], v16 offset0:0 offset1:1
    ds_read2st64_b32 v[22:23], v16 offset0:2 offset1:3
    ds_read_b128 v[36:39], v17 offset:0
    s_waitcnt lgkmcnt(14)
    ds_read2st64_b32 v[24:25], v16 offset0:5 offset1:6
    s_waitcnt lgkmcnt(14)
    ds_read2st64_b32 v[26:27], v16 offset0:7 offset1:8
    s_waitcnt lgkmcnt(14)
    ds_read_b128 v[40:43], v17 offset:1280
    s_waitcnt lgkmcnt(14)
    ds_read2st64_b32 v[28:29], v16 offset0:10 offset1:11
    s_waitcnt lgkmcnt(14)
    ds_read2st64_b32 v[30:31], v16 offset0:12 offset1:13
    s_waitcnt lgkmcnt(14)
    ds_read_b128 v[44:47], v17 offset:2560
    s_waitcnt lgkmcnt(14)
    ds_read2st64_b32 v[32:33], v16 offset0:15 offset1:16
    s_waitcnt lgkmcnt(14)
    ds_read2st64_b32 v[34:35], v16 offset0:17 offset1:18
    s_waitcnt lgkmcnt(14)
    ds_read_b128 v[48:51], v17 offset:3840
    v_and_b32 v16, 2, v1
    v_cmp_eq_u32 vcc, 0, v16
    v_mov_b32 v60, s42
    v_mov_b32 v61, s42
    v_mov_b32 v62, s42
    v_mov_b32 v63, s42
    s_lshl_b32 s67, s59, 12
    s_add_u32 s79, s67, 90112
    s_waitcnt lgkmcnt(6)
    v_cvt_pk_bf16_f32 v20, v20, v21
    v_cvt_pk_bf16_f32 v21, v22, v23
    v_cvt_pk_bf16_f32 v24, v24, v25
    v_cvt_pk_bf16_f32 v25, v26, v27
    v_cvt_pk_bf16_f32 v36, v36, v37
    v_cvt_pk_bf16_f32 v37, v38, v39
    v_cvt_pk_bf16_f32 v38, v40, v41
    v_cvt_pk_bf16_f32 v39, v42, v43
    v_cndmask_b32 v36, 0, v36, vcc
    v_cndmask_b32 v37, 0, v37, vcc
    v_cndmask_b32 v38, v38, 0, vcc
    v_cndmask_b32 v39, v39, 0, vcc
    s_nop 1
    v_mfma_f32_16x16x32_bf16 v[52:55], v[36:39], v[64:67], v[60:63]
    v_mfma_f32_16x16x16_bf16 v[80:83], v[20:21], v[64:65], 0
    v_mfma_f32_16x16x16_bf16 v[84:87], v[24:25], v[66:67], 0
    v_mfma_f32_16x16x32_bf16 v[56:59], v[36:39], v[68:71], v[60:63]
    v_mfma_f32_16x16x16_bf16 v[88:91], v[20:21], v[68:69], 0
    v_mfma_f32_16x16x16_bf16 v[92:95], v[24:25], v[70:71], 0
    s_waitcnt lgkmcnt(0)
    v_cvt_pk_bf16_f32 v28, v28, v29
    v_cvt_pk_bf16_f32 v29, v30, v31
    v_cvt_pk_bf16_f32 v32, v32, v33
    v_cvt_pk_bf16_f32 v33, v34, v35
    v_cvt_pk_bf16_f32 v44, v44, v45
    v_cvt_pk_bf16_f32 v45, v46, v47
    v_cvt_pk_bf16_f32 v46, v48, v49
    v_cvt_pk_bf16_f32 v47, v50, v51
    v_cndmask_b32 v44, 0, v44, vcc
    v_cndmask_b32 v45, 0, v45, vcc
    v_cndmask_b32 v46, v46, 0, vcc
    v_cndmask_b32 v47, v47, 0, vcc
    s_nop 1
    v_mfma_f32_16x16x32_bf16 v[40:43], v[44:47], v[72:75], v[60:63]
    v_mfma_f32_16x16x16_bf16 v[112:115], v[28:29], v[72:73], 0
    v_mfma_f32_16x16x16_bf16 v[116:119], v[32:33], v[74:75], 0
    v_mfma_f32_16x16x32_bf16 v[48:51], v[44:47], v[76:79], v[60:63]
    v_mfma_f32_16x16x16_bf16 v[120:123], v[28:29], v[76:77], 0
    v_mfma_f32_16x16x16_bf16 v[124:127], v[32:33], v[78:79], 0
    v_rcp_f32 v52, v52
    v_rcp_f32 v54, v54
    v_mul_f32 v80, v80, v52
    v_mul_f32 v81, v81, v52
    v_mul_f32 v82, v82, v52
    v_mul_f32 v83, v83, v52
    v_mul_f32 v84, v84, v54
    v_mul_f32 v85, v85, v54
    v_mul_f32 v86, v86, v54
    v_mul_f32 v87, v87, v54
    v_cvt_pk_bf16_f32 v80, v80, v81
    v_cvt_pk_bf16_f32 v81, v82, v83
    v_cvt_pk_bf16_f32 v82, v84, v85
    v_cvt_pk_bf16_f32 v83, v86, v87
    buffer_store_dwordx4 v[80:83], v12, s[24:27], s79 offen offset:0 sc1
    v_rcp_f32 v56, v56
    v_rcp_f32 v58, v58
    v_mul_f32 v88, v88, v56
    v_mul_f32 v89, v89, v56
    v_mul_f32 v90, v90, v56
    v_mul_f32 v91, v91, v56
    v_mul_f32 v92, v92, v58
    v_mul_f32 v93, v93, v58
    v_mul_f32 v94, v94, v58
    v_mul_f32 v95, v95, v58
    v_cvt_pk_bf16_f32 v88, v88, v89
    v_cvt_pk_bf16_f32 v89, v90, v91
    v_cvt_pk_bf16_f32 v90, v92, v93
    v_cvt_pk_bf16_f32 v91, v94, v95
    buffer_store_dwordx4 v[88:91], v12, s[24:27], s79 offen offset:1024 sc1
    v_rcp_f32 v40, v40
    v_rcp_f32 v42, v42
    v_mul_f32 v112, v112, v40
    v_mul_f32 v113, v113, v40
    v_mul_f32 v114, v114, v40
    v_mul_f32 v115, v115, v40
    v_mul_f32 v116, v116, v42
    v_mul_f32 v117, v117, v42
    v_mul_f32 v118, v118, v42
    v_mul_f32 v119, v119, v42
    v_cvt_pk_bf16_f32 v112, v112, v113
    v_cvt_pk_bf16_f32 v113, v114, v115
    v_cvt_pk_bf16_f32 v114, v116, v117
    v_cvt_pk_bf16_f32 v115, v118, v119
    buffer_store_dwordx4 v[112:115], v12, s[24:27], s79 offen offset:2048 sc1
    v_rcp_f32 v48, v48
    v_rcp_f32 v50, v50
    v_mul_f32 v120, v120, v48
    v_mul_f32 v121, v121, v48
    v_mul_f32 v122, v122, v48
    v_mul_f32 v123, v123, v48
    v_mul_f32 v124, v124, v50
    v_mul_f32 v125, v125, v50
    v_mul_f32 v126, v126, v50
    v_mul_f32 v127, v127, v50
    v_cvt_pk_bf16_f32 v120, v120, v121
    v_cvt_pk_bf16_f32 v121, v122, v123
    v_cvt_pk_bf16_f32 v122, v124, v125
    v_cvt_pk_bf16_f32 v123, v126, v127
    buffer_store_dwordx4 v[120:123], v12, s[24:27], s79 offen offset:3072 sc1
    v_mfma_f32_16x16x32_bf16 v[96:99], v[136:139], v[128:131], v[96:99]
    ds_read_b128 v[160:163], v2 offset:4096
    ds_read_b64_tr_b16 v[168:169], v6 offset:16384
    v_mfma_f32_16x16x32_bf16 v[100:103], v[136:139], v[132:135], v[100:103]
    ds_read_b64_tr_b16 v[170:171], v6 offset:20480
    ds_read_b128 v[164:167], v2 offset:5120
    v_mfma_f32_16x16x32_bf16 v[104:107], v[140:143], v[128:131], v[104:107]
    ds_read_b64_tr_b16 v[172:173], v7 offset:16384
    ds_read_b64_tr_b16 v[174:175], v7 offset:20480
    v_mfma_f32_16x16x32_bf16 v[108:111], v[140:143], v[132:135], v[108:111]
    v_mfma_f32_16x16x32_bf16 v[96:99], v[152:155], v[144:147], v[96:99]
    ds_read_b128 v[176:179], v2 offset:6144
    ds_read_b64_tr_b16 v[184:185], v6 offset:24576
    v_mfma_f32_16x16x32_bf16 v[100:103], v[152:155], v[148:151], v[100:103]
    ds_read_b64_tr_b16 v[186:187], v6 offset:28672
    ds_read_b128 v[180:183], v2 offset:7168
    v_mfma_f32_16x16x32_bf16 v[104:107], v[156:159], v[144:147], v[104:107]
    ds_read_b64_tr_b16 v[188:189], v7 offset:24576
    ds_read_b64_tr_b16 v[190:191], v7 offset:28672
    v_mfma_f32_16x16x32_bf16 v[108:111], v[156:159], v[148:151], v[108:111]
    s_waitcnt lgkmcnt(6)
    v_mfma_f32_16x16x32_bf16 v[96:99], v[168:171], v[160:163], v[96:99]
    v_mfma_f32_16x16x32_bf16 v[100:103], v[168:171], v[164:167], v[100:103]
    v_mfma_f32_16x16x32_bf16 v[104:107], v[172:175], v[160:163], v[104:107]
    v_mfma_f32_16x16x32_bf16 v[108:111], v[172:175], v[164:167], v[108:111]
    s_waitcnt lgkmcnt(0)
    s_barrier
    v_mfma_f32_16x16x32_bf16 v[96:99], v[184:187], v[176:179], v[96:99]
    v_add_u32 v2, 65536, v2
    ds_read_b128 v[128:131], v2 offset:49152
    ds_read_b64_tr_b16 v[136:137], v4 offset:32768
    ds_read_b64_tr_b16 v[138:139], v4 offset:36864
    v_mfma_f32_16x16x32_bf16 v[100:103], v[184:187], v[180:183], v[100:103]
    ds_read_b128 v[132:135], v2 offset:50176
    ds_read_b64_tr_b16 v[140:141], v5 offset:32768
    ds_read_b64_tr_b16 v[142:143], v5 offset:36864
    v_mfma_f32_16x16x32_bf16 v[104:107], v[188:191], v[176:179], v[104:107]
    ds_read_b128 v[144:147], v2 offset:51200
    ds_read_b64_tr_b16 v[152:153], v4 offset:40960
    ds_read_b64_tr_b16 v[154:155], v4 offset:45056
    v_mfma_f32_16x16x32_bf16 v[108:111], v[188:191], v[180:183], v[108:111]
    ds_read_b128 v[148:151], v2 offset:52224
    ds_read_b64_tr_b16 v[156:157], v5 offset:40960
    ds_read_b64_tr_b16 v[158:159], v5 offset:45056
    s_waitcnt lgkmcnt(6)
    v_mfma_f32_16x16x32_bf16 v[96:99], v[136:139], v[128:131], v[96:99]
    ds_read_b128 v[160:163], v2 offset:53248
    ds_read_b64_tr_b16 v[168:169], v6 offset:32768
    v_mfma_f32_16x16x32_bf16 v[100:103], v[136:139], v[132:135], v[100:103]
    ds_read_b64_tr_b16 v[170:171], v6 offset:36864
    ds_read_b128 v[164:167], v2 offset:54272
    v_mfma_f32_16x16x32_bf16 v[104:107], v[140:143], v[128:131], v[104:107]
    ds_read_b64_tr_b16 v[172:173], v7 offset:32768
    ds_read_b64_tr_b16 v[174:175], v7 offset:36864
    v_mfma_f32_16x16x32_bf16 v[108:111], v[140:143], v[132:135], v[108:111]
    s_waitcnt lgkmcnt(6)
    v_mfma_f32_16x16x32_bf16 v[96:99], v[152:155], v[144:147], v[96:99]
    ds_read_b128 v[176:179], v2 offset:55296
    ds_read_b64_tr_b16 v[184:185], v6 offset:40960
    s_branch L_pg9x
L_pg9:
    s_setpc_b64 s[6:7]
L_pg9x:
    v_mfma_f32_16x16x32_bf16 v[100:103], v[152:155], v[148:151], v[100:103]
    ds_read_b64_tr_b16 v[186:187], v6 offset:45056
    ds_read_b128 v[180:183], v2 offset:56320
    v_mfma_f32_16x16x32_bf16 v[104:107], v[156:159], v[144:147], v[104:107]
    ds_read_b64_tr_b16 v[188:189], v7 offset:40960
    ds_read_b64_tr_b16 v[190:191], v7 offset:45056
    v_mfma_f32_16x16x32_bf16 v[108:111], v[156:159], v[148:151], v[108:111]
    s_waitcnt lgkmcnt(6)
    v_mfma_f32_16x16x32_bf16 v[96:99], v[168:171], v[160:163], v[96:99]
    v_mfma_f32_16x16x32_bf16 v[100:103], v[168:171], v[164:167], v[100:103]
    v_mfma_f32_16x16x32_bf16 v[104:107], v[172:175], v[160:163], v[104:107]
    v_mfma_f32_16x16x32_bf16 v[108:111], v[172:175], v[164:167], v[108:111]
    s_waitcnt lgkmcnt(0)
    s_barrier
    v_mfma_f32_16x16x32_bf16 v[96:99], v[184:187], v[176:179], v[96:99]
    v_add_u32 v2, 32768, v2
    ds_read_b128 v[128:131], v2 offset:32768
    v_add_u32 v4, 4294901760, v4
    ds_read_b64_tr_b16 v[136:137], v4 offset:49152
    ds_read_b64_tr_b16 v[138:139], v4 offset:53248
    v_mfma_f32_16x16x32_bf16 v[100:103], v[184:187], v[180:183], v[100:103]
    ds_read_b128 v[132:135], v2 offset:33792
    v_add_u32 v5, 4294901760, v5
    ds_read_b64_tr_b16 v[140:141], v5 offset:49152
    ds_read_b64_tr_b16 v[142:143], v5 offset:53248
    v_mfma_f32_16x16x32_bf16 v[104:107], v[188:191], v[176:179], v[104:107]
    ds_read_b128 v[144:147], v2 offset:34816
    ds_read_b64_tr_b16 v[152:153], v4 offset:57344
    ds_read_b64_tr_b16 v[154:155], v4 offset:61440
    v_mfma_f32_16x16x32_bf16 v[108:111], v[188:191], v[180:183], v[108:111]
    ds_read_b128 v[148:151], v2 offset:35840
    ds_read_b64_tr_b16 v[156:157], v5 offset:57344
    ds_read_b64_tr_b16 v[158:159], v5 offset:61440
    s_waitcnt lgkmcnt(6)
    v_mfma_f32_16x16x32_bf16 v[96:99], v[136:139], v[128:131], v[96:99]
    ds_read_b128 v[160:163], v2 offset:36864
    v_add_u32 v6, 4294901760, v6
    ds_read_b64_tr_b16 v[168:169], v6 offset:49152
    v_mfma_f32_16x16x32_bf16 v[100:103], v[136:139], v[132:135], v[100:103]
    ds_read_b64_tr_b16 v[170:171], v6 offset:53248
    ds_read_b128 v[164:167], v2 offset:37888
    v_mfma_f32_16x16x32_bf16 v[104:107], v[140:143], v[128:131], v[104:107]
    v_add_u32 v7, 4294901760, v7
    ds_read_b64_tr_b16 v[172:173], v7 offset:49152
    ds_read_b64_tr_b16 v[174:175], v7 offset:53248
    v_mfma_f32_16x16x32_bf16 v[108:111], v[140:143], v[132:135], v[108:111]
    s_waitcnt lgkmcnt(6)
    v_mfma_f32_16x16x32_bf16 v[96:99], v[152:155], v[144:147], v[96:99]
    ds_read_b128 v[176:179], v2 offset:38912
    ds_read_b64_tr_b16 v[184:185], v6 offset:57344
    v_mfma_f32_16x16x32_bf16 v[100:103], v[152:155], v[148:151], v[100:103]
    ds_read_b64_tr_b16 v[186:187], v6 offset:61440
    ds_read_b128 v[180:183], v2 offset:39936
    v_mfma_f32_16x16x32_bf16 v[104:107], v[156:159], v[144:147], v[104:107]
    ds_read_b64_tr_b16 v[188:189], v7 offset:57344
    ds_read_b64_tr_b16 v[190:191], v7 offset:61440
    v_mfma_f32_16x16x32_bf16 v[108:111], v[156:159], v[148:151], v[108:111]
    s_waitcnt lgkmcnt(6)
    v_mfma_f32_16x16x32_bf16 v[96:99], v[168:171], v[160:163], v[96:99]
    v_mfma_f32_16x16x32_bf16 v[100:103], v[168:171], v[164:167], v[100:103]
    v_mfma_f32_16x16x32_bf16 v[104:107], v[172:175], v[160:163], v[104:107]
    v_mfma_f32_16x16x32_bf16 v[108:111], v[172:175], v[164:167], v[108:111]
    s_waitcnt lgkmcnt(0)
    s_waitcnt vmcnt(0)
    s_barrier
    v_mfma_f32_16x16x32_bf16 v[96:99], v[184:187], v[176:179], v[96:99]
    v_add_u32 v2, 4294868992, v2
    ds_read_b128 v[128:131], v2 offset:16384
    ds_read_b64_tr_b16 v[136:137], v4 offset:32768
    ds_read_b64_tr_b16 v[138:139], v4 offset:36864
    v_mfma_f32_16x16x32_bf16 v[100:103], v[184:187], v[180:183], v[100:103]
    ds_read_b128 v[132:135], v2 offset:17408
    ds_read_b64_tr_b16 v[140:141], v5 offset:32768
    ds_read_b64_tr_b16 v[142:143], v5 offset:36864
    v_mfma_f32_16x16x32_bf16 v[104:107], v[188:191], v[176:179], v[104:107]
    ds_read_b128 v[144:147], v2 offset:18432
    ds_read_b64_tr_b16 v[152:153], v4 offset:40960
    ds_read_b64_tr_b16 v[154:155], v4 offset:45056
    v_mfma_f32_16x16x32_bf16 v[108:111], v[188:191], v[180:183], v[108:111]
    ds_read_b128 v[148:151], v2 offset:19456
    ds_read_b64_tr_b16 v[156:157], v5 offset:40960
    ds_read_b64_tr_b16 v[158:159], v5 offset:45056
    s_waitcnt lgkmcnt(6)
    v_mfma_f32_16x16x32_bf16 v[96:99], v[136:139], v[128:131], v[96:99]
    ds_read_b128 v[160:163], v2 offset:20480
    ds_read_b64_tr_b16 v[168:169], v6 offset:32768
    v_mfma_f32_16x16x32_bf16 v[100:103], v[136:139], v[132:135], v[100:103]
    ds_read_b64_tr_b16 v[170:171], v6 offset:36864
    ds_read_b128 v[164:167], v2 offset:21504
    v_mfma_f32_16x16x32_bf16 v[104:107], v[140:143], v[128:131], v[104:107]
    ds_read_b64_tr_b16 v[172:173], v7 offset:32768
    ds_read_b64_tr_b16 v[174:175], v7 offset:36864
    v_mfma_f32_16x16x32_bf16 v[108:111], v[140:143], v[132:135], v[108:111]
    s_waitcnt lgkmcnt(6)
    v_mfma_f32_16x16x32_bf16 v[96:99], v[152:155], v[144:147], v[96:99]
    ds_read_b128 v[176:179], v2 offset:22528
    ds_read_b64_tr_b16 v[184:185], v6 offset:40960
    v_mfma_f32_16x16x32_bf16 v[100:103], v[152:155], v[148:151], v[100:103]
    ds_read_b64_tr_b16 v[186:187], v6 offset:45056
    ds_read_b128 v[180:183], v2 offset:23552
    v_mfma_f32_16x16x32_bf16 v[104:107], v[156:159], v[144:147], v[104:107]
    ds_read_b64_tr_b16 v[188:189], v7 offset:40960
    ds_read_b64_tr_b16 v[190:191], v7 offset:45056
    v_mfma_f32_16x16x32_bf16 v[108:111], v[156:159], v[148:151], v[108:111]
    s_waitcnt lgkmcnt(6)
    v_mfma_f32_16x16x32_bf16 v[96:99], v[168:171], v[160:163], v[96:99]
    v_mfma_f32_16x16x32_bf16 v[100:103], v[168:171], v[164:167], v[100:103]
    v_mfma_f32_16x16x32_bf16 v[104:107], v[172:175], v[160:163], v[104:107]
    v_mfma_f32_16x16x32_bf16 v[108:111], v[172:175], v[164:167], v[108:111]
    s_waitcnt lgkmcnt(0)
    s_barrier
    v_mfma_f32_16x16x32_bf16 v[96:99], v[184:187], v[176:179], v[96:99]
    ds_read_b128 v[128:131], v2 offset:0
    v_add_u32 v4, 65536, v4
    ds_read_b64_tr_b16 v[136:137], v4 offset:0
    ds_read_b64_tr_b16 v[138:139], v4 offset:4096
    v_mfma_f32_16x16x32_bf16 v[100:103], v[184:187], v[180:183], v[100:103]
    ds_read_b128 v[132:135], v2 offset:1024
    v_add_u32 v5, 65536, v5
    ds_read_b64_tr_b16 v[140:141], v5 offset:0
    ds_read_b64_tr_b16 v[142:143], v5 offset:4096
    v_mfma_f32_16x16x32_bf16 v[104:107], v[188:191], v[176:179], v[104:107]
    ds_read_b128 v[144:147], v2 offset:2048
    ds_read_b64_tr_b16 v[152:153], v4 offset:8192
    ds_read_b64_tr_b16 v[154:155], v4 offset:12288
    v_mfma_f32_16x16x32_bf16 v[108:111], v[188:191], v[180:183], v[108:111]
    ds_read_b128 v[148:151], v2 offset:3072
    ds_read_b64_tr_b16 v[156:157], v5 offset:8192
    ds_read_b64_tr_b16 v[158:159], v5 offset:12288
    s_waitcnt lgkmcnt(6)
    v_mfma_f32_16x16x32_bf16 v[96:99], v[136:139], v[128:131], v[96:99]
    ds_read_b128 v[160:163], v2 offset:4096
    v_add_u32 v6, 65536, v6
    ds_read_b64_tr_b16 v[168:169], v6 offset:0
    v_mfma_f32_16x16x32_bf16 v[100:103], v[136:139], v[132:135], v[100:103]
    ds_read_b64_tr_b16 v[170:171], v6 offset:4096
    ds_read_b128 v[164:167], v2 offset:5120
    v_mfma_f32_16x16x32_bf16 v[104:107], v[140:143], v[128:131], v[104:107]
    v_add_u32 v7, 65536, v7
    ds_read_b64_tr_b16 v[172:173], v7 offset:0
    ds_read_b64_tr_b16 v[174:175], v7 offset:4096
    v_mfma_f32_16x16x32_bf16 v[108:111], v[140:143], v[132:135], v[108:111]
    s_waitcnt lgkmcnt(6)
    v_mfma_f32_16x16x32_bf16 v[96:99], v[152:155], v[144:147], v[96:99]
    ds_read_b128 v[176:179], v2 offset:6144
    ds_read_b64_tr_b16 v[184:185], v6 offset:8192
    v_mfma_f32_16x16x32_bf16 v[100:103], v[152:155], v[148:151], v[100:103]
    ds_read_b64_tr_b16 v[186:187], v6 offset:12288
    ds_read_b128 v[180:183], v2 offset:7168
    v_mfma_f32_16x16x32_bf16 v[104:107], v[156:159], v[144:147], v[104:107]
    ds_read_b64_tr_b16 v[188:189], v7 offset:8192
    ds_read_b64_tr_b16 v[190:191], v7 offset:12288
    v_mfma_f32_16x16x32_bf16 v[108:111], v[156:159], v[148:151], v[108:111]
    s_waitcnt lgkmcnt(6)
    v_mfma_f32_16x16x32_bf16 v[96:99], v[168:171], v[160:163], v[96:99]
    v_mfma_f32_16x16x32_bf16 v[100:103], v[168:171], v[164:167], v[100:103]
    v_mfma_f32_16x16x32_bf16 v[104:107], v[172:175], v[160:163], v[104:107]
    v_mfma_f32_16x16x32_bf16 v[108:111], v[172:175], v[164:167], v[108:111]
    s_waitcnt lgkmcnt(0)
    s_barrier
    v_mfma_f32_16x16x32_bf16 v[96:99], v[184:187], v[176:179], v[96:99]
    v_add_u32 v2, 65536, v2
    ds_read_b128 v[128:131], v2 offset:49152
    ds_read_b64_tr_b16 v[136:137], v4 offset:16384
    ds_read_b64_tr_b16 v[138:139], v4 offset:20480
    v_mfma_f32_16x16x32_bf16 v[100:103], v[184:187], v[180:183], v[100:103]
    ds_read_b128 v[132:135], v2 offset:50176
    ds_read_b64_tr_b16 v[140:141], v5 offset:16384
    ds_read_b64_tr_b16 v[142:143], v5 offset:20480
    v_mfma_f32_16x16x32_bf16 v[104:107], v[188:191], v[176:179], v[104:107]
    ds_read_b128 v[144:147], v2 offset:51200
    ds_read_b64_tr_b16 v[152:153], v4 offset:24576
    ds_read_b64_tr_b16 v[154:155], v4 offset:28672
    v_mfma_f32_16x16x32_bf16 v[108:111], v[188:191], v[180:183], v[108:111]
    ds_read_b128 v[148:151], v2 offset:52224
    ds_read_b64_tr_b16 v[156:157], v5 offset:24576
    ds_read_b64_tr_b16 v[158:159], v5 offset:28672
    s_waitcnt lgkmcnt(6)
    v_mfma_f32_16x16x32_bf16 v[96:99], v[136:139], v[128:131], v[96:99]
    ds_read_b128 v[160:163], v2 offset:53248
    ds_read_b64_tr_b16 v[168:169], v6 offset:16384
    v_mfma_f32_16x16x32_bf16 v[100:103], v[136:139], v[132:135], v[100:103]
    ds_read_b64_tr_b16 v[170:171], v6 offset:20480
    ds_read_b128 v[164:167], v2 offset:54272
    v_mfma_f32_16x16x32_bf16 v[104:107], v[140:143], v[128:131], v[104:107]
    ds_read_b64_tr_b16 v[172:173], v7 offset:16384
    ds_read_b64_tr_b16 v[174:175], v7 offset:20480
    v_mfma_f32_16x16x32_bf16 v[108:111], v[140:143], v[132:135], v[108:111]
    s_waitcnt lgkmcnt(6)
    v_mfma_f32_16x16x32_bf16 v[96:99], v[152:155], v[144:147], v[96:99]
    ds_read_b128 v[176:179], v2 offset:55296
    ds_read_b64_tr_b16 v[184:185], v6 offset:24576
    v_mfma_f32_16x16x32_bf16 v[100:103], v[152:155], v[148:151], v[100:103]
    ds_read_b64_tr_b16 v[186:187], v6 offset:28672
    ds_read_b128 v[180:183], v2 offset:56320
    v_mfma_f32_16x16x32_bf16 v[104:107], v[156:159], v[144:147], v[104:107]
    ds_read_b64_tr_b16 v[188:189], v7 offset:24576
    ds_read_b64_tr_b16 v[190:191], v7 offset:28672
    v_mfma_f32_16x16x32_bf16 v[108:111], v[156:159], v[148:151], v[108:111]
    s_waitcnt lgkmcnt(6)
    v_mfma_f32_16x16x32_bf16 v[96:99], v[168:171], v[160:163], v[96:99]
    v_mfma_f32_16x16x32_bf16 v[100:103], v[168:171], v[164:167], v[100:103]
    v_mfma_f32_16x16x32_bf16 v[104:107], v[172:175], v[160:163], v[104:107]
    v_mfma_f32_16x16x32_bf16 v[108:111], v[172:175], v[164:167], v[108:111]
    s_waitcnt lgkmcnt(0)
    s_barrier
    v_mfma_f32_16x16x32_bf16 v[96:99], v[184:187], v[176:179], v[96:99]
    v_add_u32 v2, 32768, v2
    ds_read_b128 v[128:131], v2 offset:32768
    ds_read_b64_tr_b16 v[136:137], v4 offset:32768
    ds_read_b64_tr_b16 v[138:139], v4 offset:36864
    v_mfma_f32_16x16x32_bf16 v[100:103], v[184:187], v[180:183], v[100:103]
    ds_read_b128 v[132:135], v2 offset:33792
    ds_read_b64_tr_b16 v[140:141], v5 offset:32768
    ds_read_b64_tr_b16 v[142:143], v5 offset:36864
    v_mfma_f32_16x16x32_bf16 v[104:107], v[188:191], v[176:179], v[104:107]
    ds_read_b128 v[144:147], v2 offset:34816
    ds_read_b64_tr_b16 v[152:153], v4 offset:40960
    ds_read_b64_tr_b16 v[154:155], v4 offset:45056
    v_mfma_f32_16x16x32_bf16 v[108:111], v[188:191], v[180:183], v[108:111]
    ds_read_b128 v[148:151], v2 offset:35840
    ds_read_b64_tr_b16 v[156:157], v5 offset:40960
    ds_read_b64_tr_b16 v[158:159], v5 offset:45056
    s_lshr_b32 s68, s56, 1
    s_lshl1_add_u32 s67, s60, s68
    s_lshl_b32 s68, s67, 7
    s_add_u32 s68, s68, 8192
    v_and_b32 v16, 15, v1
    v_lshlrev_b32 v17, 2, v16
    buffer_load_dword v8, v17, s[24:27], s68 offen sc1
    buffer_load_dword v10, v17, s[24:27], s68 offen offset:64 sc1
    s_lshl_b32 s67, s67, 15
    s_lshl_b32 s68, s61, 7
    s_add_u32 s67, s67, s68
    s_and_b32 s68, s56, 1
    s_lshl_b32 s68, s68, 6
    s_add_u32 s67, s67, s68
    v_lshl_add_u32 v3, v16, 10, s67
    v_bfe_u32 v16, v1, 4, 1
    v_lshl_add_u32 v3, v16, 5, v3
    v_lshrrev_b32 v16, 5, v1
    v_lshl_add_u32 v3, v16, 4, v3
    s_movk_i32 s69, 0x4000
    s_waitcnt lgkmcnt(6)
    v_mfma_f32_16x16x32_bf16 v[96:99], v[136:139], v[128:131], v[96:99]
    ds_read_b128 v[160:163], v2 offset:36864
    ds_read_b64_tr_b16 v[168:169], v6 offset:32768
    v_mfma_f32_16x16x32_bf16 v[100:103], v[136:139], v[132:135], v[100:103]
    ds_read_b64_tr_b16 v[170:171], v6 offset:36864
    ds_read_b128 v[164:167], v2 offset:37888
    v_mfma_f32_16x16x32_bf16 v[104:107], v[140:143], v[128:131], v[104:107]
    ds_read_b64_tr_b16 v[172:173], v7 offset:32768
    ds_read_b64_tr_b16 v[174:175], v7 offset:36864
    v_mfma_f32_16x16x32_bf16 v[108:111], v[140:143], v[132:135], v[108:111]
    s_waitcnt lgkmcnt(6)
    v_mfma_f32_16x16x32_bf16 v[96:99], v[152:155], v[144:147], v[96:99]
    ds_read_b128 v[176:179], v2 offset:38912
    ds_read_b64_tr_b16 v[184:185], v6 offset:40960
    v_mfma_f32_16x16x32_bf16 v[100:103], v[152:155], v[148:151], v[100:103]
    ds_read_b64_tr_b16 v[186:187], v6 offset:45056
    ds_read_b128 v[180:183], v2 offset:39936
    v_mfma_f32_16x16x32_bf16 v[104:107], v[156:159], v[144:147], v[104:107]
    ds_read_b64_tr_b16 v[188:189], v7 offset:40960
    ds_read_b64_tr_b16 v[190:191], v7 offset:45056
    v_mfma_f32_16x16x32_bf16 v[108:111], v[156:159], v[148:151], v[108:111]
    s_waitcnt lgkmcnt(6)
    v_mfma_f32_16x16x32_bf16 v[96:99], v[168:171], v[160:163], v[96:99]
    v_mfma_f32_16x16x32_bf16 v[100:103], v[168:171], v[164:167], v[100:103]
    v_mfma_f32_16x16x32_bf16 v[104:107], v[172:175], v[160:163], v[104:107]
    v_mfma_f32_16x16x32_bf16 v[108:111], v[172:175], v[164:167], v[108:111]
    s_waitcnt lgkmcnt(0)
    s_barrier
    v_mfma_f32_16x16x32_bf16 v[96:99], v[184:187], v[176:179], v[96:99]
    v_add_u32 v2, 4294868992, v2
    ds_read_b128 v[128:131], v2 offset:16384
    v_add_u32 v4, 4294901760, v4
    ds_read_b64_tr_b16 v[136:137], v4 offset:49152
    ds_read_b64_tr_b16 v[138:139], v4 offset:53248
    v_mfma_f32_16x16x32_bf16 v[100:103], v[184:187], v[180:183], v[100:103]
    ds_read_b128 v[132:135], v2 offset:17408
    v_add_u32 v5, 4294901760, v5
    ds_read_b64_tr_b16 v[140:141], v5 offset:49152
    ds_read_b64_tr_b16 v[142:143], v5 offset:53248
    v_mfma_f32_16x16x32_bf16 v[104:107], v[188:191], v[176:179], v[104:107]
    ds_read_b128 v[144:147], v2 offset:18432
    ds_read_b64_tr_b16 v[152:153], v4 offset:57344
    ds_read_b64_tr_b16 v[154:155], v4 offset:61440
    v_mfma_f32_16x16x32_bf16 v[108:111], v[188:191], v[180:183], v[108:111]
    ds_read_b128 v[148:151], v2 offset:19456
    ds_read_b64_tr_b16 v[156:157], v5 offset:57344
    ds_read_b64_tr_b16 v[158:159], v5 offset:61440
    s_waitcnt lgkmcnt(6)
    v_mfma_f32_16x16x32_bf16 v[96:99], v[136:139], v[128:131], v[96:99]
    ds_read_b128 v[160:163], v2 offset:20480
    v_add_u32 v6, 4294901760, v6
    ds_read_b64_tr_b16 v[168:169], v6 offset:49152
    v_mfma_f32_16x16x32_bf16 v[100:103], v[136:139], v[132:135], v[100:103]
    ds_read_b64_tr_b16 v[170:171], v6 offset:53248
    ds_read_b128 v[164:167], v2 offset:21504
    v_mfma_f32_16x16x32_bf16 v[104:107], v[140:143], v[128:131], v[104:107]
    v_add_u32 v7, 4294901760, v7
    ds_read_b64_tr_b16 v[172:173], v7 offset:49152
    ds_read_b64_tr_b16 v[174:175], v7 offset:53248
    v_mfma_f32_16x16x32_bf16 v[108:111], v[140:143], v[132:135], v[108:111]
    s_waitcnt lgkmcnt(6)
    v_mfma_f32_16x16x32_bf16 v[96:99], v[152:155], v[144:147], v[96:99]
    ds_read_b128 v[176:179], v2 offset:22528
    ds_read_b64_tr_b16 v[184:185], v6 offset:57344
    v_mfma_f32_16x16x32_bf16 v[100:103], v[152:155], v[148:151], v[100:103]
    ds_read_b64_tr_b16 v[186:187], v6 offset:61440
    ds_read_b128 v[180:183], v2 offset:23552
    v_mfma_f32_16x16x32_bf16 v[104:107], v[156:159], v[144:147], v[104:107]
    ds_read_b64_tr_b16 v[188:189], v7 offset:57344
    ds_read_b64_tr_b16 v[190:191], v7 offset:61440
    v_mfma_f32_16x16x32_bf16 v[108:111], v[156:159], v[148:151], v[108:111]
    s_waitcnt lgkmcnt(6)
    v_mfma_f32_16x16x32_bf16 v[96:99], v[168:171], v[160:163], v[96:99]
    v_mfma_f32_16x16x32_bf16 v[100:103], v[168:171], v[164:167], v[100:103]
    v_mfma_f32_16x16x32_bf16 v[104:107], v[172:175], v[160:163], v[104:107]
    v_mfma_f32_16x16x32_bf16 v[108:111], v[172:175], v[164:167], v[108:111]
    s_waitcnt lgkmcnt(0)
    s_barrier
    v_mfma_f32_16x16x32_bf16 v[96:99], v[184:187], v[176:179], v[96:99]
    ds_read_b128 v[128:131], v2 offset:0
    ds_read_b64_tr_b16 v[136:137], v4 offset:32768
    ds_read_b64_tr_b16 v[138:139], v4 offset:36864
    v_mfma_f32_16x16x32_bf16 v[100:103], v[184:187], v[180:183], v[100:103]
    ds_read_b128 v[132:135], v2 offset:1024
    ds_read_b64_tr_b16 v[140:141], v5 offset:32768
    ds_read_b64_tr_b16 v[142:143], v5 offset:36864
    v_mfma_f32_16x16x32_bf16 v[104:107], v[188:191], v[176:179], v[104:107]
    ds_read_b128 v[144:147], v2 offset:2048
    ds_read_b64_tr_b16 v[152:153], v4 offset:40960
    ds_read_b64_tr_b16 v[154:155], v4 offset:45056
    v_mfma_f32_16x16x32_bf16 v[108:111], v[188:191], v[180:183], v[108:111]
    ds_read_b128 v[148:151], v2 offset:3072
    ds_read_b64_tr_b16 v[156:157], v5 offset:40960
    ds_read_b64_tr_b16 v[158:159], v5 offset:45056
    s_waitcnt lgkmcnt(6)
    v_mfma_f32_16x16x32_bf16 v[112:115], v[136:139], v[128:131], 0
    ds_read_b128 v[160:163], v2 offset:4096
    ds_read_b64_tr_b16 v[168:169], v6 offset:32768
    v_mfma_f32_16x16x32_bf16 v[116:119], v[136:139], v[132:135], 0
    ds_read_b64_tr_b16 v[170:171], v6 offset:36864
    ds_read_b128 v[164:167], v2 offset:5120
    v_mfma_f32_16x16x32_bf16 v[120:123], v[140:143], v[128:131], 0
    ds_read_b64_tr_b16 v[172:173], v7 offset:32768
    ds_read_b64_tr_b16 v[174:175], v7 offset:36864
    v_mfma_f32_16x16x32_bf16 v[124:127], v[140:143], v[132:135], 0
    s_waitcnt lgkmcnt(6)
    v_mfma_f32_16x16x32_bf16 v[112:115], v[152:155], v[144:147], v[112:115]
    ds_read_b128 v[176:179], v2 offset:6144
    ds_read_b64_tr_b16 v[184:185], v6 offset:40960
    v_mfma_f32_16x16x32_bf16 v[116:119], v[152:155], v[148:151], v[116:119]
    ds_read_b64_tr_b16 v[186:187], v6 offset:45056
    ds_read_b128 v[180:183], v2 offset:7168
    v_mfma_f32_16x16x32_bf16 v[120:123], v[156:159], v[144:147], v[120:123]
    ds_read_b64_tr_b16 v[188:189], v7 offset:40960
    ds_read_b64_tr_b16 v[190:191], v7 offset:45056
    v_mfma_f32_16x16x32_bf16 v[124:127], v[156:159], v[148:151], v[124:127]
    s_waitcnt lgkmcnt(6)
    v_mfma_f32_16x16x32_bf16 v[112:115], v[168:171], v[160:163], v[112:115]
    v_mfma_f32_16x16x32_bf16 v[116:119], v[168:171], v[164:167], v[116:119]
    v_mfma_f32_16x16x32_bf16 v[120:123], v[172:175], v[160:163], v[120:123]
    v_mfma_f32_16x16x32_bf16 v[124:127], v[172:175], v[164:167], v[124:127]
    s_waitcnt lgkmcnt(0)
    s_barrier
    v_mfma_f32_16x16x32_bf16 v[112:115], v[184:187], v[176:179], v[112:115]
    v_add_u32 v2, 65536, v2
    ds_read_b128 v[128:131], v2 offset:49152
    v_add_u32 v4, 65536, v4
    ds_read_b64_tr_b16 v[136:137], v4 offset:0
    ds_read_b64_tr_b16 v[138:139], v4 offset:4096
    v_mfma_f32_16x16x32_bf16 v[116:119], v[184:187], v[180:183], v[116:119]
    ds_read_b128 v[132:135], v2 offset:50176
    v_add_u32 v5, 65536, v5
    ds_read_b64_tr_b16 v[140:141], v5 offset:0
    ds_read_b64_tr_b16 v[142:143], v5 offset:4096
    v_mfma_f32_16x16x32_bf16 v[120:123], v[188:191], v[176:179], v[120:123]
    ds_read_b128 v[144:147], v2 offset:51200
    ds_read_b64_tr_b16 v[152:153], v4 offset:8192
    ds_read_b64_tr_b16 v[154:155], v4 offset:12288
    v_mfma_f32_16x16x32_bf16 v[124:127], v[188:191], v[180:183], v[124:127]
    ds_read_b128 v[148:151], v2 offset:52224
    ds_read_b64_tr_b16 v[156:157], v5 offset:8192
    ds_read_b64_tr_b16 v[158:159], v5 offset:12288
    s_waitcnt vmcnt(0)
    v_sub_f32 v16, 1.0, v8
    v_sub_f32 v17, 1.0, v10
    v_mul_f32 v96, v16, v96
    v_mul_f32 v97, v16, v97
    v_mul_f32 v98, v16, v98
    v_mul_f32 v99, v16, v99
    v_mul_f32 v100, v17, v100
    v_mul_f32 v101, v17, v101
    v_mul_f32 v102, v17, v102
    v_mul_f32 v103, v17, v103
    v_mul_f32 v104, v16, v104
    v_mul_f32 v105, v16, v105
    v_mul_f32 v106, v16, v106
    v_mul_f32 v107, v16, v107
    v_mul_f32 v108, v17, v108
    v_mul_f32 v109, v17, v109
    v_mul_f32 v110, v17, v110
    v_mul_f32 v111, v17, v111
    s_waitcnt lgkmcnt(6)
    v_mfma_f32_16x16x32_bf16 v[112:115], v[136:139], v[128:131], v[112:115]
    ds_read_b128 v[160:163], v2 offset:53248
    v_add_u32 v6, 65536, v6
    ds_read_b64_tr_b16 v[168:169], v6 offset:0
    v_mfma_f32_16x16x32_bf16 v[116:119], v[136:139], v[132:135], v[116:119]
    ds_read_b64_tr_b16 v[170:171], v6 offset:4096
    ds_read_b128 v[164:167], v2 offset:54272
    v_mfma_f32_16x16x32_bf16 v[120:123], v[140:143], v[128:131], v[120:123]
    v_add_u32 v7, 65536, v7
    ds_read_b64_tr_b16 v[172:173], v7 offset:0
    ds_read_b64_tr_b16 v[174:175], v7 offset:4096
    v_mfma_f32_16x16x32_bf16 v[124:127], v[140:143], v[132:135], v[124:127]
    s_waitcnt lgkmcnt(6)
    v_mfma_f32_16x16x32_bf16 v[112:115], v[152:155], v[144:147], v[112:115]
    ds_read_b128 v[176:179], v2 offset:55296
    ds_read_b64_tr_b16 v[184:185], v6 offset:8192
    v_mfma_f32_16x16x32_bf16 v[116:119], v[152:155], v[148:151], v[116:119]
    ds_read_b64_tr_b16 v[186:187], v6 offset:12288
    ds_read_b128 v[180:183], v2 offset:56320
    v_mfma_f32_16x16x32_bf16 v[120:123], v[156:159], v[144:147], v[120:123]
    ds_read_b64_tr_b16 v[188:189], v7 offset:8192
    ds_read_b64_tr_b16 v[190:191], v7 offset:12288
    v_mfma_f32_16x16x32_bf16 v[124:127], v[156:159], v[148:151], v[124:127]
    s_waitcnt lgkmcnt(6)
    v_mfma_f32_16x16x32_bf16 v[112:115], v[168:171], v[160:163], v[112:115]
    v_mfma_f32_16x16x32_bf16 v[116:119], v[168:171], v[164:167], v[116:119]
    v_mfma_f32_16x16x32_bf16 v[120:123], v[172:175], v[160:163], v[120:123]
    v_mfma_f32_16x16x32_bf16 v[124:127], v[172:175], v[164:167], v[124:127]
    s_waitcnt lgkmcnt(0)
    s_barrier
    v_mfma_f32_16x16x32_bf16 v[112:115], v[184:187], v[176:179], v[112:115]
    v_add_u32 v2, 32768, v2
    ds_read_b128 v[128:131], v2 offset:32768
    ds_read_b64_tr_b16 v[136:137], v4 offset:16384
    ds_read_b64_tr_b16 v[138:139], v4 offset:20480
    v_mfma_f32_16x16x32_bf16 v[116:119], v[184:187], v[180:183], v[116:119]
    ds_read_b128 v[132:135], v2 offset:33792
    ds_read_b64_tr_b16 v[140:141], v5 offset:16384
    ds_read_b64_tr_b16 v[142:143], v5 offset:20480
    v_mfma_f32_16x16x32_bf16 v[120:123], v[188:191], v[176:179], v[120:123]
    ds_read_b128 v[144:147], v2 offset:34816
    ds_read_b64_tr_b16 v[152:153], v4 offset:24576
    ds_read_b64_tr_b16 v[154:155], v4 offset:28672
    v_mfma_f32_16x16x32_bf16 v[124:127], v[188:191], v[180:183], v[124:127]
    ds_read_b128 v[148:151], v2 offset:35840
    ds_read_b64_tr_b16 v[156:157], v5 offset:24576
    ds_read_b64_tr_b16 v[158:159], v5 offset:28672
    s_waitcnt lgkmcnt(6)
    v_mfma_f32_16x16x32_bf16 v[112:115], v[136:139], v[128:131], v[112:115]
    ds_read_b128 v[160:163], v2 offset:36864
    ds_read_b64_tr_b16 v[168:169], v6 offset:16384
    v_mfma_f32_16x16x32_bf16 v[116:119], v[136:139], v[132:135], v[116:119]
    ds_read_b64_tr_b16 v[170:171], v6 offset:20480
    ds_read_b128 v[164:167], v2 offset:37888
    v_mfma_f32_16x16x32_bf16 v[120:123], v[140:143], v[128:131], v[120:123]
    ds_read_b64_tr_b16 v[172:173], v7 offset:16384
    ds_read_b64_tr_b16 v[174:175], v7 offset:20480
    v_mfma_f32_16x16x32_bf16 v[124:127], v[140:143], v[132:135], v[124:127]
    s_waitcnt lgkmcnt(6)
    v_mfma_f32_16x16x32_bf16 v[112:115], v[152:155], v[144:147], v[112:115]
    ds_read_b128 v[176:179], v2 offset:38912
    ds_read_b64_tr_b16 v[184:185], v6 offset:24576
    v_mfma_f32_16x16x32_bf16 v[116:119], v[152:155], v[148:151], v[116:119]
    ds_read_b64_tr_b16 v[186:187], v6 offset:28672
    ds_read_b128 v[180:183], v2 offset:39936
    v_mfma_f32_16x16x32_bf16 v[120:123], v[156:159], v[144:147], v[120:123]
    ds_read_b64_tr_b16 v[188:189], v7 offset:24576
    ds_read_b64_tr_b16 v[190:191], v7 offset:28672
    v_mfma_f32_16x16x32_bf16 v[124:127], v[156:159], v[148:151], v[124:127]
    s_waitcnt lgkmcnt(6)
    v_mfma_f32_16x16x32_bf16 v[112:115], v[168:171], v[160:163], v[112:115]
    v_mfma_f32_16x16x32_bf16 v[116:119], v[168:171], v[164:167], v[116:119]
    v_mfma_f32_16x16x32_bf16 v[120:123], v[172:175], v[160:163], v[120:123]
    v_mfma_f32_16x16x32_bf16 v[124:127], v[172:175], v[164:167], v[124:127]
    s_waitcnt lgkmcnt(0)
    s_barrier
    v_mfma_f32_16x16x32_bf16 v[112:115], v[184:187], v[176:179], v[112:115]
    v_add_u32 v2, 4294868992, v2
    ds_read_b128 v[128:131], v2 offset:49152
    ds_read_b64_tr_b16 v[136:137], v4 offset:32768
    ds_read_b64_tr_b16 v[138:139], v4 offset:36864
    v_mfma_f32_16x16x32_bf16 v[116:119], v[184:187], v[180:183], v[116:119]
    ds_read_b128 v[132:135], v2 offset:50176
    ds_read_b64_tr_b16 v[140:141], v5 offset:32768
    ds_read_b64_tr_b16 v[142:143], v5 offset:36864
    v_mfma_f32_16x16x32_bf16 v[120:123], v[188:191], v[176:179], v[120:123]
    ds_read_b128 v[144:147], v2 offset:51200
    ds_read_b64_tr_b16 v[152:153], v4 offset:40960
    ds_read_b64_tr_b16 v[154:155], v4 offset:45056
    v_mfma_f32_16x16x32_bf16 v[124:127], v[188:191], v[180:183], v[124:127]
    ds_read_b128 v[148:151], v2 offset:52224
    ds_read_b64_tr_b16 v[156:157], v5 offset:40960
    ds_read_b64_tr_b16 v[158:159], v5 offset:45056
    s_waitcnt lgkmcnt(6)
    v_mfma_f32_16x16x32_bf16 v[112:115], v[136:139], v[128:131], v[112:115]
    ds_read_b128 v[160:163], v2 offset:53248
    ds_read_b64_tr_b16 v[168:169], v6 offset:32768
    v_mfma_f32_16x16x32_bf16 v[116:119], v[136:139], v[132:135], v[116:119]
    ds_read_b64_tr_b16 v[170:171], v6 offset:36864
    ds_read_b128 v[164:167], v2 offset:54272
    v_mfma_f32_16x16x32_bf16 v[120:123], v[140:143], v[128:131], v[120:123]
    ds_read_b64_tr_b16 v[172:173], v7 offset:32768
    ds_read_b64_tr_b16 v[174:175], v7 offset:36864
    v_mfma_f32_16x16x32_bf16 v[124:127], v[140:143], v[132:135], v[124:127]
    s_waitcnt lgkmcnt(6)
    v_mfma_f32_16x16x32_bf16 v[112:115], v[152:155], v[144:147], v[112:115]
    ds_read_b128 v[176:179], v2 offset:55296
    ds_read_b64_tr_b16 v[184:185], v6 offset:40960
    v_mfma_f32_16x16x32_bf16 v[116:119], v[152:155], v[148:151], v[116:119]
    ds_read_b64_tr_b16 v[186:187], v6 offset:45056
    ds_read_b128 v[180:183], v2 offset:56320
    v_mfma_f32_16x16x32_bf16 v[120:123], v[156:159], v[144:147], v[120:123]
    ds_read_b64_tr_b16 v[188:189], v7 offset:40960
    ds_read_b64_tr_b16 v[190:191], v7 offset:45056
    v_mfma_f32_16x16x32_bf16 v[124:127], v[156:159], v[148:151], v[124:127]
    s_waitcnt lgkmcnt(6)
    v_mfma_f32_16x16x32_bf16 v[112:115], v[168:171], v[160:163], v[112:115]
    v_mfma_f32_16x16x32_bf16 v[116:119], v[168:171], v[164:167], v[116:119]
    v_mfma_f32_16x16x32_bf16 v[120:123], v[172:175], v[160:163], v[120:123]
    v_mfma_f32_16x16x32_bf16 v[124:127], v[172:175], v[164:167], v[124:127]
    s_waitcnt lgkmcnt(0)
    v_mfma_f32_16x16x32_bf16 v[112:115], v[184:187], v[176:179], v[112:115]
    v_mfma_f32_16x16x32_bf16 v[116:119], v[184:187], v[180:183], v[116:119]
    v_mfma_f32_16x16x32_bf16 v[120:123], v[188:191], v[176:179], v[120:123]
    v_mfma_f32_16x16x32_bf16 v[124:127], v[188:191], v[180:183], v[124:127]
    s_nop 4
    v_pk_fma_f32 v[112:113], v[112:113], v[8:9], v[96:97] op_sel_hi:[1,0,1]
    v_pk_fma_f32 v[114:115], v[114:115], v[8:9], v[98:99] op_sel_hi:[1,0,1]
    v_pk_fma_f32 v[120:121], v[120:121], v[8:9], v[104:105] op_sel_hi:[1,0,1]
    v_pk_fma_f32 v[122:123], v[122:123], v[8:9], v[106:107] op_sel_hi:[1,0,1]
    v_cvt_pk_bf16_f32 v64, v112, v113
    v_cvt_pk_bf16_f32 v65, v114, v115
    v_cvt_pk_bf16_f32 v66, v120, v121
    v_cvt_pk_bf16_f32 v67, v122, v123
    s_nop 0
    v_permlane16_swap_b32 v64, v66
    v_permlane16_swap_b32 v65, v67
    buffer_store_dwordx4 v[64:67], v3, s[28:31], 0 offen sc1
    v_pk_fma_f32 v[116:117], v[116:117], v[10:11], v[100:101] op_sel_hi:[1,0,1]
    v_pk_fma_f32 v[118:119], v[118:119], v[10:11], v[102:103] op_sel_hi:[1,0,1]
    v_pk_fma_f32 v[124:125], v[124:125], v[10:11], v[108:109] op_sel_hi:[1,0,1]
    v_pk_fma_f32 v[126:127], v[126:127], v[10:11], v[110:111] op_sel_hi:[1,0,1]
    v_cvt_pk_bf16_f32 v68, v116, v117
    v_cvt_pk_bf16_f32 v69, v118, v119
    v_cvt_pk_bf16_f32 v70, v124, v125
    v_cvt_pk_bf16_f32 v71, v126, v127
    s_nop 0
    v_permlane16_swap_b32 v68, v70
    v_permlane16_swap_b32 v69, v71
    buffer_store_dwordx4 v[68:71], v3, s[28:31], s69 offen sc1
    s_endpgm
L_end:
    s_endpgm
.section .rodata,"a"
.p2align 6
.amdhsa_kernel gated_mix__linear_attn_block__dense_activation_relu__prompt_kernel
  .amdhsa_next_free_vgpr 256
  .amdhsa_next_free_sgpr 102
  .amdhsa_accum_offset 256
  .amdhsa_group_segment_fixed_size 0
  .amdhsa_kernarg_size 80
  .amdhsa_user_sgpr_count 2
  .amdhsa_user_sgpr_kernarg_segment_ptr 1
  .amdhsa_system_sgpr_workgroup_id_x 1
.end_amdhsa_kernel
```
